```python
import torch

def _softmax(x, axis=-1):
    return torch.softmax(x, dim=axis)

def _gelu(x):
    return torch.nn.functional.gelu(x, approximate='tanh')

def _silu(x):
    return torch.nn.functional.silu(x)

def _sigmoid(x):
    return torch.sigmoid(x)

def _layernorm(x, axis=-1, eps=1e-05):
    m = x.mean(dim=axis, keepdim=True)
    v = x.var(dim=axis, keepdim=True, unbiased=False)
    return (x - m) / torch.sqrt(v + eps)

def _scatter_add(tgt, idx, src, axis=0):
    return tgt.clone().index_add_(axis, idx, src)

def _segment_sum(src, seg, n):
    out = torch.zeros((n,) + src.shape[1:], dtype=src.dtype)
    return out.index_add_(0, seg, src)

def _pad(x, pw):
    flat = tuple((v for pair in reversed(pw) for v in pair))
    return torch.nn.functional.pad(x, flat)
kernel_name = 'adaLN_cond__softmax_full_mha__mixer_gmlp__prompt'

def setup_inputs():

    _w = lambda a: (lambda t: t.to(torch.bfloat16) if t.is_floating_point() else t)(torch.as_tensor(a))

    def _A_setup():
        B, S, D = (1, 2048, 640)
        return {'x': _w((lambda *s: torch.randn(*s, dtype=torch.bfloat16) * 0.05)(B, S, D)), 'wqkv': _w((lambda *s: torch.randn(*s, dtype=torch.bfloat16) * 0.05)(D, 3 * D)), 'wo': _w((lambda *s: torch.randn(*s, dtype=torch.bfloat16) * 0.05)(D, D))}
    _A_in = _A_setup()

    def _B_setup():
        B, S, D, F = (1, 2048, 640, 1728)
        Fh = F // 2
        return {'x': _w((lambda *s: torch.randn(*s, dtype=torch.bfloat16) * 0.05)(B, S, D)), 'w_in': _w((lambda *s: torch.randn(*s, dtype=torch.bfloat16) * 0.4)(D, 2 * Fh)), 'w_sp': _w(0.01 * (lambda *s: torch.randn(*s, dtype=torch.bfloat16) * 0.4)(S, S)), 'b_sp': _w(1.0 + 0.01 * (lambda *s: torch.randn(*s, dtype=torch.bfloat16) * 0.05)(S)), 'w_out': _w((lambda *s: torch.randn(*s, dtype=torch.bfloat16) * 0.05)(Fh, D))}
    _B_in = _B_setup()
    return {'A_x': _A_in['x'], 'A_wqkv': _A_in['wqkv'], 'A_wo': _A_in['wo'], 'B_x': _B_in['x'], 'B_w_in': _B_in['w_in'], 'B_w_sp': _B_in['w_sp'], 'B_b_sp': _B_in['b_sp'], 'B_w_out': _B_in['w_out'], 'c': _w((lambda *s: torch.randn(*s, dtype=torch.bfloat16) * 0.1)(1, 640) * 8.0), 'w_mod': _w((lambda *s: torch.randn(*s, dtype=torch.bfloat16) * 0.1)(640, 6 * 640) * 640 ** (-0.5) * 8.0)}

def reference(A_x, A_wqkv, A_wo, B_x, B_w_in, B_w_sp, B_b_sp, B_w_out, c, w_mod):

    def _A_ref(x, wqkv, wo):
        B, S, D = x.shape
        H = 32
        Dh = D // H
        qkv = (lambda x, *d: x.permute(*d))((x @ wqkv).reshape(B, S, 3, H, Dh), 2, 0, 3, 1, 4)
        q, k, v = (qkv[0], qkv[1], qkv[2])
        scale = Dh ** (-0.5)
        scores = torch.einsum('bhqd,bhkd->bhqk', q, k) * scale
        p = _softmax(scores, axis=-1)
        o = torch.einsum('bhqk,bhkd->bhqd', p, v)
        return (lambda x, *d: x.permute(*d))(o, 0, 2, 1, 3).reshape(B, S, D) @ wo

    def _B_ref(x, w_in, w_sp, b_sp, w_out):
        B, S, D = x.shape
        F = w_in.shape[-1]
        Fh = F // 2
        z = _gelu(torch.einsum('bsd,df->bsf', x, w_in))
        z1 = z[..., :Fh].clone()
        z2 = _layernorm(z[..., Fh:], axis=-1)
        g = torch.einsum('ts,bsf->btf', w_sp, z2) + b_sp[None, :, None]
        return torch.einsum('bsf,fd->bsd', z1 * g, w_out)
    x = A_x
    mod = (_silu(c) @ w_mod).reshape(c.shape[0], 6, 1, -1)
    sa, ca, ga, sb, cb, gb = (mod[:, 0].clone(), mod[:, 1].clone(), mod[:, 2].clone(), mod[:, 3].clone(), mod[:, 4].clone(), mod[:, 5].clone())
    h = _layernorm(x, axis=-1) * (1 + ca) + sa
    x = x + ga * _A_ref(h, A_wqkv, A_wo)
    h = _layernorm(x, axis=-1) * (1 + cb) + sb
    x = x + gb * _B_ref(h, B_w_in, B_w_sp, B_b_sp, B_w_out)
    return x
```

```asm
; @launch kernel=k1prep_kernel grid=(256,1,1) block=(256,1,1) lds=9216
; @launch kernel=k2to7_kernel grid=(256,1,1) block=(512,1,1) lds=163840
.amdgcn_target "amdgcn-amd-amdhsa--gfx950"
.text
.globl k1prep_kernel
.p2align 8
.type k1prep_kernel,@function
k1prep_kernel:
    s_cmp_ge_u32 s2, 256
    s_cbranch_scc1 L_end_1
    s_getpc_b64 s[40:41]
L_pc_2:
    v_lshlrev_b32 v110, 7, v0
    v_min_u32 v110, k2to7_kernel-L_pc_2-4, v110
    global_load_dword v111, v110, s[40:41]
    s_load_dwordx2 s[4:5], s[0:1], 0
    s_mov_b32 s6, 0x280000
    s_mov_b32 s7, 0x20000
    s_load_dwordx2 s[8:9], s[0:1], 64
    s_mov_b32 s10, 0x500
    s_mov_b32 s11, 0x20000
    s_load_dwordx2 s[12:13], s[0:1], 72
    s_mov_b32 s14, 0x4b0000
    s_mov_b32 s15, 0x20000
    s_load_dwordx2 s[16:17], s[0:1], 96
    s_mov_b32 s18, 0x10000000
    s_mov_b32 s19, 0x20000
    s_load_dwordx2 s[32:33], s[0:1], 8
    s_mov_b32 s34, 0x258000
    s_mov_b32 s35, 0x20000
    s_load_dwordx2 s[36:37], s[0:1], 32
    s_mov_b32 s38, 0x21c000
    s_mov_b32 s39, 0x20000
    s_and_b32 s20, s2, 7
    s_lshr_b32 s21, s2, 3
    s_lshl_b32 s20, s20, 5
    s_add_u32 s20, s20, s21
    s_mul_i32 s22, s20, 10240
    v_lshrrev_b32 v4, 5, v0
    v_and_b32 v5, 31, v0
    v_mul_u32_u24 v1, 1280, v4
    v_lshl_add_u32 v1, v5, 4, v1
    v_lshlrev_b32 v8, 9, v5
    v_lshl_add_u32 v8, v4, 4, v8
    v_mov_b32 v20, 0
    v_mov_b32 v21, 0
    v_mov_b32 v22, 0
    v_mov_b32 v23, 0
    s_min_u32 s28, s2, 239
    s_mul_i32 s23, s28, 1093
    s_lshr_b32 s23, s23, 16
    s_mul_i32 s24, s23, 60
    s_sub_u32 s24, s28, s24
    s_mul_i32 s25, s23, 1228800
    s_lshl_b32 s26, s24, 7
    s_add_u32 s25, s25, s26
    s_mul_i32 s27, s23, 320
    v_lshrrev_b32 v4, 3, v0
    v_and_b32 v5, 7, v0
    v_mul_u32_u24 v2, 7680, v4
    v_lshl_add_u32 v2, v5, 4, v2
    v_lshlrev_b32 v3, 1, v4
    v_lshlrev_b32 v9, 8, v4
    v_lshl_add_u32 v9, v5, 4, v9
    s_waitcnt lgkmcnt(0)
    buffer_load_dwordx4 v[12:15], v1, s[4:7], s22 offen
    buffer_load_dwordx4 v[16:19], v1, s[4:7], s22 offen offset:512
    s_mov_b32 exec_lo, 0xffff
    s_mov_b32 exec_hi, 0xffff
    buffer_load_dwordx4 v[20:23], v1, s[4:7], s22 offen offset:1024
    s_mov_b64 exec, -1
    buffer_load_ushort v44, v3, s[8:11], s27 offen offset:0
    buffer_load_ushort v45, v3, s[8:11], s27 offen offset:64
    buffer_load_ushort v46, v3, s[8:11], s27 offen offset:128
    buffer_load_ushort v47, v3, s[8:11], s27 offen offset:192
    buffer_load_ushort v48, v3, s[8:11], s27 offen offset:256
    s_cmp_ge_u32 s2, 240
    s_cbranch_scc1 L_wm_3
    buffer_load_dwordx4 v[24:27], v2, s[12:15], s25 offen
    s_add_u32 s25, s25, 245760
    buffer_load_dwordx4 v[28:31], v2, s[12:15], s25 offen
    s_add_u32 s25, s25, 245760
    buffer_load_dwordx4 v[32:35], v2, s[12:15], s25 offen
    s_add_u32 s25, s25, 245760
    buffer_load_dwordx4 v[36:39], v2, s[12:15], s25 offen
    s_add_u32 s25, s25, 245760
    buffer_load_dwordx4 v[40:43], v2, s[12:15], s25 offen
L_wm2_4:
    v_min_u32 v105, 75, v0
    s_mul_i32 s40, s2, 75
    v_add_lshl_u32 v104, v105, s40, 7
    buffer_load_dword v106, v104, s[32:35], 0 offen
    v_sub_u32 v105, 255, v0
    v_min_u32 v105, 67, v105
    s_mul_i32 s40, s2, 68
    v_add_lshl_u32 v104, v105, s40, 7
    buffer_load_dword v107, v104, s[36:39], 0 offen
    s_mov_b32 s29, 0x3f803f80
    s_waitcnt vmcnt(14)
    v_dot2_f32_bf16 v6, v12, s29, 0
    v_dot2_f32_bf16 v7, v13, s29, 0
    v_dot2_f32_bf16 v6, v14, s29, v6
    v_dot2_f32_bf16 v7, v15, s29, v7
    s_waitcnt vmcnt(13)
    v_dot2_f32_bf16 v6, v16, s29, v6
    v_dot2_f32_bf16 v7, v17, s29, v7
    v_dot2_f32_bf16 v6, v18, s29, v6
    v_dot2_f32_bf16 v7, v19, s29, v7
    s_waitcnt vmcnt(12)
    v_dot2_f32_bf16 v6, v20, s29, v6
    v_dot2_f32_bf16 v7, v21, s29, v7
    v_dot2_f32_bf16 v6, v22, s29, v6
    v_dot2_f32_bf16 v7, v23, s29, v7
    s_nop 2
    v_add_f32 v6, v6, v7
    s_nop 1
    v_add_f32_dpp v6, v6, v6 row_ror:8 row_mask:0xf bank_mask:0xf
    s_nop 1
    v_add_f32_dpp v6, v6, v6 row_ror:4 row_mask:0xf bank_mask:0xf
    s_nop 1
    v_add_f32_dpp v6, v6, v6 row_ror:2 row_mask:0xf bank_mask:0xf
    s_nop 1
    v_add_f32_dpp v6, v6, v6 row_ror:1 row_mask:0xf bank_mask:0xf
    v_mov_b32 v4, v6
    s_nop 1
    v_permlane16_swap_b32 v6, v4
    v_add_f32 v6, v6, v4
    v_mul_f32 v6, 0x3acccccd, v6
    v_mov_b32 v7, 0
    v_lshlrev_b32 v60, 16, v12
    v_and_b32 v61, 0xffff0000, v12
    v_sub_f32 v60, v60, v6
    v_sub_f32 v61, v61, v6
    v_fmac_f32 v7, v60, v60
    v_fmac_f32 v7, v61, v61
    v_lshlrev_b32 v62, 16, v13
    v_and_b32 v63, 0xffff0000, v13
    v_sub_f32 v62, v62, v6
    v_sub_f32 v63, v63, v6
    v_fmac_f32 v7, v62, v62
    v_fmac_f32 v7, v63, v63
    v_lshlrev_b32 v64, 16, v14
    v_and_b32 v65, 0xffff0000, v14
    v_sub_f32 v64, v64, v6
    v_sub_f32 v65, v65, v6
    v_fmac_f32 v7, v64, v64
    v_fmac_f32 v7, v65, v65
    v_lshlrev_b32 v66, 16, v15
    v_and_b32 v67, 0xffff0000, v15
    v_sub_f32 v66, v66, v6
    v_sub_f32 v67, v67, v6
    v_fmac_f32 v7, v66, v66
    v_fmac_f32 v7, v67, v67
    v_lshlrev_b32 v68, 16, v16
    v_and_b32 v69, 0xffff0000, v16
    v_sub_f32 v68, v68, v6
    v_sub_f32 v69, v69, v6
    v_fmac_f32 v7, v68, v68
    v_fmac_f32 v7, v69, v69
    v_lshlrev_b32 v70, 16, v17
    v_and_b32 v71, 0xffff0000, v17
    v_sub_f32 v70, v70, v6
    v_sub_f32 v71, v71, v6
    v_fmac_f32 v7, v70, v70
    v_fmac_f32 v7, v71, v71
    v_lshlrev_b32 v72, 16, v18
    v_and_b32 v73, 0xffff0000, v18
    v_sub_f32 v72, v72, v6
    v_sub_f32 v73, v73, v6
    v_fmac_f32 v7, v72, v72
    v_fmac_f32 v7, v73, v73
    v_lshlrev_b32 v74, 16, v19
    v_and_b32 v75, 0xffff0000, v19
    v_sub_f32 v74, v74, v6
    v_sub_f32 v75, v75, v6
    v_fmac_f32 v7, v74, v74
    v_fmac_f32 v7, v75, v75
    s_mov_b32 exec_lo, 0xffff
    s_mov_b32 exec_hi, 0xffff
    v_lshlrev_b32 v76, 16, v20
    v_and_b32 v77, 0xffff0000, v20
    v_sub_f32 v76, v76, v6
    v_sub_f32 v77, v77, v6
    v_fmac_f32 v7, v76, v76
    v_fmac_f32 v7, v77, v77
    v_lshlrev_b32 v78, 16, v21
    v_and_b32 v79, 0xffff0000, v21
    v_sub_f32 v78, v78, v6
    v_sub_f32 v79, v79, v6
    v_fmac_f32 v7, v78, v78
    v_fmac_f32 v7, v79, v79
    v_lshlrev_b32 v80, 16, v22
    v_and_b32 v81, 0xffff0000, v22
    v_sub_f32 v80, v80, v6
    v_sub_f32 v81, v81, v6
    v_fmac_f32 v7, v80, v80
    v_fmac_f32 v7, v81, v81
    v_lshlrev_b32 v82, 16, v23
    v_and_b32 v83, 0xffff0000, v23
    v_sub_f32 v82, v82, v6
    v_sub_f32 v83, v83, v6
    v_fmac_f32 v7, v82, v82
    v_fmac_f32 v7, v83, v83
    s_mov_b64 exec, -1
    s_nop 0
    v_add_f32_dpp v7, v7, v7 row_ror:8 row_mask:0xf bank_mask:0xf
    s_nop 1
    v_add_f32_dpp v7, v7, v7 row_ror:4 row_mask:0xf bank_mask:0xf
    s_nop 1
    v_add_f32_dpp v7, v7, v7 row_ror:2 row_mask:0xf bank_mask:0xf
    s_nop 1
    v_add_f32_dpp v7, v7, v7 row_ror:1 row_mask:0xf bank_mask:0xf
    v_mov_b32 v4, v7
    s_nop 1
    v_permlane16_swap_b32 v7, v4
    v_add_f32 v7, v7, v4
    v_mov_b32 v4, 0x3727c5ac
    v_fmac_f32 v4, 0x3acccccd, v7
    v_rsq_f32 v4, v4
    s_lshr_b32 s30, s20, 2
    s_mul_i32 s30, s30, 40960
    s_and_b32 s31, s20, 3
    s_lshl_b32 s31, s31, 7
    s_add_u32 s30, s30, s31
    s_add_u32 s30, s30, 0x100000
    v_mul_f32 v60, v60, v4
    v_mul_f32 v61, v61, v4
    v_cvt_pk_f16_f32 v12, v60, v61
    v_and_b32 v12, -2, v12
    v_mul_f32 v62, v62, v4
    v_mul_f32 v63, v63, v4
    v_cvt_pk_f16_f32 v13, v62, v63
    v_mul_f32 v64, v64, v4
    v_mul_f32 v65, v65, v4
    v_cvt_pk_f16_f32 v14, v64, v65
    v_and_b32 v14, -2, v14
    v_mul_f32 v66, v66, v4
    v_mul_f32 v67, v67, v4
    v_cvt_pk_f16_f32 v15, v66, v67
    buffer_store_dwordx4 v[12:15], v8, s[16:19], s30 offen
    s_add_u32 s30, s30, 16384
    v_mul_f32 v68, v68, v4
    v_mul_f32 v69, v69, v4
    v_cvt_pk_f16_f32 v16, v68, v69
    v_and_b32 v16, -2, v16
    v_mul_f32 v70, v70, v4
    v_mul_f32 v71, v71, v4
    v_cvt_pk_f16_f32 v17, v70, v71
    v_mul_f32 v72, v72, v4
    v_mul_f32 v73, v73, v4
    v_cvt_pk_f16_f32 v18, v72, v73
    v_and_b32 v18, -2, v18
    v_mul_f32 v74, v74, v4
    v_mul_f32 v75, v75, v4
    v_cvt_pk_f16_f32 v19, v74, v75
    buffer_store_dwordx4 v[16:19], v8, s[16:19], s30 offen
    s_add_u32 s30, s30, 16384
    s_mov_b32 exec_lo, 0xffff
    s_mov_b32 exec_hi, 0xffff
    v_mul_f32 v76, v76, v4
    v_mul_f32 v77, v77, v4
    v_cvt_pk_f16_f32 v20, v76, v77
    v_and_b32 v20, -2, v20
    v_mul_f32 v78, v78, v4
    v_mul_f32 v79, v79, v4
    v_cvt_pk_f16_f32 v21, v78, v79
    v_mul_f32 v80, v80, v4
    v_mul_f32 v81, v81, v4
    v_cvt_pk_f16_f32 v22, v80, v81
    v_and_b32 v22, -2, v22
    v_mul_f32 v82, v82, v4
    v_mul_f32 v83, v83, v4
    v_cvt_pk_f16_f32 v23, v82, v83
    buffer_store_dwordx4 v[20:23], v8, s[16:19], s30 offen
    s_mov_b64 exec, -1
    s_cmp_ge_u32 s2, 240
    s_cbranch_scc1 L_misc_6
    s_waitcnt vmcnt(14)
    v_lshlrev_b32 v44, 16, v44
    v_mul_f32 v4, 0xbfb8aa3b, v44
    v_exp_f32 v4, v4
    s_nop 0
    v_add_f32 v4, 1.0, v4
    v_rcp_f32 v4, v4
    s_nop 0
    v_mul_f32 v4, v4, v44
    v_cvt_pk_bf16_f32 v84, v4, 0
    v_lshlrev_b32 v85, 16, v84
    s_waitcnt vmcnt(9)
    v_dot2_f32_bf16 v52, v24, v84, 0
    v_dot2_f32_bf16 v53, v24, v85, 0
    v_dot2_f32_bf16 v54, v25, v84, 0
    v_dot2_f32_bf16 v55, v25, v85, 0
    v_dot2_f32_bf16 v56, v26, v84, 0
    v_dot2_f32_bf16 v57, v26, v85, 0
    v_dot2_f32_bf16 v58, v27, v84, 0
    v_dot2_f32_bf16 v59, v27, v85, 0
    v_lshlrev_b32 v45, 16, v45
    v_mul_f32 v4, 0xbfb8aa3b, v45
    v_exp_f32 v4, v4
    s_nop 0
    v_add_f32 v4, 1.0, v4
    v_rcp_f32 v4, v4
    s_nop 0
    v_mul_f32 v4, v4, v45
    v_cvt_pk_bf16_f32 v84, v4, 0
    v_lshlrev_b32 v85, 16, v84
    s_waitcnt vmcnt(8)
    v_dot2_f32_bf16 v52, v28, v84, v52
    v_dot2_f32_bf16 v53, v28, v85, v53
    v_dot2_f32_bf16 v54, v29, v84, v54
    v_dot2_f32_bf16 v55, v29, v85, v55
    v_dot2_f32_bf16 v56, v30, v84, v56
    v_dot2_f32_bf16 v57, v30, v85, v57
    v_dot2_f32_bf16 v58, v31, v84, v58
    v_dot2_f32_bf16 v59, v31, v85, v59
    v_lshlrev_b32 v46, 16, v46
    v_mul_f32 v4, 0xbfb8aa3b, v46
    v_exp_f32 v4, v4
    s_nop 0
    v_add_f32 v4, 1.0, v4
    v_rcp_f32 v4, v4
    s_nop 0
    v_mul_f32 v4, v4, v46
    v_cvt_pk_bf16_f32 v84, v4, 0
    v_lshlrev_b32 v85, 16, v84
    s_waitcnt vmcnt(7)
    v_dot2_f32_bf16 v52, v32, v84, v52
    v_dot2_f32_bf16 v53, v32, v85, v53
    v_dot2_f32_bf16 v54, v33, v84, v54
    v_dot2_f32_bf16 v55, v33, v85, v55
    v_dot2_f32_bf16 v56, v34, v84, v56
    v_dot2_f32_bf16 v57, v34, v85, v57
    v_dot2_f32_bf16 v58, v35, v84, v58
    v_dot2_f32_bf16 v59, v35, v85, v59
    v_lshlrev_b32 v47, 16, v47
    v_mul_f32 v4, 0xbfb8aa3b, v47
    v_exp_f32 v4, v4
    s_nop 0
    v_add_f32 v4, 1.0, v4
    v_rcp_f32 v4, v4
    s_nop 0
    v_mul_f32 v4, v4, v47
    v_cvt_pk_bf16_f32 v84, v4, 0
    v_lshlrev_b32 v85, 16, v84
    s_waitcnt vmcnt(6)
    v_dot2_f32_bf16 v52, v36, v84, v52
    v_dot2_f32_bf16 v53, v36, v85, v53
    v_dot2_f32_bf16 v54, v37, v84, v54
    v_dot2_f32_bf16 v55, v37, v85, v55
    v_dot2_f32_bf16 v56, v38, v84, v56
    v_dot2_f32_bf16 v57, v38, v85, v57
    v_dot2_f32_bf16 v58, v39, v84, v58
    v_dot2_f32_bf16 v59, v39, v85, v59
    v_lshlrev_b32 v48, 16, v48
    v_mul_f32 v4, 0xbfb8aa3b, v48
    v_exp_f32 v4, v4
    s_nop 0
    v_add_f32 v4, 1.0, v4
    v_rcp_f32 v4, v4
    s_nop 0
    v_mul_f32 v4, v4, v48
    v_cvt_pk_bf16_f32 v84, v4, 0
    v_lshlrev_b32 v85, 16, v84
    s_waitcnt vmcnt(5)
    v_dot2_f32_bf16 v52, v40, v84, v52
    v_dot2_f32_bf16 v53, v40, v85, v53
    v_dot2_f32_bf16 v54, v41, v84, v54
    v_dot2_f32_bf16 v55, v41, v85, v55
    v_dot2_f32_bf16 v56, v42, v84, v56
    v_dot2_f32_bf16 v57, v42, v85, v57
    v_dot2_f32_bf16 v58, v43, v84, v58
    v_dot2_f32_bf16 v59, v43, v85, v59
    ds_write_b128 v9, v[52:55]
    s_nop 1
    ds_write_b128 v9, v[56:59] offset:128
    v_lshrrev_b32 v4, 6, v0
    v_and_b32 v5, 63, v0
    v_lshlrev_b32 v9, 11, v4
    v_lshl_add_u32 v9, v5, 2, v9
    v_lshlrev_b32 v10, 2, v0
    s_waitcnt lgkmcnt(0)
    ds_read_b32 v86, v9 offset:0
    ds_read_b32 v87, v9 offset:256
    ds_read_b32 v88, v9 offset:512
    ds_read_b32 v89, v9 offset:768
    ds_read_b32 v90, v9 offset:1024
    ds_read_b32 v91, v9 offset:1280
    ds_read_b32 v92, v9 offset:1536
    ds_read_b32 v93, v9 offset:1792
    s_waitcnt lgkmcnt(6)
    v_add_f32 v86, v86, v87
    s_waitcnt lgkmcnt(5)
    v_add_f32 v86, v86, v88
    s_waitcnt lgkmcnt(4)
    v_add_f32 v86, v86, v89
    s_waitcnt lgkmcnt(3)
    v_add_f32 v86, v86, v90
    s_waitcnt lgkmcnt(2)
    v_add_f32 v86, v86, v91
    s_waitcnt lgkmcnt(1)
    v_add_f32 v86, v86, v92
    s_waitcnt lgkmcnt(0)
    v_add_f32 v86, v86, v93
    ds_write_b32 v10, v86 offset:8192
    v_lshlrev_b32 v9, 2, v5
    v_bfe_u32 v4, v5, 2, 3
    v_lshlrev_b32 v4, 3, v4
    v_lshrrev_b32 v10, 5, v5
    v_lshl_add_u32 v4, v10, 2, v4
    v_and_b32 v10, 3, v5
    v_add_lshl_u32 v10, v4, v10, 2
    s_mul_i32 s25, s23, 15360
    s_lshl_b32 s26, s24, 8
    s_add_u32 s25, s25, s26
    s_waitcnt lgkmcnt(0)
    s_barrier
    ds_read_b32 v86, v9 offset:8192
    ds_read_b32 v87, v9 offset:8448
    ds_read_b32 v88, v9 offset:8704
    ds_read_b32 v89, v9 offset:8960
    s_waitcnt lgkmcnt(2)
    v_add_f32 v86, v86, v87
    s_waitcnt lgkmcnt(0)
    v_add_f32 v88, v88, v89
    v_add_f32 v86, v86, v88
    buffer_store_dword v86, v10, s[16:19], s25 offen
    s_endpgm
L_misc_6:
    s_cmp_eq_u32 s2, 240
    s_cbranch_scc0 L_nomod_7
    v_min_u32 v4, 159, v0
    v_lshrrev_b32 v5, 1, v4
    v_and_b32 v4, 1, v4
    v_lshlrev_b32 v9, 9, v5
    v_lshl_add_u32 v9, v4, 4, v9
    s_mov_b32 s25, 0x78007800
    v_mul_lo_u32 v60, s25, v4
    v_mov_b32 v61, v60
    v_mov_b32 v62, v60
    v_mov_b32 v63, v60
    s_mov_b32 s25, 0x380000
    buffer_store_dwordx4 v[60:63], v9, s[16:19], s25 offen
    s_endpgm
L_nomod_7:
    s_cmp_le_u32 s2, 253
    s_cbranch_scc0 L_end_1
    v_lshlrev_b32 v9, 4, v0
    s_cmp_le_u32 s2, 245
    s_cselect_b32 s26, 0, -1
    v_mov_b32 v60, s26
    v_mov_b32 v61, s26
    v_mov_b32 v62, s26
    v_mov_b32 v63, s26
    s_mov_b32 s26, 0x10000
    s_cselect_b32 s26, 0x70000, s26
    s_sub_u32 s25, s2, 242
    s_lshl_b32 s25, s25, 14
    s_add_u32 s25, s25, s26
    s_cmp_eq_u32 s2, 241
    s_cselect_b32 s25, 0x40000, s25
    buffer_store_dwordx4 v[60:63], v9, s[16:19], s25 offen sc0 sc1
    s_add_u32 s25, s25, 4096
    buffer_store_dwordx4 v[60:63], v9, s[16:19], s25 offen sc0 sc1
    s_add_u32 s25, s25, 4096
    buffer_store_dwordx4 v[60:63], v9, s[16:19], s25 offen sc0 sc1
    s_add_u32 s25, s25, 4096
    buffer_store_dwordx4 v[60:63], v9, s[16:19], s25 offen sc0 sc1
    s_endpgm
L_wm_3:
    s_getpc_b64 s[40:41]
L_pc_5:
    s_bfe_u32 s42, s2, 0x10003
    s_lshl_b32 s42, s42, 15
    s_add_u32 s42, s42, k2to7_kernel-L_pc_5
    v_lshl_add_u32 v2, v0, 7, s42
    v_min_u32 v2, L_text_end-L_pc_5-4, v2
    global_load_dword v24, v2, s[40:41]
    buffer_load_dword v25, off, s[8:11], 0
    buffer_load_dword v26, off, s[8:11], 0
    buffer_load_dword v27, off, s[8:11], 0
    buffer_load_dword v28, off, s[8:11], 0
    s_branch L_wm2_4
L_end_1:
    s_endpgm

.globl k2to7_kernel
.p2align 8
.type k2to7_kernel,@function
k2to7_kernel:
    s_cmp_ge_u32 s2, 256
    s_cbranch_scc1 L_end_8
    s_load_dwordx2 s[4:5], s[0:1], 8
    s_mov_b32 s6, 0x258000
    s_mov_b32 s7, 0x20000
    s_load_dwordx2 s[8:9], s[0:1], 96
    s_mov_b32 s10, 0x10000000
    s_mov_b32 s11, 0x20000
    s_load_dwordx2 s[20:21], s[0:1], 32
    s_and_b32 s22, s2, 7
    s_lshr_b32 s23, s2, 3
    s_lshr_b32 s24, s22, 1
    s_lshl_b32 s24, s24, 2
    s_and_b32 s25, s23, 3
    s_add_u32 s24, s24, s25
    s_and_b32 s25, s22, 1
    s_lshl_b32 s25, s25, 3
    s_lshr_b32 s26, s23, 2
    s_add_u32 s25, s25, s26
    v_lshrrev_b32 v224, 6, v0
    s_nop 0
    v_readfirstlane_b32 s12, v224
    s_nop 0
    s_and_b32 s19, s12, 3
    s_lshr_b32 s3, s12, 2
    s_lshl_b32 s26, s25, 8
    s_mul_i32 s27, s24, 216
    s_lshl_b32 s28, s24, 2
    s_add_u32 s28, s28, s19
    s_cmp_eq_u32 s25, 15
    s_mov_b32 s29, 3840
    s_cselect_b32 s13, 3456, s29
    s_cselect_b32 s14, s27, s26
    s_cselect_b32 s28, 64, s28
    s_cselect_b32 s29, 7680, 0
    s_mul_i32 s15, s28, 40960
    s_add_u32 s15, s15, 0x100000
    v_min_u32 v228, 159, v0
    v_lshlrev_b32 v229, 4, v228
    s_mul_i32 s18, s3, 40
    s_add_u32 s18, s18, s19
    s_mul_i32 s18, s18, s13
    s_lshl_b32 s18, s18, 3
    s_add_u32 s14, s14, s18
    s_mul_i32 s18, s3, 20480
    s_add_u32 s15, s15, s18
    s_lshl_b32 s16, s3, 16
    s_lshl_b32 s18, s19, 11
    s_add_u32 s16, s16, s18
    v_and_b32 v224, 63, v0
    v_lshlrev_b32 v218, 4, v224
    v_lshrrev_b32 v225, 4, v224
    v_bfe_u32 v226, v224, 2, 2
    v_xor_b32 v226, v226, v225
    v_and_b32 v227, 3, v224
    v_lshlrev_b32 v227, 4, v227
    v_lshl_add_u32 v227, v226, 6, v227
    v_mad_u32_u24 v216, v225, s13, v227
    s_lshl_b32 s17, s13, 2
    s_sub_u32 s17, s17, 1024
    v_add_u32 v217, s17, v216
    s_lshl_b32 s17, s13, 5
    s_waitcnt lgkmcnt(0)
    s_cmp_eq_u32 s25, 15
    s_cselect_b32 s4, s20, s4
    s_cselect_b32 s5, s21, s5
    s_cselect_b32 s6, 0x21c000, s6
    s_cmp_ge_u32 s12, 3
    s_cbranch_scc1 L_notab_10
    buffer_load_dwordx4 v[40:43], v229, s[8:11], s29 offen
    buffer_load_dwordx4 v[44:47], v229, s[8:11], s29 offen offset:2560
    s_add_u32 s29, s29, 15360
    buffer_load_dwordx4 v[48:51], v229, s[8:11], s29 offen
    buffer_load_dwordx4 v[52:55], v229, s[8:11], s29 offen offset:2560
    s_add_u32 s29, s29, 15360
    buffer_load_dwordx4 v[56:59], v229, s[8:11], s29 offen
    buffer_load_dwordx4 v[60:63], v229, s[8:11], s29 offen offset:2560
    s_add_u32 s29, s29, 15360
    buffer_load_dwordx4 v[64:67], v229, s[8:11], s29 offen
    buffer_load_dwordx4 v[68:71], v229, s[8:11], s29 offen offset:2560
L_notab_10:
    s_add_u32 m0, s16, 0x0
    s_nop 0
    buffer_load_dwordx4 v216, s[4:7], s14 offen offset:0 lds
    buffer_load_dwordx4 v[104:107], v218, s[8:11], s15 offen offset:0
    buffer_load_dwordx4 v217, s[4:7], s14 offen offset:1024 lds
    buffer_load_dwordx4 v[108:111], v218, s[8:11], s15 offen offset:1024
    s_add_u32 s14, s14, s17
    s_add_u32 m0, s16, 0x2000
    s_nop 0
    buffer_load_dwordx4 v216, s[4:7], s14 offen offset:0 lds
    buffer_load_dwordx4 v[112:115], v218, s[8:11], s15 offen offset:2048
    buffer_load_dwordx4 v217, s[4:7], s14 offen offset:1024 lds
    buffer_load_dwordx4 v[116:119], v218, s[8:11], s15 offen offset:3072
    s_add_u32 s14, s14, s17
    s_add_u32 s15, s15, 4096
    s_add_u32 m0, s16, 0x4000
    s_nop 0
    buffer_load_dwordx4 v216, s[4:7], s14 offen offset:0 lds
    buffer_load_dwordx4 v[120:123], v218, s[8:11], s15 offen offset:0
    v_and_b32 v224, 63, v0
    v_bfe_u32 v225, v224, 2, 2
    v_and_b32 v226, 3, v224
    v_lshlrev_b32 v226, 3, v226
    v_bfe_u32 v227, v224, 4, 1
    v_lshl_add_u32 v226, v227, 5, v226
    v_lshl_add_u32 v226, v225, 8, v226
    s_lshl_b32 s18, s3, 16
    v_add_u32 v226, s18, v226
    s_lshl_b32 s18, s3, 1
    v_xor_b32 v225, s18, v225
    v_lshl_add_u32 v226, v225, 6, v226
    v_lshrrev_b32 v224, 5, v224
    s_movk_i32 s18, 2048
    v_mad_u32_u24 v220, v224, s18, v226
    v_xor_b32 v221, 64, v220
    v_xor_b32 v222, 128, v220
    v_xor_b32 v223, 192, v220
    v_bfe_u32 v36, v0, 5, 1
    v_lshlrev_b32 v36, 6, v36
    s_mul_i32 s18, s3, 2560
    s_add_u32 s18, s18, 0x20000
    v_add_u32 v36, s18, v36
    s_mul_i32 s30, s25, 52
    s_lshr_b32 s30, s30, 8
    s_mul_i32 s31, s30, 5
    s_sub_u32 s31, s25, s31
    s_lshl_b32 s31, s31, 1
    s_add_u32 s31, s31, s3
    s_lshl_b32 s31, s31, 6
    v_and_b32 v224, 31, v0
    v_add_u32 v224, s31, v224
    v_bfe_u32 v225, v0, 5, 1
    v_mul_u32_u24 v225, 320, v225
    s_mov_b32 s32, 81600
    s_cmp_eq_u32 s30, 0
    s_cselect_b32 s32, s32, 163520
    v_mul_u32_u24 v226, 3277, v224
    v_lshrrev_b32 v226, 16, v226
    v_lshl_add_u32 v230, v224, 4, v225
    v_mad_u32_u24 v230, v226, s32, v230
    v_add_u32 v224, 32, v224
    v_mul_u32_u24 v226, 3277, v224
    v_lshrrev_b32 v226, 16, v226
    v_lshl_add_u32 v231, v224, 4, v225
    v_mad_u32_u24 v231, v226, s32, v231
    s_mul_i32 s33, s30, 1280
    s_add_u32 s33, s33, 0x27fb00
    s_mul_i32 s34, s28, 1280
    s_add_u32 s33, s33, s34
    s_cmp_eq_u32 s30, 0
    s_cselect_b32 s33, 0, s33
    s_add_u32 s33, s33, s34
    s_add_u32 s33, s33, 0x400000
    s_cmp_eq_u32 s30, 0
    s_cselect_b32 s34, 0x3ea52b5c, 1.0
    s_mov_b32 s35, s34
    s_cselect_b32 s36, 0x10000, 0
    s_cselect_b32 s37, 0xfffe0000, -1
    s_cmp_ge_u32 s12, 3
    s_cbranch_scc1 L_notab2_11
    v_lshrrev_b32 v229, 1, v228
    v_lshlrev_b32 v229, 6, v229
    v_and_b32 v228, 1, v228
    v_lshl_add_u32 v229, v228, 3, v229
    v_add_u32 v229, 0x20000, v229
    s_waitcnt vmcnt(15)
    v_add_f32 v40, v40, v48
    s_waitcnt vmcnt(11)
    v_add_f32 v56, v56, v64
    v_add_f32 v41, v41, v49
    v_add_f32 v57, v57, v65
    v_add_f32 v42, v42, v50
    v_add_f32 v58, v58, v66
    v_add_f32 v43, v43, v51
    v_add_f32 v59, v59, v67
    v_add_f32 v44, v44, v52
    s_waitcnt vmcnt(10)
    v_add_f32 v60, v60, v68
    v_add_f32 v45, v45, v53
    v_add_f32 v61, v61, v69
    v_add_f32 v46, v46, v54
    v_add_f32 v62, v62, v70
    v_add_f32 v47, v47, v55
    v_add_f32 v63, v63, v71
    v_add_f32 v40, v40, v56
    v_add_f32 v41, v41, v57
    v_add_f32 v42, v42, v58
    v_add_f32 v43, v43, v59
    v_add_f32 v44, v44, v60
    v_add_f32 v45, v45, v61
    v_add_f32 v46, v46, v62
    v_add_f32 v47, v47, v63
    v_cvt_pk_bf16_f32 v56, v40, v41
    v_cvt_pk_bf16_f32 v58, v44, v45
    v_cvt_pk_bf16_f32 v57, v42, v43
    v_cvt_pk_bf16_f32 v59, v46, v47
    v_lshlrev_b32 v48, 16, v56
    v_and_b32 v49, 0xffff0000, v56
    v_lshlrev_b32 v44, 16, v58
    v_and_b32 v45, 0xffff0000, v58
    v_lshlrev_b32 v50, 16, v57
    v_and_b32 v51, 0xffff0000, v57
    v_lshlrev_b32 v46, 16, v59
    v_and_b32 v47, 0xffff0000, v59
    v_add_f32 v44, 1.0, v44
    v_add_f32 v45, 1.0, v45
    v_add_f32 v46, 1.0, v46
    v_add_f32 v47, 1.0, v47
    v_cvt_pk_bf16_f32 v58, v44, v45
    v_cvt_pk_bf16_f32 v59, v46, v47
    v_lshlrev_b32 v52, 16, v58
    v_and_b32 v53, 0xffff0000, v58
    v_lshlrev_b32 v54, 16, v59
    v_and_b32 v55, 0xffff0000, v59
    v_cvt_pk_f16_f32 v40, v52, v53
    v_cvt_pk_f16_f32 v42, v48, v49
    v_cvt_pk_f16_f32 v41, v54, v55
    v_cvt_pk_f16_f32 v43, v50, v51
    ds_write_b64 v229, v[40:41]
    ds_write_b64 v229, v[42:43] offset:32
    s_waitcnt lgkmcnt(0)
L_notab2_11:
    s_waitcnt vmcnt(7)
    s_barrier
    ds_read_b64_tr_b16 v[184:185], v220 offset:0
    ds_read_b64_tr_b16 v[186:187], v220 offset:1024
    ds_read_b64_tr_b16 v[188:189], v221 offset:0
    ds_read_b64_tr_b16 v[190:191], v221 offset:1024
    ds_read_b64_tr_b16 v[192:193], v222 offset:0
    ds_read_b64_tr_b16 v[194:195], v222 offset:1024
    ds_read_b64_tr_b16 v[196:197], v223 offset:0
    ds_read_b64_tr_b16 v[198:199], v223 offset:1024
    ds_read_b128 v[4:7], v36 offset:0
    ds_read_b128 v[8:11], v36 offset:32
    s_waitcnt lgkmcnt(0)
    v_fma_mix_f32 v20, v104, v4, v8 op_sel:[0,0,0] op_sel_hi:[1,1,1]
    v_fma_mix_f32 v21, v104, v4, v8 op_sel:[1,1,1] op_sel_hi:[1,1,1]
    v_fma_mix_f32 v22, v105, v5, v9 op_sel:[0,0,0] op_sel_hi:[1,1,1]
    v_fma_mix_f32 v23, v105, v5, v9 op_sel:[1,1,1] op_sel_hi:[1,1,1]
    v_fma_mix_f32 v24, v106, v6, v10 op_sel:[0,0,0] op_sel_hi:[1,1,1]
    v_fma_mix_f32 v25, v106, v6, v10 op_sel:[1,1,1] op_sel_hi:[1,1,1]
    v_fma_mix_f32 v26, v107, v7, v11 op_sel:[0,0,0] op_sel_hi:[1,1,1]
    v_fma_mix_f32 v27, v107, v7, v11 op_sel:[1,1,1] op_sel_hi:[1,1,1]
    v_cvt_pk_bf16_f32 v28, v20, v21
    v_cvt_pk_bf16_f32 v29, v22, v23
    v_cvt_pk_bf16_f32 v30, v24, v25
    v_cvt_pk_bf16_f32 v31, v26, v27
    ds_read_b128 v[4:7], v36 offset:128
    ds_read_b128 v[8:11], v36 offset:160
    v_mfma_f32_32x32x16_bf16 v[40:55], v[28:31], v[184:187], 0
    ds_read_b64_tr_b16 v[200:201], v220 offset:4096
    ds_read_b64_tr_b16 v[202:203], v220 offset:5120
    ds_read_b64_tr_b16 v[204:205], v221 offset:4096
    ds_read_b64_tr_b16 v[206:207], v221 offset:5120
    ds_read_b64_tr_b16 v[208:209], v222 offset:4096
    ds_read_b64_tr_b16 v[210:211], v222 offset:5120
    v_mfma_f32_32x32x16_bf16 v[56:71], v[28:31], v[188:191], 0
    ds_read_b64_tr_b16 v[212:213], v223 offset:4096
    ds_read_b64_tr_b16 v[214:215], v223 offset:5120
    s_waitcnt vmcnt(6) lgkmcnt(8)
    v_fma_mix_f32 v20, v108, v4, v8 op_sel:[0,0,0] op_sel_hi:[1,1,1]
    v_fma_mix_f32 v21, v108, v4, v8 op_sel:[1,1,1] op_sel_hi:[1,1,1]
    v_fma_mix_f32 v22, v109, v5, v9 op_sel:[0,0,0] op_sel_hi:[1,1,1]
    v_fma_mix_f32 v23, v109, v5, v9 op_sel:[1,1,1] op_sel_hi:[1,1,1]
    v_mfma_f32_32x32x16_bf16 v[72:87], v[28:31], v[192:195], 0
    v_fma_mix_f32 v24, v110, v6, v10 op_sel:[0,0,0] op_sel_hi:[1,1,1]
    v_fma_mix_f32 v25, v110, v6, v10 op_sel:[1,1,1] op_sel_hi:[1,1,1]
    v_fma_mix_f32 v26, v111, v7, v11 op_sel:[0,0,0] op_sel_hi:[1,1,1]
    v_fma_mix_f32 v27, v111, v7, v11 op_sel:[1,1,1] op_sel_hi:[1,1,1]
    ds_read_b128 v[4:7], v36 offset:256
    ds_read_b128 v[8:11], v36 offset:288
    v_mfma_f32_32x32x16_bf16 v[88:103], v[28:31], v[196:199], 0
    v_cvt_pk_bf16_f32 v32, v20, v21
    v_cvt_pk_bf16_f32 v33, v22, v23
    v_cvt_pk_bf16_f32 v34, v24, v25
    v_cvt_pk_bf16_f32 v35, v26, v27
    buffer_load_dwordx4 v217, s[4:7], s14 offen offset:1024 lds
    buffer_load_dwordx4 v[124:127], v218, s[8:11], s15 offen offset:1024
    s_add_u32 s14, s14, s17
    s_waitcnt vmcnt(5)
    s_barrier
    s_waitcnt lgkmcnt(8)
    v_mfma_f32_32x32x16_bf16 v[40:55], v[32:35], v[200:203], v[40:55]
    ds_read_b64_tr_b16 v[184:185], v220 offset:8192
    ds_read_b64_tr_b16 v[186:187], v220 offset:9216
    ds_read_b64_tr_b16 v[188:189], v221 offset:8192
    ds_read_b64_tr_b16 v[190:191], v221 offset:9216
    ds_read_b64_tr_b16 v[192:193], v222 offset:8192
    ds_read_b64_tr_b16 v[194:195], v222 offset:9216
    s_waitcnt lgkmcnt(12)
    v_mfma_f32_32x32x16_bf16 v[56:71], v[32:35], v[204:207], v[56:71]
    ds_read_b64_tr_b16 v[196:197], v223 offset:8192
    ds_read_b64_tr_b16 v[198:199], v223 offset:9216
    s_waitcnt lgkmcnt(8)
    v_fma_mix_f32 v20, v112, v4, v8 op_sel:[0,0,0] op_sel_hi:[1,1,1]
    v_fma_mix_f32 v21, v112, v4, v8 op_sel:[1,1,1] op_sel_hi:[1,1,1]
    v_fma_mix_f32 v22, v113, v5, v9 op_sel:[0,0,0] op_sel_hi:[1,1,1]
    v_fma_mix_f32 v23, v113, v5, v9 op_sel:[1,1,1] op_sel_hi:[1,1,1]
    v_mfma_f32_32x32x16_bf16 v[72:87], v[32:35], v[208:211], v[72:87]
    v_fma_mix_f32 v24, v114, v6, v10 op_sel:[0,0,0] op_sel_hi:[1,1,1]
    v_fma_mix_f32 v25, v114, v6, v10 op_sel:[1,1,1] op_sel_hi:[1,1,1]
    v_fma_mix_f32 v26, v115, v7, v11 op_sel:[0,0,0] op_sel_hi:[1,1,1]
    v_fma_mix_f32 v27, v115, v7, v11 op_sel:[1,1,1] op_sel_hi:[1,1,1]
    ds_read_b128 v[4:7], v36 offset:384
    ds_read_b128 v[8:11], v36 offset:416
    v_mfma_f32_32x32x16_bf16 v[88:103], v[32:35], v[212:215], v[88:103]
    v_cvt_pk_bf16_f32 v28, v20, v21
    v_cvt_pk_bf16_f32 v29, v22, v23
    v_cvt_pk_bf16_f32 v30, v24, v25
    v_cvt_pk_bf16_f32 v31, v26, v27
    s_add_u32 m0, s16, 0x6000
    s_nop 0
    buffer_load_dwordx4 v216, s[4:7], s14 offen offset:0 lds
    buffer_load_dwordx4 v[128:131], v218, s[8:11], s15 offen offset:2048
    s_waitcnt lgkmcnt(8)
    v_mfma_f32_32x32x16_bf16 v[40:55], v[28:31], v[184:187], v[40:55]
    ds_read_b64_tr_b16 v[200:201], v220 offset:12288
    ds_read_b64_tr_b16 v[202:203], v220 offset:13312
    ds_read_b64_tr_b16 v[204:205], v221 offset:12288
    ds_read_b64_tr_b16 v[206:207], v221 offset:13312
    ds_read_b64_tr_b16 v[208:209], v222 offset:12288
    ds_read_b64_tr_b16 v[210:211], v222 offset:13312
    s_waitcnt lgkmcnt(12)
    v_mfma_f32_32x32x16_bf16 v[56:71], v[28:31], v[188:191], v[56:71]
    ds_read_b64_tr_b16 v[212:213], v223 offset:12288
    ds_read_b64_tr_b16 v[214:215], v223 offset:13312
    s_waitcnt vmcnt(6) lgkmcnt(8)
    v_fma_mix_f32 v20, v116, v4, v8 op_sel:[0,0,0] op_sel_hi:[1,1,1]
    v_fma_mix_f32 v21, v116, v4, v8 op_sel:[1,1,1] op_sel_hi:[1,1,1]
    v_fma_mix_f32 v22, v117, v5, v9 op_sel:[0,0,0] op_sel_hi:[1,1,1]
    v_fma_mix_f32 v23, v117, v5, v9 op_sel:[1,1,1] op_sel_hi:[1,1,1]
    v_mfma_f32_32x32x16_bf16 v[72:87], v[28:31], v[192:195], v[72:87]
    v_fma_mix_f32 v24, v118, v6, v10 op_sel:[0,0,0] op_sel_hi:[1,1,1]
    v_fma_mix_f32 v25, v118, v6, v10 op_sel:[1,1,1] op_sel_hi:[1,1,1]
    v_fma_mix_f32 v26, v119, v7, v11 op_sel:[0,0,0] op_sel_hi:[1,1,1]
    v_fma_mix_f32 v27, v119, v7, v11 op_sel:[1,1,1] op_sel_hi:[1,1,1]
    ds_read_b128 v[4:7], v36 offset:512
    ds_read_b128 v[8:11], v36 offset:544
    v_mfma_f32_32x32x16_bf16 v[88:103], v[28:31], v[196:199], v[88:103]
    v_cvt_pk_bf16_f32 v32, v20, v21
    v_cvt_pk_bf16_f32 v33, v22, v23
    v_cvt_pk_bf16_f32 v34, v24, v25
    v_cvt_pk_bf16_f32 v35, v26, v27
    buffer_load_dwordx4 v217, s[4:7], s14 offen offset:1024 lds
    buffer_load_dwordx4 v[132:135], v218, s[8:11], s15 offen offset:3072
    s_add_u32 s14, s14, s17
    s_add_u32 s15, s15, 4096
    s_waitcnt vmcnt(5)
    s_barrier
    s_waitcnt lgkmcnt(8)
    v_mfma_f32_32x32x16_bf16 v[40:55], v[32:35], v[200:203], v[40:55]
    ds_read_b64_tr_b16 v[184:185], v220 offset:16384
    ds_read_b64_tr_b16 v[186:187], v220 offset:17408
    ds_read_b64_tr_b16 v[188:189], v221 offset:16384
    ds_read_b64_tr_b16 v[190:191], v221 offset:17408
    ds_read_b64_tr_b16 v[192:193], v222 offset:16384
    ds_read_b64_tr_b16 v[194:195], v222 offset:17408
    s_waitcnt lgkmcnt(12)
    v_mfma_f32_32x32x16_bf16 v[56:71], v[32:35], v[204:207], v[56:71]
    ds_read_b64_tr_b16 v[196:197], v223 offset:16384
    ds_read_b64_tr_b16 v[198:199], v223 offset:17408
    s_waitcnt lgkmcnt(8)
    v_fma_mix_f32 v20, v120, v4, v8 op_sel:[0,0,0] op_sel_hi:[1,1,1]
    v_fma_mix_f32 v21, v120, v4, v8 op_sel:[1,1,1] op_sel_hi:[1,1,1]
    v_fma_mix_f32 v22, v121, v5, v9 op_sel:[0,0,0] op_sel_hi:[1,1,1]
    v_fma_mix_f32 v23, v121, v5, v9 op_sel:[1,1,1] op_sel_hi:[1,1,1]
    v_mfma_f32_32x32x16_bf16 v[72:87], v[32:35], v[208:211], v[72:87]
    v_fma_mix_f32 v24, v122, v6, v10 op_sel:[0,0,0] op_sel_hi:[1,1,1]
    v_fma_mix_f32 v25, v122, v6, v10 op_sel:[1,1,1] op_sel_hi:[1,1,1]
    v_fma_mix_f32 v26, v123, v7, v11 op_sel:[0,0,0] op_sel_hi:[1,1,1]
    v_fma_mix_f32 v27, v123, v7, v11 op_sel:[1,1,1] op_sel_hi:[1,1,1]
    ds_read_b128 v[4:7], v36 offset:640
    ds_read_b128 v[8:11], v36 offset:672
    v_mfma_f32_32x32x16_bf16 v[88:103], v[32:35], v[212:215], v[88:103]
    v_cvt_pk_bf16_f32 v28, v20, v21
    v_cvt_pk_bf16_f32 v29, v22, v23
    v_cvt_pk_bf16_f32 v30, v24, v25
    v_cvt_pk_bf16_f32 v31, v26, v27
    s_add_u32 m0, s16, 0x8000
    s_nop 0
    buffer_load_dwordx4 v216, s[4:7], s14 offen offset:0 lds
    buffer_load_dwordx4 v[136:139], v218, s[8:11], s15 offen offset:0
    s_waitcnt lgkmcnt(8)
    v_mfma_f32_32x32x16_bf16 v[40:55], v[28:31], v[184:187], v[40:55]
    ds_read_b64_tr_b16 v[200:201], v220 offset:20480
    ds_read_b64_tr_b16 v[202:203], v220 offset:21504
    ds_read_b64_tr_b16 v[204:205], v221 offset:20480
    ds_read_b64_tr_b16 v[206:207], v221 offset:21504
    ds_read_b64_tr_b16 v[208:209], v222 offset:20480
    ds_read_b64_tr_b16 v[210:211], v222 offset:21504
    s_waitcnt lgkmcnt(12)
    v_mfma_f32_32x32x16_bf16 v[56:71], v[28:31], v[188:191], v[56:71]
    ds_read_b64_tr_b16 v[212:213], v223 offset:20480
    ds_read_b64_tr_b16 v[214:215], v223 offset:21504
    s_waitcnt vmcnt(6) lgkmcnt(8)
    v_fma_mix_f32 v20, v124, v4, v8 op_sel:[0,0,0] op_sel_hi:[1,1,1]
    v_fma_mix_f32 v21, v124, v4, v8 op_sel:[1,1,1] op_sel_hi:[1,1,1]
    v_fma_mix_f32 v22, v125, v5, v9 op_sel:[0,0,0] op_sel_hi:[1,1,1]
    v_fma_mix_f32 v23, v125, v5, v9 op_sel:[1,1,1] op_sel_hi:[1,1,1]
    v_mfma_f32_32x32x16_bf16 v[72:87], v[28:31], v[192:195], v[72:87]
    v_fma_mix_f32 v24, v126, v6, v10 op_sel:[0,0,0] op_sel_hi:[1,1,1]
    v_fma_mix_f32 v25, v126, v6, v10 op_sel:[1,1,1] op_sel_hi:[1,1,1]
    v_fma_mix_f32 v26, v127, v7, v11 op_sel:[0,0,0] op_sel_hi:[1,1,1]
    v_fma_mix_f32 v27, v127, v7, v11 op_sel:[1,1,1] op_sel_hi:[1,1,1]
    ds_read_b128 v[4:7], v36 offset:768
    ds_read_b128 v[8:11], v36 offset:800
    v_mfma_f32_32x32x16_bf16 v[88:103], v[28:31], v[196:199], v[88:103]
    v_cvt_pk_bf16_f32 v32, v20, v21
    v_cvt_pk_bf16_f32 v33, v22, v23
    v_cvt_pk_bf16_f32 v34, v24, v25
    v_cvt_pk_bf16_f32 v35, v26, v27
    buffer_load_dwordx4 v217, s[4:7], s14 offen offset:1024 lds
    buffer_load_dwordx4 v[140:143], v218, s[8:11], s15 offen offset:1024
    s_add_u32 s14, s14, s17
    s_waitcnt vmcnt(5)
    s_barrier
    s_waitcnt lgkmcnt(8)
    v_mfma_f32_32x32x16_bf16 v[40:55], v[32:35], v[200:203], v[40:55]
    ds_read_b64_tr_b16 v[184:185], v220 offset:24576
    ds_read_b64_tr_b16 v[186:187], v220 offset:25600
    ds_read_b64_tr_b16 v[188:189], v221 offset:24576
    ds_read_b64_tr_b16 v[190:191], v221 offset:25600
    ds_read_b64_tr_b16 v[192:193], v222 offset:24576
    ds_read_b64_tr_b16 v[194:195], v222 offset:25600
    s_waitcnt lgkmcnt(12)
    v_mfma_f32_32x32x16_bf16 v[56:71], v[32:35], v[204:207], v[56:71]
    ds_read_b64_tr_b16 v[196:197], v223 offset:24576
    ds_read_b64_tr_b16 v[198:199], v223 offset:25600
    s_waitcnt lgkmcnt(8)
    v_fma_mix_f32 v20, v128, v4, v8 op_sel:[0,0,0] op_sel_hi:[1,1,1]
    v_fma_mix_f32 v21, v128, v4, v8 op_sel:[1,1,1] op_sel_hi:[1,1,1]
    v_fma_mix_f32 v22, v129, v5, v9 op_sel:[0,0,0] op_sel_hi:[1,1,1]
    v_fma_mix_f32 v23, v129, v5, v9 op_sel:[1,1,1] op_sel_hi:[1,1,1]
    v_mfma_f32_32x32x16_bf16 v[72:87], v[32:35], v[208:211], v[72:87]
    v_fma_mix_f32 v24, v130, v6, v10 op_sel:[0,0,0] op_sel_hi:[1,1,1]
    v_fma_mix_f32 v25, v130, v6, v10 op_sel:[1,1,1] op_sel_hi:[1,1,1]
    v_fma_mix_f32 v26, v131, v7, v11 op_sel:[0,0,0] op_sel_hi:[1,1,1]
    v_fma_mix_f32 v27, v131, v7, v11 op_sel:[1,1,1] op_sel_hi:[1,1,1]
    ds_read_b128 v[4:7], v36 offset:896
    ds_read_b128 v[8:11], v36 offset:928
    v_mfma_f32_32x32x16_bf16 v[88:103], v[32:35], v[212:215], v[88:103]
    v_cvt_pk_bf16_f32 v28, v20, v21
    v_cvt_pk_bf16_f32 v29, v22, v23
    v_cvt_pk_bf16_f32 v30, v24, v25
    v_cvt_pk_bf16_f32 v31, v26, v27
    s_add_u32 m0, s16, 0xa000
    s_nop 0
    buffer_load_dwordx4 v216, s[4:7], s14 offen offset:0 lds
    buffer_load_dwordx4 v[144:147], v218, s[8:11], s15 offen offset:2048
    s_waitcnt lgkmcnt(8)
    v_mfma_f32_32x32x16_bf16 v[40:55], v[28:31], v[184:187], v[40:55]
    ds_read_b64_tr_b16 v[200:201], v220 offset:28672
    ds_read_b64_tr_b16 v[202:203], v220 offset:29696
    ds_read_b64_tr_b16 v[204:205], v221 offset:28672
    ds_read_b64_tr_b16 v[206:207], v221 offset:29696
    ds_read_b64_tr_b16 v[208:209], v222 offset:28672
    ds_read_b64_tr_b16 v[210:211], v222 offset:29696
    s_waitcnt lgkmcnt(12)
    v_mfma_f32_32x32x16_bf16 v[56:71], v[28:31], v[188:191], v[56:71]
    ds_read_b64_tr_b16 v[212:213], v223 offset:28672
    ds_read_b64_tr_b16 v[214:215], v223 offset:29696
    s_waitcnt vmcnt(6) lgkmcnt(8)
    v_fma_mix_f32 v20, v132, v4, v8 op_sel:[0,0,0] op_sel_hi:[1,1,1]
    v_fma_mix_f32 v21, v132, v4, v8 op_sel:[1,1,1] op_sel_hi:[1,1,1]
    v_fma_mix_f32 v22, v133, v5, v9 op_sel:[0,0,0] op_sel_hi:[1,1,1]
    v_fma_mix_f32 v23, v133, v5, v9 op_sel:[1,1,1] op_sel_hi:[1,1,1]
    v_mfma_f32_32x32x16_bf16 v[72:87], v[28:31], v[192:195], v[72:87]
    v_fma_mix_f32 v24, v134, v6, v10 op_sel:[0,0,0] op_sel_hi:[1,1,1]
    v_fma_mix_f32 v25, v134, v6, v10 op_sel:[1,1,1] op_sel_hi:[1,1,1]
    v_fma_mix_f32 v26, v135, v7, v11 op_sel:[0,0,0] op_sel_hi:[1,1,1]
    v_fma_mix_f32 v27, v135, v7, v11 op_sel:[1,1,1] op_sel_hi:[1,1,1]
    ds_read_b128 v[4:7], v36 offset:1024
    ds_read_b128 v[8:11], v36 offset:1056
    v_mfma_f32_32x32x16_bf16 v[88:103], v[28:31], v[196:199], v[88:103]
    v_cvt_pk_bf16_f32 v32, v20, v21
    v_cvt_pk_bf16_f32 v33, v22, v23
    v_cvt_pk_bf16_f32 v34, v24, v25
    v_cvt_pk_bf16_f32 v35, v26, v27
    buffer_load_dwordx4 v217, s[4:7], s14 offen offset:1024 lds
    buffer_load_dwordx4 v[148:151], v218, s[8:11], s15 offen offset:3072
    s_add_u32 s14, s14, s17
    s_add_u32 s15, s15, 4096
    s_waitcnt vmcnt(5)
    s_barrier
    s_waitcnt lgkmcnt(8)
    v_mfma_f32_32x32x16_bf16 v[40:55], v[32:35], v[200:203], v[40:55]
    ds_read_b64_tr_b16 v[184:185], v220 offset:32768
    ds_read_b64_tr_b16 v[186:187], v220 offset:33792
    ds_read_b64_tr_b16 v[188:189], v221 offset:32768
    ds_read_b64_tr_b16 v[190:191], v221 offset:33792
    ds_read_b64_tr_b16 v[192:193], v222 offset:32768
    ds_read_b64_tr_b16 v[194:195], v222 offset:33792
    s_waitcnt lgkmcnt(12)
    v_mfma_f32_32x32x16_bf16 v[56:71], v[32:35], v[204:207], v[56:71]
    ds_read_b64_tr_b16 v[196:197], v223 offset:32768
    ds_read_b64_tr_b16 v[198:199], v223 offset:33792
    s_waitcnt lgkmcnt(8)
    v_fma_mix_f32 v20, v136, v4, v8 op_sel:[0,0,0] op_sel_hi:[1,1,1]
    v_fma_mix_f32 v21, v136, v4, v8 op_sel:[1,1,1] op_sel_hi:[1,1,1]
    v_fma_mix_f32 v22, v137, v5, v9 op_sel:[0,0,0] op_sel_hi:[1,1,1]
    v_fma_mix_f32 v23, v137, v5, v9 op_sel:[1,1,1] op_sel_hi:[1,1,1]
    v_mfma_f32_32x32x16_bf16 v[72:87], v[32:35], v[208:211], v[72:87]
    v_fma_mix_f32 v24, v138, v6, v10 op_sel:[0,0,0] op_sel_hi:[1,1,1]
    v_fma_mix_f32 v25, v138, v6, v10 op_sel:[1,1,1] op_sel_hi:[1,1,1]
    v_fma_mix_f32 v26, v139, v7, v11 op_sel:[0,0,0] op_sel_hi:[1,1,1]
    v_fma_mix_f32 v27, v139, v7, v11 op_sel:[1,1,1] op_sel_hi:[1,1,1]
    ds_read_b128 v[4:7], v36 offset:1152
    ds_read_b128 v[8:11], v36 offset:1184
    v_mfma_f32_32x32x16_bf16 v[88:103], v[32:35], v[212:215], v[88:103]
    v_cvt_pk_bf16_f32 v28, v20, v21
    v_cvt_pk_bf16_f32 v29, v22, v23
    v_cvt_pk_bf16_f32 v30, v24, v25
    v_cvt_pk_bf16_f32 v31, v26, v27
    s_add_u32 m0, s16, 0xc000
    s_nop 0
    buffer_load_dwordx4 v216, s[4:7], s14 offen offset:0 lds
    buffer_load_dwordx4 v[152:155], v218, s[8:11], s15 offen offset:0
    s_waitcnt lgkmcnt(8)
    v_mfma_f32_32x32x16_bf16 v[40:55], v[28:31], v[184:187], v[40:55]
    ds_read_b64_tr_b16 v[200:201], v220 offset:36864
    ds_read_b64_tr_b16 v[202:203], v220 offset:37888
    ds_read_b64_tr_b16 v[204:205], v221 offset:36864
    ds_read_b64_tr_b16 v[206:207], v221 offset:37888
    ds_read_b64_tr_b16 v[208:209], v222 offset:36864
    ds_read_b64_tr_b16 v[210:211], v222 offset:37888
    s_waitcnt lgkmcnt(12)
    v_mfma_f32_32x32x16_bf16 v[56:71], v[28:31], v[188:191], v[56:71]
    ds_read_b64_tr_b16 v[212:213], v223 offset:36864
    ds_read_b64_tr_b16 v[214:215], v223 offset:37888
    s_waitcnt vmcnt(6) lgkmcnt(8)
    v_fma_mix_f32 v20, v140, v4, v8 op_sel:[0,0,0] op_sel_hi:[1,1,1]
    v_fma_mix_f32 v21, v140, v4, v8 op_sel:[1,1,1] op_sel_hi:[1,1,1]
    v_fma_mix_f32 v22, v141, v5, v9 op_sel:[0,0,0] op_sel_hi:[1,1,1]
    v_fma_mix_f32 v23, v141, v5, v9 op_sel:[1,1,1] op_sel_hi:[1,1,1]
    v_mfma_f32_32x32x16_bf16 v[72:87], v[28:31], v[192:195], v[72:87]
    v_fma_mix_f32 v24, v142, v6, v10 op_sel:[0,0,0] op_sel_hi:[1,1,1]
    v_fma_mix_f32 v25, v142, v6, v10 op_sel:[1,1,1] op_sel_hi:[1,1,1]
    v_fma_mix_f32 v26, v143, v7, v11 op_sel:[0,0,0] op_sel_hi:[1,1,1]
    v_fma_mix_f32 v27, v143, v7, v11 op_sel:[1,1,1] op_sel_hi:[1,1,1]
    ds_read_b128 v[4:7], v36 offset:1280
    ds_read_b128 v[8:11], v36 offset:1312
    v_mfma_f32_32x32x16_bf16 v[88:103], v[28:31], v[196:199], v[88:103]
    v_cvt_pk_bf16_f32 v32, v20, v21
    v_cvt_pk_bf16_f32 v33, v22, v23
    v_cvt_pk_bf16_f32 v34, v24, v25
    v_cvt_pk_bf16_f32 v35, v26, v27
    buffer_load_dwordx4 v217, s[4:7], s14 offen offset:1024 lds
    buffer_load_dwordx4 v[156:159], v218, s[8:11], s15 offen offset:1024
    s_add_u32 s14, s14, s17
    s_waitcnt vmcnt(5)
    s_barrier
    s_waitcnt lgkmcnt(8)
    v_mfma_f32_32x32x16_bf16 v[40:55], v[32:35], v[200:203], v[40:55]
    ds_read_b64_tr_b16 v[184:185], v220 offset:40960
    ds_read_b64_tr_b16 v[186:187], v220 offset:41984
    ds_read_b64_tr_b16 v[188:189], v221 offset:40960
    ds_read_b64_tr_b16 v[190:191], v221 offset:41984
    ds_read_b64_tr_b16 v[192:193], v222 offset:40960
    ds_read_b64_tr_b16 v[194:195], v222 offset:41984
    s_waitcnt lgkmcnt(12)
    v_mfma_f32_32x32x16_bf16 v[56:71], v[32:35], v[204:207], v[56:71]
    ds_read_b64_tr_b16 v[196:197], v223 offset:40960
    ds_read_b64_tr_b16 v[198:199], v223 offset:41984
    s_waitcnt lgkmcnt(8)
    v_fma_mix_f32 v20, v144, v4, v8 op_sel:[0,0,0] op_sel_hi:[1,1,1]
    v_fma_mix_f32 v21, v144, v4, v8 op_sel:[1,1,1] op_sel_hi:[1,1,1]
    v_fma_mix_f32 v22, v145, v5, v9 op_sel:[0,0,0] op_sel_hi:[1,1,1]
    v_fma_mix_f32 v23, v145, v5, v9 op_sel:[1,1,1] op_sel_hi:[1,1,1]
    v_mfma_f32_32x32x16_bf16 v[72:87], v[32:35], v[208:211], v[72:87]
    v_fma_mix_f32 v24, v146, v6, v10 op_sel:[0,0,0] op_sel_hi:[1,1,1]
    v_fma_mix_f32 v25, v146, v6, v10 op_sel:[1,1,1] op_sel_hi:[1,1,1]
    v_fma_mix_f32 v26, v147, v7, v11 op_sel:[0,0,0] op_sel_hi:[1,1,1]
    v_fma_mix_f32 v27, v147, v7, v11 op_sel:[1,1,1] op_sel_hi:[1,1,1]
    ds_read_b128 v[4:7], v36 offset:1408
    ds_read_b128 v[8:11], v36 offset:1440
    v_mfma_f32_32x32x16_bf16 v[88:103], v[32:35], v[212:215], v[88:103]
    v_cvt_pk_bf16_f32 v28, v20, v21
    v_cvt_pk_bf16_f32 v29, v22, v23
    v_cvt_pk_bf16_f32 v30, v24, v25
    v_cvt_pk_bf16_f32 v31, v26, v27
    s_add_u32 m0, s16, 0xe000
    s_nop 0
    buffer_load_dwordx4 v216, s[4:7], s14 offen offset:0 lds
    buffer_load_dwordx4 v[160:163], v218, s[8:11], s15 offen offset:2048
    s_waitcnt lgkmcnt(8)
    v_mfma_f32_32x32x16_bf16 v[40:55], v[28:31], v[184:187], v[40:55]
    ds_read_b64_tr_b16 v[200:201], v220 offset:45056
    ds_read_b64_tr_b16 v[202:203], v220 offset:46080
    ds_read_b64_tr_b16 v[204:205], v221 offset:45056
    ds_read_b64_tr_b16 v[206:207], v221 offset:46080
    ds_read_b64_tr_b16 v[208:209], v222 offset:45056
    ds_read_b64_tr_b16 v[210:211], v222 offset:46080
    s_waitcnt lgkmcnt(12)
    v_mfma_f32_32x32x16_bf16 v[56:71], v[28:31], v[188:191], v[56:71]
    ds_read_b64_tr_b16 v[212:213], v223 offset:45056
    ds_read_b64_tr_b16 v[214:215], v223 offset:46080
    s_waitcnt vmcnt(6) lgkmcnt(8)
    v_fma_mix_f32 v20, v148, v4, v8 op_sel:[0,0,0] op_sel_hi:[1,1,1]
    v_fma_mix_f32 v21, v148, v4, v8 op_sel:[1,1,1] op_sel_hi:[1,1,1]
    v_fma_mix_f32 v22, v149, v5, v9 op_sel:[0,0,0] op_sel_hi:[1,1,1]
    v_fma_mix_f32 v23, v149, v5, v9 op_sel:[1,1,1] op_sel_hi:[1,1,1]
    v_mfma_f32_32x32x16_bf16 v[72:87], v[28:31], v[192:195], v[72:87]
    v_fma_mix_f32 v24, v150, v6, v10 op_sel:[0,0,0] op_sel_hi:[1,1,1]
    v_fma_mix_f32 v25, v150, v6, v10 op_sel:[1,1,1] op_sel_hi:[1,1,1]
    v_fma_mix_f32 v26, v151, v7, v11 op_sel:[0,0,0] op_sel_hi:[1,1,1]
    v_fma_mix_f32 v27, v151, v7, v11 op_sel:[1,1,1] op_sel_hi:[1,1,1]
    ds_read_b128 v[4:7], v36 offset:1536
    ds_read_b128 v[8:11], v36 offset:1568
    v_mfma_f32_32x32x16_bf16 v[88:103], v[28:31], v[196:199], v[88:103]
    v_cvt_pk_bf16_f32 v32, v20, v21
    v_cvt_pk_bf16_f32 v33, v22, v23
    v_cvt_pk_bf16_f32 v34, v24, v25
    v_cvt_pk_bf16_f32 v35, v26, v27
    buffer_load_dwordx4 v217, s[4:7], s14 offen offset:1024 lds
    buffer_load_dwordx4 v[164:167], v218, s[8:11], s15 offen offset:3072
    s_add_u32 s14, s14, s17
    s_add_u32 s15, s15, 4096
    s_waitcnt vmcnt(5)
    s_barrier
    s_waitcnt lgkmcnt(8)
    v_mfma_f32_32x32x16_bf16 v[40:55], v[32:35], v[200:203], v[40:55]
    ds_read_b64_tr_b16 v[184:185], v220 offset:49152
    ds_read_b64_tr_b16 v[186:187], v220 offset:50176
    ds_read_b64_tr_b16 v[188:189], v221 offset:49152
    ds_read_b64_tr_b16 v[190:191], v221 offset:50176
    ds_read_b64_tr_b16 v[192:193], v222 offset:49152
    ds_read_b64_tr_b16 v[194:195], v222 offset:50176
    s_waitcnt lgkmcnt(12)
    v_mfma_f32_32x32x16_bf16 v[56:71], v[32:35], v[204:207], v[56:71]
    ds_read_b64_tr_b16 v[196:197], v223 offset:49152
    ds_read_b64_tr_b16 v[198:199], v223 offset:50176
    s_waitcnt lgkmcnt(8)
    v_fma_mix_f32 v20, v152, v4, v8 op_sel:[0,0,0] op_sel_hi:[1,1,1]
    v_fma_mix_f32 v21, v152, v4, v8 op_sel:[1,1,1] op_sel_hi:[1,1,1]
    v_fma_mix_f32 v22, v153, v5, v9 op_sel:[0,0,0] op_sel_hi:[1,1,1]
    v_fma_mix_f32 v23, v153, v5, v9 op_sel:[1,1,1] op_sel_hi:[1,1,1]
    v_mfma_f32_32x32x16_bf16 v[72:87], v[32:35], v[208:211], v[72:87]
    v_fma_mix_f32 v24, v154, v6, v10 op_sel:[0,0,0] op_sel_hi:[1,1,1]
    v_fma_mix_f32 v25, v154, v6, v10 op_sel:[1,1,1] op_sel_hi:[1,1,1]
    v_fma_mix_f32 v26, v155, v7, v11 op_sel:[0,0,0] op_sel_hi:[1,1,1]
    v_fma_mix_f32 v27, v155, v7, v11 op_sel:[1,1,1] op_sel_hi:[1,1,1]
    ds_read_b128 v[4:7], v36 offset:1664
    ds_read_b128 v[8:11], v36 offset:1696
    v_mfma_f32_32x32x16_bf16 v[88:103], v[32:35], v[212:215], v[88:103]
    v_cvt_pk_bf16_f32 v28, v20, v21
    v_cvt_pk_bf16_f32 v29, v22, v23
    v_cvt_pk_bf16_f32 v30, v24, v25
    v_cvt_pk_bf16_f32 v31, v26, v27
    s_add_u32 m0, s16, 0x0
    s_nop 0
    buffer_load_dwordx4 v216, s[4:7], s14 offen offset:0 lds
    buffer_load_dwordx4 v[168:171], v218, s[8:11], s15 offen offset:0
    s_waitcnt lgkmcnt(8)
    v_mfma_f32_32x32x16_bf16 v[40:55], v[28:31], v[184:187], v[40:55]
    ds_read_b64_tr_b16 v[200:201], v220 offset:53248
    ds_read_b64_tr_b16 v[202:203], v220 offset:54272
    ds_read_b64_tr_b16 v[204:205], v221 offset:53248
    ds_read_b64_tr_b16 v[206:207], v221 offset:54272
    ds_read_b64_tr_b16 v[208:209], v222 offset:53248
    ds_read_b64_tr_b16 v[210:211], v222 offset:54272
    s_waitcnt lgkmcnt(12)
    v_mfma_f32_32x32x16_bf16 v[56:71], v[28:31], v[188:191], v[56:71]
    ds_read_b64_tr_b16 v[212:213], v223 offset:53248
    ds_read_b64_tr_b16 v[214:215], v223 offset:54272
    s_waitcnt vmcnt(6) lgkmcnt(8)
    v_fma_mix_f32 v20, v156, v4, v8 op_sel:[0,0,0] op_sel_hi:[1,1,1]
    v_fma_mix_f32 v21, v156, v4, v8 op_sel:[1,1,1] op_sel_hi:[1,1,1]
    v_fma_mix_f32 v22, v157, v5, v9 op_sel:[0,0,0] op_sel_hi:[1,1,1]
    v_fma_mix_f32 v23, v157, v5, v9 op_sel:[1,1,1] op_sel_hi:[1,1,1]
    v_mfma_f32_32x32x16_bf16 v[72:87], v[28:31], v[192:195], v[72:87]
    v_fma_mix_f32 v24, v158, v6, v10 op_sel:[0,0,0] op_sel_hi:[1,1,1]
    v_fma_mix_f32 v25, v158, v6, v10 op_sel:[1,1,1] op_sel_hi:[1,1,1]
    v_fma_mix_f32 v26, v159, v7, v11 op_sel:[0,0,0] op_sel_hi:[1,1,1]
    v_fma_mix_f32 v27, v159, v7, v11 op_sel:[1,1,1] op_sel_hi:[1,1,1]
    ds_read_b128 v[4:7], v36 offset:1792
    ds_read_b128 v[8:11], v36 offset:1824
    v_mfma_f32_32x32x16_bf16 v[88:103], v[28:31], v[196:199], v[88:103]
    v_cvt_pk_bf16_f32 v32, v20, v21
    v_cvt_pk_bf16_f32 v33, v22, v23
    v_cvt_pk_bf16_f32 v34, v24, v25
    v_cvt_pk_bf16_f32 v35, v26, v27
    buffer_load_dwordx4 v217, s[4:7], s14 offen offset:1024 lds
    buffer_load_dwordx4 v[172:175], v218, s[8:11], s15 offen offset:1024
    s_add_u32 s14, s14, s17
    s_waitcnt vmcnt(5)
    s_barrier
    s_waitcnt lgkmcnt(8)
    v_mfma_f32_32x32x16_bf16 v[40:55], v[32:35], v[200:203], v[40:55]
    ds_read_b64_tr_b16 v[184:185], v220 offset:57344
    ds_read_b64_tr_b16 v[186:187], v220 offset:58368
    ds_read_b64_tr_b16 v[188:189], v221 offset:57344
    ds_read_b64_tr_b16 v[190:191], v221 offset:58368
    ds_read_b64_tr_b16 v[192:193], v222 offset:57344
    ds_read_b64_tr_b16 v[194:195], v222 offset:58368
    s_waitcnt lgkmcnt(12)
    v_mfma_f32_32x32x16_bf16 v[56:71], v[32:35], v[204:207], v[56:71]
    ds_read_b64_tr_b16 v[196:197], v223 offset:57344
    ds_read_b64_tr_b16 v[198:199], v223 offset:58368
    s_waitcnt lgkmcnt(8)
    v_fma_mix_f32 v20, v160, v4, v8 op_sel:[0,0,0] op_sel_hi:[1,1,1]
    v_fma_mix_f32 v21, v160, v4, v8 op_sel:[1,1,1] op_sel_hi:[1,1,1]
    v_fma_mix_f32 v22, v161, v5, v9 op_sel:[0,0,0] op_sel_hi:[1,1,1]
    v_fma_mix_f32 v23, v161, v5, v9 op_sel:[1,1,1] op_sel_hi:[1,1,1]
    v_mfma_f32_32x32x16_bf16 v[72:87], v[32:35], v[208:211], v[72:87]
    v_fma_mix_f32 v24, v162, v6, v10 op_sel:[0,0,0] op_sel_hi:[1,1,1]
    v_fma_mix_f32 v25, v162, v6, v10 op_sel:[1,1,1] op_sel_hi:[1,1,1]
    v_fma_mix_f32 v26, v163, v7, v11 op_sel:[0,0,0] op_sel_hi:[1,1,1]
    v_fma_mix_f32 v27, v163, v7, v11 op_sel:[1,1,1] op_sel_hi:[1,1,1]
    ds_read_b128 v[4:7], v36 offset:1920
    ds_read_b128 v[8:11], v36 offset:1952
    v_mfma_f32_32x32x16_bf16 v[88:103], v[32:35], v[212:215], v[88:103]
    v_cvt_pk_bf16_f32 v28, v20, v21
    v_cvt_pk_bf16_f32 v29, v22, v23
    v_cvt_pk_bf16_f32 v30, v24, v25
    v_cvt_pk_bf16_f32 v31, v26, v27
    s_add_u32 m0, s16, 0x2000
    s_nop 0
    buffer_load_dwordx4 v216, s[4:7], s14 offen offset:0 lds
    buffer_load_dwordx4 v[176:179], v218, s[8:11], s15 offen offset:2048
    s_waitcnt lgkmcnt(8)
    v_mfma_f32_32x32x16_bf16 v[40:55], v[28:31], v[184:187], v[40:55]
    ds_read_b64_tr_b16 v[200:201], v220 offset:61440
    ds_read_b64_tr_b16 v[202:203], v220 offset:62464
    ds_read_b64_tr_b16 v[204:205], v221 offset:61440
    ds_read_b64_tr_b16 v[206:207], v221 offset:62464
    ds_read_b64_tr_b16 v[208:209], v222 offset:61440
    ds_read_b64_tr_b16 v[210:211], v222 offset:62464
    s_waitcnt lgkmcnt(12)
    v_mfma_f32_32x32x16_bf16 v[56:71], v[28:31], v[188:191], v[56:71]
    ds_read_b64_tr_b16 v[212:213], v223 offset:61440
    ds_read_b64_tr_b16 v[214:215], v223 offset:62464
    s_waitcnt vmcnt(6) lgkmcnt(8)
    v_fma_mix_f32 v20, v164, v4, v8 op_sel:[0,0,0] op_sel_hi:[1,1,1]
    v_fma_mix_f32 v21, v164, v4, v8 op_sel:[1,1,1] op_sel_hi:[1,1,1]
    v_fma_mix_f32 v22, v165, v5, v9 op_sel:[0,0,0] op_sel_hi:[1,1,1]
    v_fma_mix_f32 v23, v165, v5, v9 op_sel:[1,1,1] op_sel_hi:[1,1,1]
    v_mfma_f32_32x32x16_bf16 v[72:87], v[28:31], v[192:195], v[72:87]
    v_fma_mix_f32 v24, v166, v6, v10 op_sel:[0,0,0] op_sel_hi:[1,1,1]
    v_fma_mix_f32 v25, v166, v6, v10 op_sel:[1,1,1] op_sel_hi:[1,1,1]
    v_fma_mix_f32 v26, v167, v7, v11 op_sel:[0,0,0] op_sel_hi:[1,1,1]
    v_fma_mix_f32 v27, v167, v7, v11 op_sel:[1,1,1] op_sel_hi:[1,1,1]
    ds_read_b128 v[4:7], v36 offset:2048
    ds_read_b128 v[8:11], v36 offset:2080
    v_mfma_f32_32x32x16_bf16 v[88:103], v[28:31], v[196:199], v[88:103]
    v_cvt_pk_bf16_f32 v32, v20, v21
    v_cvt_pk_bf16_f32 v33, v22, v23
    v_cvt_pk_bf16_f32 v34, v24, v25
    v_cvt_pk_bf16_f32 v35, v26, v27
    buffer_load_dwordx4 v217, s[4:7], s14 offen offset:1024 lds
    buffer_load_dwordx4 v[180:183], v218, s[8:11], s15 offen offset:3072
    s_add_u32 s14, s14, s17
    s_add_u32 s15, s15, 4096
    s_waitcnt vmcnt(5)
    s_barrier
    s_waitcnt lgkmcnt(8)
    v_mfma_f32_32x32x16_bf16 v[40:55], v[32:35], v[200:203], v[40:55]
    ds_read_b64_tr_b16 v[184:185], v220 offset:0
    ds_read_b64_tr_b16 v[186:187], v220 offset:1024
    ds_read_b64_tr_b16 v[188:189], v221 offset:0
    ds_read_b64_tr_b16 v[190:191], v221 offset:1024
    ds_read_b64_tr_b16 v[192:193], v222 offset:0
    ds_read_b64_tr_b16 v[194:195], v222 offset:1024
    s_waitcnt lgkmcnt(12)
    v_mfma_f32_32x32x16_bf16 v[56:71], v[32:35], v[204:207], v[56:71]
    ds_read_b64_tr_b16 v[196:197], v223 offset:0
    ds_read_b64_tr_b16 v[198:199], v223 offset:1024
    s_waitcnt lgkmcnt(8)
    v_fma_mix_f32 v20, v168, v4, v8 op_sel:[0,0,0] op_sel_hi:[1,1,1]
    v_fma_mix_f32 v21, v168, v4, v8 op_sel:[1,1,1] op_sel_hi:[1,1,1]
    v_fma_mix_f32 v22, v169, v5, v9 op_sel:[0,0,0] op_sel_hi:[1,1,1]
    v_fma_mix_f32 v23, v169, v5, v9 op_sel:[1,1,1] op_sel_hi:[1,1,1]
    v_mfma_f32_32x32x16_bf16 v[72:87], v[32:35], v[208:211], v[72:87]
    v_fma_mix_f32 v24, v170, v6, v10 op_sel:[0,0,0] op_sel_hi:[1,1,1]
    v_fma_mix_f32 v25, v170, v6, v10 op_sel:[1,1,1] op_sel_hi:[1,1,1]
    v_fma_mix_f32 v26, v171, v7, v11 op_sel:[0,0,0] op_sel_hi:[1,1,1]
    v_fma_mix_f32 v27, v171, v7, v11 op_sel:[1,1,1] op_sel_hi:[1,1,1]
    ds_read_b128 v[4:7], v36 offset:2176
    ds_read_b128 v[8:11], v36 offset:2208
    v_mfma_f32_32x32x16_bf16 v[88:103], v[32:35], v[212:215], v[88:103]
    v_cvt_pk_bf16_f32 v28, v20, v21
    v_cvt_pk_bf16_f32 v29, v22, v23
    v_cvt_pk_bf16_f32 v30, v24, v25
    v_cvt_pk_bf16_f32 v31, v26, v27
    s_waitcnt lgkmcnt(8)
    s_nop 0
    v_mfma_f32_32x32x16_bf16 v[40:55], v[28:31], v[184:187], v[40:55]
    ds_read_b64_tr_b16 v[200:201], v220 offset:4096
    ds_read_b64_tr_b16 v[202:203], v220 offset:5120
    ds_read_b64_tr_b16 v[204:205], v221 offset:4096
    ds_read_b64_tr_b16 v[206:207], v221 offset:5120
    ds_read_b64_tr_b16 v[208:209], v222 offset:4096
    ds_read_b64_tr_b16 v[210:211], v222 offset:5120
    s_waitcnt lgkmcnt(12)
    v_mfma_f32_32x32x16_bf16 v[56:71], v[28:31], v[188:191], v[56:71]
    ds_read_b64_tr_b16 v[212:213], v223 offset:4096
    ds_read_b64_tr_b16 v[214:215], v223 offset:5120
    s_waitcnt vmcnt(4) lgkmcnt(8)
    v_fma_mix_f32 v20, v172, v4, v8 op_sel:[0,0,0] op_sel_hi:[1,1,1]
    v_fma_mix_f32 v21, v172, v4, v8 op_sel:[1,1,1] op_sel_hi:[1,1,1]
    v_fma_mix_f32 v22, v173, v5, v9 op_sel:[0,0,0] op_sel_hi:[1,1,1]
    v_fma_mix_f32 v23, v173, v5, v9 op_sel:[1,1,1] op_sel_hi:[1,1,1]
    v_mfma_f32_32x32x16_bf16 v[72:87], v[28:31], v[192:195], v[72:87]
    v_fma_mix_f32 v24, v174, v6, v10 op_sel:[0,0,0] op_sel_hi:[1,1,1]
    v_fma_mix_f32 v25, v174, v6, v10 op_sel:[1,1,1] op_sel_hi:[1,1,1]
    v_fma_mix_f32 v26, v175, v7, v11 op_sel:[0,0,0] op_sel_hi:[1,1,1]
    v_fma_mix_f32 v27, v175, v7, v11 op_sel:[1,1,1] op_sel_hi:[1,1,1]
    ds_read_b128 v[4:7], v36 offset:2304
    ds_read_b128 v[8:11], v36 offset:2336
    v_mfma_f32_32x32x16_bf16 v[88:103], v[28:31], v[196:199], v[88:103]
    v_cvt_pk_bf16_f32 v32, v20, v21
    v_cvt_pk_bf16_f32 v33, v22, v23
    v_cvt_pk_bf16_f32 v34, v24, v25
    v_cvt_pk_bf16_f32 v35, v26, v27
    s_waitcnt vmcnt(1)
    s_barrier
    s_waitcnt lgkmcnt(8)
    v_mfma_f32_32x32x16_bf16 v[40:55], v[32:35], v[200:203], v[40:55]
    ds_read_b64_tr_b16 v[184:185], v220 offset:8192
    ds_read_b64_tr_b16 v[186:187], v220 offset:9216
    ds_read_b64_tr_b16 v[188:189], v221 offset:8192
    ds_read_b64_tr_b16 v[190:191], v221 offset:9216
    ds_read_b64_tr_b16 v[192:193], v222 offset:8192
    ds_read_b64_tr_b16 v[194:195], v222 offset:9216
    s_waitcnt lgkmcnt(12)
    v_mfma_f32_32x32x16_bf16 v[56:71], v[32:35], v[204:207], v[56:71]
    ds_read_b64_tr_b16 v[196:197], v223 offset:8192
    ds_read_b64_tr_b16 v[198:199], v223 offset:9216
    s_waitcnt lgkmcnt(8)
    v_fma_mix_f32 v20, v176, v4, v8 op_sel:[0,0,0] op_sel_hi:[1,1,1]
    v_fma_mix_f32 v21, v176, v4, v8 op_sel:[1,1,1] op_sel_hi:[1,1,1]
    v_fma_mix_f32 v22, v177, v5, v9 op_sel:[0,0,0] op_sel_hi:[1,1,1]
    v_fma_mix_f32 v23, v177, v5, v9 op_sel:[1,1,1] op_sel_hi:[1,1,1]
    v_mfma_f32_32x32x16_bf16 v[72:87], v[32:35], v[208:211], v[72:87]
    v_fma_mix_f32 v24, v178, v6, v10 op_sel:[0,0,0] op_sel_hi:[1,1,1]
    v_fma_mix_f32 v25, v178, v6, v10 op_sel:[1,1,1] op_sel_hi:[1,1,1]
    v_fma_mix_f32 v26, v179, v7, v11 op_sel:[0,0,0] op_sel_hi:[1,1,1]
    v_fma_mix_f32 v27, v179, v7, v11 op_sel:[1,1,1] op_sel_hi:[1,1,1]
    ds_read_b128 v[4:7], v36 offset:2432
    ds_read_b128 v[8:11], v36 offset:2464
    v_mfma_f32_32x32x16_bf16 v[88:103], v[32:35], v[212:215], v[88:103]
    v_cvt_pk_bf16_f32 v28, v20, v21
    v_cvt_pk_bf16_f32 v29, v22, v23
    v_cvt_pk_bf16_f32 v30, v24, v25
    v_cvt_pk_bf16_f32 v31, v26, v27
    s_waitcnt lgkmcnt(8)
    s_nop 0
    v_mfma_f32_32x32x16_bf16 v[40:55], v[28:31], v[184:187], v[40:55]
    ds_read_b64_tr_b16 v[200:201], v220 offset:12288
    ds_read_b64_tr_b16 v[202:203], v220 offset:13312
    ds_read_b64_tr_b16 v[204:205], v221 offset:12288
    ds_read_b64_tr_b16 v[206:207], v221 offset:13312
    ds_read_b64_tr_b16 v[208:209], v222 offset:12288
    ds_read_b64_tr_b16 v[210:211], v222 offset:13312
    s_waitcnt lgkmcnt(12)
    v_mfma_f32_32x32x16_bf16 v[56:71], v[28:31], v[188:191], v[56:71]
    ds_read_b64_tr_b16 v[212:213], v223 offset:12288
    ds_read_b64_tr_b16 v[214:215], v223 offset:13312
    s_waitcnt vmcnt(0) lgkmcnt(8)
    v_fma_mix_f32 v20, v180, v4, v8 op_sel:[0,0,0] op_sel_hi:[1,1,1]
    v_fma_mix_f32 v21, v180, v4, v8 op_sel:[1,1,1] op_sel_hi:[1,1,1]
    v_fma_mix_f32 v22, v181, v5, v9 op_sel:[0,0,0] op_sel_hi:[1,1,1]
    v_fma_mix_f32 v23, v181, v5, v9 op_sel:[1,1,1] op_sel_hi:[1,1,1]
    v_mfma_f32_32x32x16_bf16 v[72:87], v[28:31], v[192:195], v[72:87]
    v_fma_mix_f32 v24, v182, v6, v10 op_sel:[0,0,0] op_sel_hi:[1,1,1]
    v_fma_mix_f32 v25, v182, v6, v10 op_sel:[1,1,1] op_sel_hi:[1,1,1]
    v_fma_mix_f32 v26, v183, v7, v11 op_sel:[0,0,0] op_sel_hi:[1,1,1]
    v_fma_mix_f32 v27, v183, v7, v11 op_sel:[1,1,1] op_sel_hi:[1,1,1]
    v_mfma_f32_32x32x16_bf16 v[88:103], v[28:31], v[196:199], v[88:103]
    v_cvt_pk_bf16_f32 v32, v20, v21
    v_cvt_pk_bf16_f32 v33, v22, v23
    v_cvt_pk_bf16_f32 v34, v24, v25
    v_cvt_pk_bf16_f32 v35, v26, v27
    s_waitcnt lgkmcnt(6)
    s_nop 0
    v_mfma_f32_32x32x16_bf16 v[40:55], v[32:35], v[200:203], v[40:55]
    s_waitcnt lgkmcnt(4)
    v_mfma_f32_32x32x16_bf16 v[56:71], v[32:35], v[204:207], v[56:71]
    s_waitcnt lgkmcnt(2)
    v_mfma_f32_32x32x16_bf16 v[72:87], v[32:35], v[208:211], v[72:87]
    s_waitcnt lgkmcnt(0)
    v_mfma_f32_32x32x16_bf16 v[88:103], v[32:35], v[212:215], v[88:103]
    s_lshl_b32 s18, s19, 13
    s_lshl_b32 s17, s3, 16
    s_add_u32 s18, s18, s17
    s_add_u32 s18, s18, 16384
    v_add_u32 v224, s18, v218
    v_xor_b32 v225, 0x10000, v224
    s_nop 3
    ds_write_b128 v224, v[72:75] offset:0
    ds_write_b128 v224, v[76:79] offset:1024
    ds_write_b128 v224, v[80:83] offset:2048
    ds_write_b128 v224, v[84:87] offset:3072
    ds_write_b128 v224, v[88:91] offset:4096
    ds_write_b128 v224, v[92:95] offset:5120
    ds_write_b128 v224, v[96:99] offset:6144
    ds_write_b128 v224, v[100:103] offset:7168
    s_waitcnt lgkmcnt(0)
    s_barrier
    ds_read_b128 v[104:107], v225 offset:0
    ds_read_b128 v[108:111], v225 offset:1024
    ds_read_b128 v[112:115], v225 offset:2048
    ds_read_b128 v[116:119], v225 offset:3072
    ds_read_b128 v[120:123], v225 offset:4096
    ds_read_b128 v[124:127], v225 offset:5120
    ds_read_b128 v[128:131], v225 offset:6144
    ds_read_b128 v[132:135], v225 offset:7168
    s_cmp_eq_u32 s25, 15
    s_cbranch_scc1 L_spare_12
    s_waitcnt lgkmcnt(7)
    v_pk_add_f32 v[40:41], v[40:41], v[104:105]
    v_pk_add_f32 v[42:43], v[42:43], v[106:107]
    s_waitcnt lgkmcnt(6)
    v_pk_add_f32 v[44:45], v[44:45], v[108:109]
    v_pk_add_f32 v[46:47], v[46:47], v[110:111]
    v_pk_mul_f32 v[40:41], v[40:41], s[34:35]
    v_pk_mul_f32 v[42:43], v[42:43], s[34:35]
    v_pk_mul_f32 v[44:45], v[44:45], s[34:35]
    v_pk_mul_f32 v[46:47], v[46:47], s[34:35]
    v_add_u32 v40, 0x10000, v40
    v_add_u32 v44, s36, v44
    v_and_b32 v40, 0xfffe0000, v40
    v_and_b32 v44, s37, v44
    v_cvt_pk_bf16_f32 v184, v40, v41
    v_cvt_pk_bf16_f32 v185, v42, v43
    v_cvt_pk_bf16_f32 v186, v44, v45
    v_cvt_pk_bf16_f32 v187, v46, v47
    buffer_store_dwordx4 v[184:187], v230, s[8:11], s33 offen offset:0 sc0 sc1
    s_waitcnt lgkmcnt(5)
    v_pk_add_f32 v[48:49], v[48:49], v[112:113]
    v_pk_add_f32 v[50:51], v[50:51], v[114:115]
    s_waitcnt lgkmcnt(4)
    v_pk_add_f32 v[52:53], v[52:53], v[116:117]
    v_pk_add_f32 v[54:55], v[54:55], v[118:119]
    v_pk_mul_f32 v[48:49], v[48:49], s[34:35]
    v_pk_mul_f32 v[50:51], v[50:51], s[34:35]
    v_pk_mul_f32 v[52:53], v[52:53], s[34:35]
    v_pk_mul_f32 v[54:55], v[54:55], s[34:35]
    v_add_u32 v48, 0x10000, v48
    v_add_u32 v52, s36, v52
    v_and_b32 v48, 0xfffe0000, v48
    v_and_b32 v52, s37, v52
    v_cvt_pk_bf16_f32 v188, v48, v49
    v_cvt_pk_bf16_f32 v189, v50, v51
    v_cvt_pk_bf16_f32 v190, v52, v53
    v_cvt_pk_bf16_f32 v191, v54, v55
    buffer_store_dwordx4 v[188:191], v230, s[8:11], s33 offen offset:640 sc0 sc1
    s_waitcnt lgkmcnt(3)
    v_pk_add_f32 v[56:57], v[56:57], v[120:121]
    v_pk_add_f32 v[58:59], v[58:59], v[122:123]
    s_waitcnt lgkmcnt(2)
    v_pk_add_f32 v[60:61], v[60:61], v[124:125]
    v_pk_add_f32 v[62:63], v[62:63], v[126:127]
    v_pk_mul_f32 v[56:57], v[56:57], s[34:35]
    v_pk_mul_f32 v[58:59], v[58:59], s[34:35]
    v_pk_mul_f32 v[60:61], v[60:61], s[34:35]
    v_pk_mul_f32 v[62:63], v[62:63], s[34:35]
    v_add_u32 v56, 0x10000, v56
    v_add_u32 v60, s36, v60
    v_and_b32 v56, 0xfffe0000, v56
    v_and_b32 v60, s37, v60
    v_cvt_pk_bf16_f32 v192, v56, v57
    v_cvt_pk_bf16_f32 v193, v58, v59
    v_cvt_pk_bf16_f32 v194, v60, v61
    v_cvt_pk_bf16_f32 v195, v62, v63
    buffer_store_dwordx4 v[192:195], v231, s[8:11], s33 offen offset:0 sc0 sc1
    s_waitcnt lgkmcnt(1)
    v_pk_add_f32 v[64:65], v[64:65], v[128:129]
    v_pk_add_f32 v[66:67], v[66:67], v[130:131]
    s_waitcnt lgkmcnt(0)
    v_pk_add_f32 v[68:69], v[68:69], v[132:133]
    v_pk_add_f32 v[70:71], v[70:71], v[134:135]
    v_pk_mul_f32 v[64:65], v[64:65], s[34:35]
    v_pk_mul_f32 v[66:67], v[66:67], s[34:35]
    v_pk_mul_f32 v[68:69], v[68:69], s[34:35]
    v_pk_mul_f32 v[70:71], v[70:71], s[34:35]
    v_add_u32 v64, 0x10000, v64
    v_add_u32 v68, s36, v68
    v_and_b32 v64, 0xfffe0000, v64
    v_and_b32 v68, s37, v68
    v_cvt_pk_bf16_f32 v196, v64, v65
    v_cvt_pk_bf16_f32 v197, v66, v67
    v_cvt_pk_bf16_f32 v198, v68, v69
    v_cvt_pk_bf16_f32 v199, v70, v71
    buffer_store_dwordx4 v[196:199], v231, s[8:11], s33 offen offset:640 sc0 sc1
    s_branch L_join_9
L_spare_12:
    v_min_u32 v224, 239, v0
    s_mul_i32 s30, s24, 240
    v_add_u32 v224, s30, v224
    v_lshlrev_b32 v225, 2, v224
    s_mov_b32 s31, 0
    buffer_load_dword v184, v225, s[8:11], s31 offen
    s_mov_b32 s31, 15360
    buffer_load_dword v185, v225, s[8:11], s31 offen
    s_mov_b32 s31, 30720
    buffer_load_dword v186, v225, s[8:11], s31 offen
    s_mov_b32 s31, 46080
    buffer_load_dword v187, v225, s[8:11], s31 offen
    s_lshl_b32 s31, s24, 12
    s_lshl_b32 s32, s3, 11
    s_add_u32 s31, s31, s32
    s_add_u32 s31, s31, 0x60000
    v_mov_b32 v192, 0
    v_mov_b32 v193, 0
    v_mov_b32 v194, 0
    v_mov_b32 v195, 0
    v_mov_b32 v196, 0
    v_mov_b32 v197, 0
    v_mov_b32 v198, 0
    v_mov_b32 v199, 0
    s_mov_b32 exec_hi, 0
    s_waitcnt lgkmcnt(7)
    v_add_f32 v40, v40, v104
    v_add_f32 v41, v41, v105
    v_mul_f32 v41, 0x38000000, v41
    v_cvt_pk_bf16_f32 v192, v40, v40
    v_and_b32 v226, 0xffff0000, v192
    v_sub_f32 v40, v40, v226
    v_cvt_pk_bf16_f32 v193, v40, v40
    v_cvt_pk_bf16_f32 v194, v41, v41
    v_and_b32 v226, 0xffff0000, v194
    v_sub_f32 v41, v41, v226
    v_cvt_pk_bf16_f32 v195, v41, v41
    s_waitcnt lgkmcnt(3)
    v_add_f32 v56, v56, v120
    v_add_f32 v57, v57, v121
    v_mul_f32 v57, 0x38000000, v57
    v_cvt_pk_bf16_f32 v196, v56, v56
    v_and_b32 v226, 0xffff0000, v196
    v_sub_f32 v56, v56, v226
    v_cvt_pk_bf16_f32 v197, v56, v56
    v_cvt_pk_bf16_f32 v198, v57, v57
    v_and_b32 v226, 0xffff0000, v198
    v_sub_f32 v57, v57, v226
    v_cvt_pk_bf16_f32 v199, v57, v57
    s_mov_b64 exec, -1
    buffer_store_dwordx4 v[192:195], v218, s[8:11], s31 offen offset:0 sc0 sc1
    buffer_store_dwordx4 v[196:199], v218, s[8:11], s31 offen offset:1024 sc0 sc1
    s_waitcnt vmcnt(4)
    v_add_f32 v184, v184, v185
    s_waitcnt vmcnt(2)
    v_add_f32 v186, v186, v187
    v_add_f32 v184, v184, v186
    v_cvt_pk_bf16_f32 v184, v184, v184
    v_and_b32 v184, 0xffff0000, v184
    v_add_f32 v185, 1.0, v184
    v_cvt_pk_bf16_f32 v185, v185, v185
    v_and_b32 v185, 0xffff0000, v185
    v_subrev_u32 v226, 1920, v224
    v_min_u32 v226, v226, v224
    v_subrev_u32 v226, 640, v226
    v_cmp_gt_u32 vcc, 640, v226
    s_nop 1
    v_cndmask_b32 v184, v184, v185, vcc
    s_mov_b32 s31, 0x10000
    buffer_store_dword v184, v225, s[8:11], s31 offen sc0 sc1
L_join_9:
    s_lshl_b32 s66, s25, 1
    s_lshr_b32 s67, s24, 3
    s_add_u32 s66, s66, s67
    s_lshl_b32 s66, s66, 7
    s_add_u32 s66, s66, 0x70000
    s_load_dwordx2 s[8:9], s[0:1], 96
    s_mov_b32 s10, 0x10000000
    s_mov_b32 s11, 0x20000
    s_load_dwordx2 s[4:5], s[0:1], 16
    s_mov_b32 s6, 0xc8000
    s_mov_b32 s7, 0x20000
    s_load_dwordx2 s[52:53], s[0:1], 32
    s_mov_b32 s54, 0x21c000
    s_mov_b32 s55, 0x20000
    s_load_dwordx2 s[12:13], s[0:1], 0
    s_mov_b32 s14, 0x280000
    s_mov_b32 s15, 0x20000
    s_load_dwordx2 s[44:45], s[0:1], 56
    s_mov_b32 s46, 0x10e000
    s_mov_b32 s47, 0x20000
    s_load_dwordx2 s[48:49], s[0:1], 40
    s_mov_b32 s50, 0x800000
    s_mov_b32 s51, 0x20000
    v_lshrrev_b32 v136, 6, v0
    s_nop 0
    v_readfirstlane_b32 s16, v136
    s_and_b32 s22, s2, 7
    s_lshr_b32 s23, s2, 3
    s_lshl_b32 s22, s22, 2
    s_lshr_b32 s24, s23, 3
    s_add_u32 s41, s22, s24
    s_and_b32 s24, s23, 7
    s_lshl_b32 s24, s24, 3
    s_add_u32 s42, s24, s16
    v_and_b32 v126, 63, v0
    v_lshlrev_b32 v127, 4, v126
    s_mul_i32 s25, s41, 81920
    s_mul_i32 s26, s42, 1280
    s_add_u32 s26, s26, s25
    s_add_u32 s26, s26, 0x400000
    s_mul_i32 s27, s16, 1280
    s_lshl_b32 s39, s16, 12
    s_add_u32 s39, s39, 131072
    s_lshl_b32 s25, s25, 1
    s_add_u32 s40, s39, s25
    s_add_u32 s40, s40, 0x680000
    s_mov_b32 m0, s27
    s_mov_b32 s61, s26
    v_and_b32 v1, 63, v0
    v_lshlrev_b32 v2, 7, v1
    v_lshlrev_b32 v1, 12, v1
    v_min_u32 v2, 0xf80, v2
    v_mov_b32 v3, 1
    s_and_b32 s67, s2, 7
    s_lshl_b32 s67, s67, 12
    s_add_u32 s67, s67, 0x70000
    s_waitcnt vmcnt(0) lgkmcnt(0)
    s_barrier
    s_cmp_lg_u32 s16, 0
    s_cbranch_scc1 L_nosig_15
    s_mov_b64 exec, 0xff
    buffer_atomic_add v3, v1, s[8:11], s66 offen sc1
    s_mov_b64 exec, -1
L_nosig_15:
    v_bfe_u32 v137, v126, 4, 1
    v_mul_u32_u24 v119, 640, v137
    v_and_b32 v137, 1, v126
    v_mul_u32_u24 v137, 320, v137
    v_add_u32 v119, v119, v137
    v_lshrrev_b32 v137, 5, v126
    v_lshl_add_u32 v119, v137, 7, v119
    v_bfe_u32 v138, v126, 2, 2
    v_lshl_add_u32 v119, v138, 4, v119
    v_bfe_u32 v138, v126, 1, 1
    v_lshl_add_u32 v119, v138, 3, v119
    v_add_u32 v125, s27, v119
    v_mul_u32_u24 v122, 320, v137
    v_and_b32 v139, 31, v126
    v_lshl_add_u32 v122, v139, 4, v122
    v_add_u32 v122, 1280, v122
    v_add_u32 v120, 61440, v119
    v_add_u32 v123, 61440, v122
    v_add_u32 v121, 122880, v119
    v_add_u32 v124, 122880, v122
    s_mov_b32 s36, 0x000fffff
    s_mov_b32 s37, 0x000fffff
    v_mov_b32 v24, 0x3f803f80
    v_mov_b32 v25, 0x3f803f80
    v_mov_b32 v26, 0x3f803f80
    v_mov_b32 v27, 0x3f803f80
    v_mov_b32 v28, 0x3f803f80
    v_mov_b32 v29, 0x3f803f80
    v_mov_b32 v30, 0x3f803f80
    v_mov_b32 v31, 0x3f803f80
    v_mov_b32 v32, 0x3f803f80
    v_mov_b32 v33, 0x3f803f80
    v_mov_b32 v34, 0x3f803f80
    v_mov_b32 v35, 0x3f803f80
    v_mov_b32 v36, 0x3f803f80
    v_mov_b32 v37, 0x3f803f80
    v_mov_b32 v38, 0x3f803f80
    v_mov_b32 v39, 0x3f803f80
    v_mov_b64 v[64:65], 0
    v_mov_b64 v[66:67], 0
    v_mov_b64 v[68:69], 0
    v_mov_b64 v[70:71], 0
    v_mov_b64 v[72:73], 0
    v_mov_b64 v[74:75], 0
    v_mov_b64 v[76:77], 0
    v_mov_b64 v[78:79], 0
    s_mul_i32 s22, s42, 40960
    s_add_u32 s22, s22, 0x100000
    s_lshl_b32 s92, s41, 9
    s_add_u32 s92, s92, s22
    s_lshr_b32 s24, s41, 1
    s_add_u32 s24, s24, 64
    s_lshl_b32 s24, s24, 8
    s_and_b32 s25, s41, 1
    s_lshl_b32 s25, s25, 3
    s_add_u32 s24, s24, s25
    s_add_u32 s93, s24, s22
    v_bfe_u32 v172, v126, 4, 1
    v_mul_u32_u24 v172, 20480, v172
    v_and_b32 v138, 15, v126
    v_lshl_add_u32 v172, v138, 4, v172
    v_lshl_add_u32 v173, v137, 8, v172
    s_lshl_b32 s98, s16, 5
    s_add_u32 s98, s98, s23
    s_and_b32 s22, s2, 7
    s_lshr_b32 s23, s2, 3
    s_lshl_b32 s22, s22, 1
    s_and_b32 s26, s23, 1
    s_add_u32 s26, s26, s22
    s_lshr_b32 s25, s23, 1
    s_and_b32 s17, s16, 3
    s_lshr_b32 s18, s16, 2
    s_lshl_b32 s28, s26, 2
    s_add_u32 s28, s28, s17
    s_mul_i32 s20, s28, 40960
    s_mul_i32 s22, s18, 20480
    s_add_u32 s20, s20, s22
    s_add_u32 s20, s20, 0x400000
    s_mov_b32 s59, 0
    s_xor_b32 s21, s18, 1
    s_lshl_b32 s63, s21, 15
    s_add_u32 s63, s63, 98304
    s_mul_i32 s21, s21, 49152
    v_and_b32 v200, 63, v0
    v_lshlrev_b32 v182, 4, v200
    v_bfe_u32 v201, v200, 2, 2
    v_and_b32 v202, 3, v200
    v_lshlrev_b32 v202, 3, v202
    v_bfe_u32 v203, v200, 4, 1
    v_lshl_add_u32 v202, v203, 5, v202
    s_mul_i32 s19, s25, 216
    s_and_b32 s38, s19, 63
    s_sub_u32 s19, s19, s38
    s_lshl_b32 s22, s18, 7
    s_add_u32 s22, s22, s38
    v_add_u32 v202, s22, v202
    v_lshlrev_b32 v203, 6, v201
    v_lshl_add_u32 v201, v201, 8, s21
    v_lshrrev_b32 v200, 5, v200
    v_lshl_add_u32 v201, v200, 10, v201
    v_add_u32 v184, 0, v202
    v_and_b32 v184, 255, v184
    v_xor_b32 v184, v184, v203
    v_add_u32 v184, v184, v201
    v_lshl_add_u32 v188, v200, 10, v184
    v_add_u32 v185, 64, v202
    v_and_b32 v185, 255, v185
    v_xor_b32 v185, v185, v203
    v_add_u32 v185, v185, v201
    v_lshl_add_u32 v189, v200, 10, v185
    v_add_u32 v186, 128, v202
    v_and_b32 v186, 255, v186
    v_xor_b32 v186, v186, v203
    v_add_u32 v186, v186, v201
    v_lshl_add_u32 v190, v200, 10, v186
    v_add_u32 v187, 192, v202
    v_and_b32 v187, 255, v187
    v_xor_b32 v187, v187, v203
    v_add_u32 v187, v187, v201
    v_lshl_add_u32 v191, v200, 10, v187
    s_sub_u32 s22, s63, s21
    v_add_u32 v192, s22, v184
    v_add_u32 v193, s22, v185
    v_add_u32 v194, s22, v186
    v_add_u32 v195, s22, v187
    v_add_u32 v196, s22, v188
    v_add_u32 v197, s22, v189
    v_add_u32 v198, s22, v190
    v_add_u32 v199, s22, v191
    v_and_b32 v204, 31, v0
    v_lshlrev_b32 v205, 3, v204
    v_lshl_add_u32 v206, v200, 16, v205
    s_lshl_b32 s29, s28, 8
    s_add_u32 s29, s29, 0x20000
    s_lshl_b32 s30, s25, 12
    s_lshl_b32 s31, s18, 11
    s_add_u32 s30, s30, s31
    s_add_u32 s30, s30, 0x60000
    s_mul_i32 s31, s28, 57344
    s_and_b32 s32, s25, 7
    s_mul_i32 s32, s32, 7168
    s_add_u32 s31, s31, s32
    s_lshl_b32 s32, s18, 12
    s_add_u32 s31, s31, s32
    s_cmp_ge_u32 s25, 8
    s_mov_b32 s32, 0x1500000
    s_cselect_b32 s32, 0x1900000, s32
    s_add_u32 s31, s31, s32
    s_lshl_b32 s33, s28, 7
    s_add_u32 s33, s33, 0x40000
    s_lshl_b32 s34, s28, 10
    s_lshl_b32 s35, s18, 9
    s_add_u32 s34, s34, s35
    s_and_b32 s35, s25, 7
    s_lshl_b32 s35, s35, 1
    s_add_u32 s34, s34, s35
    s_add_u32 s34, s34, 0x50000
    s_mul_i32 s22, s17, 27648
    s_add_u32 s19, s19, s22
    s_lshl_b32 s24, s17, 11
    v_and_b32 v200, 63, v0
    v_lshrrev_b32 v201, 4, v200
    v_bfe_u32 v202, v200, 2, 2
    v_xor_b32 v202, v202, v201
    v_and_b32 v203, 3, v200
    v_lshlrev_b32 v203, 4, v203
    v_lshl_add_u32 v203, v202, 6, v203
    s_cmp_gt_u32 s38, 40
    s_cselect_b32 s22, 256, 0
    v_mov_b32 v202, s22
    v_cmp_eq_u32 vcc, 0, v203
    s_nop 1
    v_cndmask_b32 v203, v203, v202, vcc
    s_movk_i32 s22, 3456
    v_mad_u32_u24 v180, v201, s22, v203
    v_add_u32 v181, 12800, v180
    s_mul_i32 s64, s18, 1105920
    s_add_u32 s64, s64, s19
    s_add_u32 s64, s64, 884736
    s_add_u32 s63, s63, s24
    s_mul_i32 s66, s41, 20
    s_add_u32 s58, s66, 19
    s_lshr_b32 s66, s66, 7
    s_lshr_b32 s58, s58, 7
    s_lshl_b32 s66, s66, 1
    s_lshl_b32 s58, s58, 1
    s_lshl_b32 s66, 3, s66
    s_lshl_b32 s58, 3, s58
    s_or_b32 s66, s66, s58
    s_mul_i32 s66, s66, 0x100401
    s_mov_b32 s58, 0
    s_cmp_lg_u32 s16, 0
    s_cbranch_scc1 L_ok_17
L_poll_16:
    s_add_u32 s58, s58, 1
    s_cmp_gt_u32 s58, 3000
    s_cbranch_scc1 L_ok_17
    s_sleep 1
    buffer_load_dword v3, v2, s[8:11], s67 offen sc1
    s_waitcnt vmcnt(0)
    v_cmp_gt_u32 vcc, 8, v3
    s_and_b32 vcc_lo, vcc_lo, s66
    s_cbranch_scc1 L_poll_16
L_ok_17:
    s_barrier
    buffer_load_dwordx4 v127, s[8:11], s61 offen lds
    s_mov_b64 exec, 0xffff
    buffer_load_dwordx4 v127, s[8:11], s61 offen offset:1024 lds
    s_mov_b64 exec, -1
    s_mov_b32 m0, s39
    s_nop 0
    buffer_load_dwordx4 v127, s[8:11], s40 offen offset:0 lds
    buffer_load_dwordx4 v127, s[8:11], s40 offen offset:1024 lds
    buffer_load_dwordx4 v127, s[8:11], s40 offen offset:2048 lds
    buffer_load_dwordx4 v127, s[8:11], s40 offen offset:3072 lds
    s_and_b32 s22, s2, 7
    s_lshr_b32 s23, s2, 3
    s_lshl_b32 s22, s22, 2
    s_and_b32 s27, s23, 3
    s_add_u32 s22, s22, s27
    s_lshr_b32 s23, s23, 2
    s_lshl_b32 s22, s22, 2
    s_add_u32 s22, s22, s17
    s_mul_i32 s96, s23, 160
    s_mul_i32 s27, s22, 20480
    s_add_u32 s88, s27, 0x100000
    s_lshl_b32 s56, s18, 11
    s_add_u32 s65, s88, s56
    s_add_u32 s65, s65, 16384
    s_lshl_b32 s56, s18, 13
    s_add_u32 s88, s88, s56
    s_add_u32 s3, s88, 4096
    s_add_u32 s94, s27, s96
    s_mul_i32 s95, s23, 320
    s_add_u32 s95, s95, 0x11400
    s_lshr_b32 s27, s22, 1
    s_mul_i32 s27, s27, 40960
    s_and_b32 s56, s22, 1
    s_lshl_b32 s56, s56, 8
    s_add_u32 s27, s27, s56
    s_mul_i32 s56, s23, 5120
    s_add_u32 s27, s27, s56
    s_add_u32 s89, s27, 0x400000
    s_add_u32 s56, s27, 0xf00000
    s_add_u32 s57, s56, 4096
    s_add_u32 s90, s89, 4096
    s_lshl_b32 s91, s23, 14
    s_lshl_b32 s27, s22, 7
    s_add_u32 s91, s91, s27
    s_add_u32 s91, s91, 0x20000
    s_movk_i32 s27, 1120
    v_add_u32 v137, 0, v0
    v_mul_u32_u24 v138, 6554, v137
    v_lshrrev_b32 v138, 16, v138
    v_lshlrev_b32 v137, 4, v137
    v_mad_u32_u24 v128, v138, s27, v137
    v_add_u32 v137, 512, v0
    v_mul_u32_u24 v138, 6554, v137
    v_lshrrev_b32 v138, 16, v138
    v_lshlrev_b32 v137, 4, v137
    v_mad_u32_u24 v129, v138, s27, v137
    v_add_u32 v137, 1024, v0
    v_mul_u32_u24 v138, 6554, v137
    v_lshrrev_b32 v138, 16, v138
    v_lshlrev_b32 v137, 4, v137
    v_mad_u32_u24 v130, v138, s27, v137
    v_add_u32 v137, 1536, v0
    v_mul_u32_u24 v138, 6554, v137
    v_lshrrev_b32 v138, 16, v138
    v_lshlrev_b32 v137, 4, v137
    v_mad_u32_u24 v131, v138, s27, v137
    v_add_u32 v137, 2048, v0
    v_mul_u32_u24 v138, 6554, v137
    v_lshrrev_b32 v138, 16, v138
    v_lshlrev_b32 v137, 4, v137
    v_mad_u32_u24 v132, v138, s27, v137
    v_and_b32 v136, 15, v0
    v_bfe_u32 v137, v0, 4, 2
    v_mul_u32_u24 v168, 1280, v136
    v_lshl_add_u32 v168, v137, 3, v168
    v_add_u32 v169, 4800, v127
    v_cmp_le_u32 vcc, 320, v127
    s_nop 1
    v_cndmask_b32 v169, v127, v169, vcc
    s_waitcnt vmcnt(4)
    ds_read_b64_tr_b16 v[4:5], v125
    ds_read_b64_tr_b16 v[6:7], v125 offset:64
    ds_read_b64_tr_b16 v[8:9], v125 offset:128
    s_waitcnt lgkmcnt(0)
    s_mov_b32 exec_hi, 0
    v_mov_b32 v8, 0
    v_mov_b32 v9, 0
    s_mov_b64 exec, -1
    s_waitcnt vmcnt(0)
    s_barrier
    ds_read_b64_tr_b16 v[10:11], v121 offset:38400
    ds_read_b64_tr_b16 v[12:13], v121 offset:38464
    ds_read_b64_tr_b16 v[14:15], v121 offset:38528
    ds_read_b64_tr_b16 v[16:17], v121 offset:35840
    ds_read_b64_tr_b16 v[18:19], v121 offset:35904
    ds_read_b64_tr_b16 v[20:21], v121 offset:35968
    s_mov_b64 exec, s[36:37]
    ds_read_b128 v[24:27], v124 offset:38400
    ds_read_b128 v[28:31], v124 offset:39040
    s_mov_b64 exec, -1
    s_waitcnt lgkmcnt(5)
    v_mfma_f32_32x32x16_bf16 v[80:95], v[10:13], v[4:7], 0
    v_mfma_f32_32x32x8bf16_1k v[80:95], v[14:15], v[8:9], v[80:95]
    s_nop 11
    v_max3_f32 v125, v80, v81, v82
    v_max_f32 v125, v125, v83
    v_max3_f32 v125, v125, v84, v85
    v_max3_f32 v125, v125, v86, v87
    v_max3_f32 v125, v125, v88, v89
    v_max3_f32 v125, v125, v90, v91
    v_max3_f32 v125, v125, v92, v93
    v_max3_f32 v125, v125, v94, v95
    v_mov_b32 v136, v125
    s_nop 1
    v_permlane32_swap_b32 v125, v136
    v_max_f32 v125, v125, v136
    v_sub_f32 v48, 0, v125
    v_sub_f32 v49, 0, v125
    v_sub_f32 v50, 0, v125
    v_sub_f32 v51, 0, v125
    v_sub_f32 v52, 0, v125
    v_sub_f32 v53, 0, v125
    v_sub_f32 v54, 0, v125
    v_sub_f32 v55, 0, v125
    v_sub_f32 v56, 0, v125
    v_sub_f32 v57, 0, v125
    v_sub_f32 v58, 0, v125
    v_sub_f32 v59, 0, v125
    v_sub_f32 v60, 0, v125
    v_sub_f32 v61, 0, v125
    v_sub_f32 v62, 0, v125
    v_sub_f32 v63, 0, v125
    s_nop 1
    v_mfma_f32_32x32x16_bf16 v[80:95], v[10:13], v[4:7], v[48:63]
    v_mfma_f32_32x32x8bf16_1k v[80:95], v[14:15], v[8:9], v[80:95]
    s_setprio 3
    s_waitcnt lgkmcnt(0)
    v_mfma_f32_32x32x16_bf16 v[96:111], v[16:19], v[4:7], v[48:63]
    ds_read_b64_tr_b16 v[10:11], v121 offset:33280
    ds_read_b64_tr_b16 v[12:13], v121 offset:33344
    ds_read_b64_tr_b16 v[14:15], v121 offset:33408
    s_nop 5
    v_exp_f32 v80, v80
    v_exp_f32 v81, v81
    v_exp_f32 v82, v82
    v_exp_f32 v83, v83
    s_mov_b64 exec, s[36:37]
    ds_read_b128 v[32:35], v124 offset:35840
    ds_read_b128 v[36:39], v124 offset:36480
    s_mov_b64 exec, -1
    v_exp_f32 v84, v84
    v_exp_f32 v85, v85
    v_exp_f32 v86, v86
    v_exp_f32 v87, v87
    v_mfma_f32_32x32x8bf16_1k v[96:111], v[20:21], v[8:9], v[96:111]
    v_cvt_pk_bf16_f32 v40, v80, v81
    v_cvt_pk_bf16_f32 v41, v82, v83
    v_cvt_pk_bf16_f32 v42, v84, v85
    v_cvt_pk_bf16_f32 v43, v86, v87
    s_sub_u32 s39, s39, 32768
    s_sub_u32 s40, s40, 32768
    s_mov_b32 m0, s39
    s_nop 0
    buffer_load_dwordx4 v127, s[8:11], s40 offen offset:0 lds
    buffer_load_dwordx4 v127, s[8:11], s40 offen offset:1024 lds
    v_exp_f32 v88, v88
    v_exp_f32 v89, v89
    v_exp_f32 v90, v90
    v_exp_f32 v91, v91
    v_mfma_f32_32x32x16_bf16 v[64:79], v[24:27], v[40:43], v[64:79]
    buffer_load_dwordx4 v127, s[8:11], s40 offen offset:2048 lds
    v_exp_f32 v92, v92
    v_exp_f32 v93, v93
    v_exp_f32 v94, v94
    v_exp_f32 v95, v95
    v_cvt_pk_bf16_f32 v44, v88, v89
    v_cvt_pk_bf16_f32 v45, v90, v91
    v_cvt_pk_bf16_f32 v46, v92, v93
    v_cvt_pk_bf16_f32 v47, v94, v95
    s_setprio 2
    s_waitcnt lgkmcnt(0)
    v_mfma_f32_32x32x16_bf16 v[80:95], v[10:13], v[4:7], v[48:63]
    ds_read_b64_tr_b16 v[16:17], v121 offset:30720
    ds_read_b64_tr_b16 v[18:19], v121 offset:30784
    ds_read_b64_tr_b16 v[20:21], v121 offset:30848
    v_exp_f32 v96, v96
    v_exp_f32 v97, v97
    v_exp_f32 v98, v98
    v_exp_f32 v99, v99
    v_mfma_f32_32x32x16_bf16 v[64:79], v[28:31], v[44:47], v[64:79]
    s_mov_b64 exec, s[36:37]
    ds_read_b128 v[24:27], v124 offset:33280
    ds_read_b128 v[28:31], v124 offset:33920
    s_mov_b64 exec, -1
    v_exp_f32 v100, v100
    v_exp_f32 v101, v101
    v_exp_f32 v102, v102
    v_exp_f32 v103, v103
    v_mfma_f32_32x32x8bf16_1k v[80:95], v[14:15], v[8:9], v[80:95]
    v_cvt_pk_bf16_f32 v40, v96, v97
    v_cvt_pk_bf16_f32 v41, v98, v99
    v_cvt_pk_bf16_f32 v42, v100, v101
    v_cvt_pk_bf16_f32 v43, v102, v103
    buffer_load_dwordx4 v127, s[8:11], s40 offen offset:3072 lds
    s_sub_u32 s39, s39, 32768
    s_sub_u32 s40, s40, 32768
    s_mov_b32 m0, s39
    s_nop 0
    buffer_load_dwordx4 v127, s[8:11], s40 offen offset:0 lds
    v_exp_f32 v104, v104
    v_exp_f32 v105, v105
    v_exp_f32 v106, v106
    v_exp_f32 v107, v107
    v_mfma_f32_32x32x16_bf16 v[64:79], v[32:35], v[40:43], v[64:79]
    buffer_load_dwordx4 v127, s[8:11], s40 offen offset:1024 lds
    v_exp_f32 v108, v108
    v_exp_f32 v109, v109
    v_exp_f32 v110, v110
    v_exp_f32 v111, v111
    v_cvt_pk_bf16_f32 v44, v104, v105
    v_cvt_pk_bf16_f32 v45, v106, v107
    v_cvt_pk_bf16_f32 v46, v108, v109
    v_cvt_pk_bf16_f32 v47, v110, v111
    s_setprio 1
    s_waitcnt lgkmcnt(0)
    v_mfma_f32_32x32x16_bf16 v[96:111], v[16:19], v[4:7], v[48:63]
    ds_read_b64_tr_b16 v[10:11], v121 offset:28160
    ds_read_b64_tr_b16 v[12:13], v121 offset:28224
    ds_read_b64_tr_b16 v[14:15], v121 offset:28288
    v_exp_f32 v80, v80
    v_exp_f32 v81, v81
    v_exp_f32 v82, v82
    v_exp_f32 v83, v83
    v_mfma_f32_32x32x16_bf16 v[64:79], v[36:39], v[44:47], v[64:79]
    s_mov_b64 exec, s[36:37]
    ds_read_b128 v[32:35], v124 offset:30720
    ds_read_b128 v[36:39], v124 offset:31360
    s_mov_b64 exec, -1
    v_exp_f32 v84, v84
    v_exp_f32 v85, v85
    v_exp_f32 v86, v86
    v_exp_f32 v87, v87
    v_mfma_f32_32x32x8bf16_1k v[96:111], v[20:21], v[8:9], v[96:111]
    v_cvt_pk_bf16_f32 v40, v80, v81
    v_cvt_pk_bf16_f32 v41, v82, v83
    v_cvt_pk_bf16_f32 v42, v84, v85
    v_cvt_pk_bf16_f32 v43, v86, v87
    buffer_load_dwordx4 v127, s[8:11], s40 offen offset:2048 lds
    buffer_load_dwordx4 v127, s[8:11], s40 offen offset:3072 lds
    v_exp_f32 v88, v88
    v_exp_f32 v89, v89
    v_exp_f32 v90, v90
    v_exp_f32 v91, v91
    v_mfma_f32_32x32x16_bf16 v[64:79], v[24:27], v[40:43], v[64:79]
    s_sub_u32 s39, s39, 32768
    s_sub_u32 s40, s40, 32768
    s_mov_b32 m0, s39
    s_nop 0
    buffer_load_dwordx4 v127, s[8:11], s40 offen offset:0 lds
    v_exp_f32 v92, v92
    v_exp_f32 v93, v93
    v_exp_f32 v94, v94
    v_exp_f32 v95, v95
    v_cvt_pk_bf16_f32 v44, v88, v89
    v_cvt_pk_bf16_f32 v45, v90, v91
    v_cvt_pk_bf16_f32 v46, v92, v93
    v_cvt_pk_bf16_f32 v47, v94, v95
    s_setprio 0
    s_waitcnt lgkmcnt(0)
    v_mfma_f32_32x32x16_bf16 v[80:95], v[10:13], v[4:7], v[48:63]
    ds_read_b64_tr_b16 v[16:17], v121 offset:25600
    ds_read_b64_tr_b16 v[18:19], v121 offset:25664
    ds_read_b64_tr_b16 v[20:21], v121 offset:25728
    v_exp_f32 v96, v96
    v_exp_f32 v97, v97
    v_exp_f32 v98, v98
    v_exp_f32 v99, v99
    v_mfma_f32_32x32x16_bf16 v[64:79], v[28:31], v[44:47], v[64:79]
    s_mov_b64 exec, s[36:37]
    ds_read_b128 v[24:27], v124 offset:28160
    ds_read_b128 v[28:31], v124 offset:28800
    s_mov_b64 exec, -1
    v_exp_f32 v100, v100
    v_exp_f32 v101, v101
    v_exp_f32 v102, v102
    v_exp_f32 v103, v103
    v_mfma_f32_32x32x8bf16_1k v[80:95], v[14:15], v[8:9], v[80:95]
    v_cvt_pk_bf16_f32 v40, v96, v97
    v_cvt_pk_bf16_f32 v41, v98, v99
    v_cvt_pk_bf16_f32 v42, v100, v101
    v_cvt_pk_bf16_f32 v43, v102, v103
    buffer_load_dwordx4 v127, s[8:11], s40 offen offset:1024 lds
    buffer_load_dwordx4 v127, s[8:11], s40 offen offset:2048 lds
    v_exp_f32 v104, v104
    v_exp_f32 v105, v105
    v_exp_f32 v106, v106
    v_exp_f32 v107, v107
    v_mfma_f32_32x32x16_bf16 v[64:79], v[32:35], v[40:43], v[64:79]
    buffer_load_dwordx4 v127, s[8:11], s40 offen offset:3072 lds
    v_exp_f32 v108, v108
    v_exp_f32 v109, v109
    v_exp_f32 v110, v110
    v_exp_f32 v111, v111
    v_cvt_pk_bf16_f32 v44, v104, v105
    v_cvt_pk_bf16_f32 v45, v106, v107
    v_cvt_pk_bf16_f32 v46, v108, v109
    v_cvt_pk_bf16_f32 v47, v110, v111
    s_setprio 3
    s_waitcnt lgkmcnt(0)
    v_mfma_f32_32x32x16_bf16 v[96:111], v[16:19], v[4:7], v[48:63]
    ds_read_b64_tr_b16 v[10:11], v121 offset:23040
    ds_read_b64_tr_b16 v[12:13], v121 offset:23104
    ds_read_b64_tr_b16 v[14:15], v121 offset:23168
    v_exp_f32 v80, v80
    v_exp_f32 v81, v81
    v_exp_f32 v82, v82
    v_exp_f32 v83, v83
    v_mfma_f32_32x32x16_bf16 v[64:79], v[36:39], v[44:47], v[64:79]
    s_mov_b64 exec, s[36:37]
    ds_read_b128 v[32:35], v124 offset:25600
    ds_read_b128 v[36:39], v124 offset:26240
    s_mov_b64 exec, -1
    v_exp_f32 v84, v84
    v_exp_f32 v85, v85
    v_exp_f32 v86, v86
    v_exp_f32 v87, v87
    v_mfma_f32_32x32x8bf16_1k v[96:111], v[20:21], v[8:9], v[96:111]
    v_cvt_pk_bf16_f32 v40, v80, v81
    v_cvt_pk_bf16_f32 v41, v82, v83
    v_cvt_pk_bf16_f32 v42, v84, v85
    v_cvt_pk_bf16_f32 v43, v86, v87
    s_sub_u32 s39, s39, 32768
    s_sub_u32 s40, s40, 32768
    s_mov_b32 m0, s39
    s_nop 0
    buffer_load_dwordx4 v127, s[8:11], s40 offen offset:0 lds
    v_exp_f32 v88, v88
    v_exp_f32 v89, v89
    v_exp_f32 v90, v90
    v_exp_f32 v91, v91
    v_mfma_f32_32x32x16_bf16 v[64:79], v[24:27], v[40:43], v[64:79]
    buffer_load_dwordx4 v127, s[8:11], s40 offen offset:1024 lds
    v_exp_f32 v92, v92
    v_exp_f32 v93, v93
    v_exp_f32 v94, v94
    v_exp_f32 v95, v95
    v_cvt_pk_bf16_f32 v44, v88, v89
    v_cvt_pk_bf16_f32 v45, v90, v91
    v_cvt_pk_bf16_f32 v46, v92, v93
    v_cvt_pk_bf16_f32 v47, v94, v95
    s_setprio 2
    s_waitcnt lgkmcnt(0)
    v_mfma_f32_32x32x16_bf16 v[80:95], v[10:13], v[4:7], v[48:63]
    ds_read_b64_tr_b16 v[16:17], v121 offset:20480
    ds_read_b64_tr_b16 v[18:19], v121 offset:20544
    ds_read_b64_tr_b16 v[20:21], v121 offset:20608
    v_exp_f32 v96, v96
    v_exp_f32 v97, v97
    v_exp_f32 v98, v98
    v_exp_f32 v99, v99
    v_mfma_f32_32x32x16_bf16 v[64:79], v[28:31], v[44:47], v[64:79]
    s_mov_b64 exec, s[36:37]
    ds_read_b128 v[24:27], v124 offset:23040
    ds_read_b128 v[28:31], v124 offset:23680
    s_mov_b64 exec, -1
    v_exp_f32 v100, v100
    v_exp_f32 v101, v101
    v_exp_f32 v102, v102
    v_exp_f32 v103, v103
    v_mfma_f32_32x32x8bf16_1k v[80:95], v[14:15], v[8:9], v[80:95]
    v_cvt_pk_bf16_f32 v40, v96, v97
    v_cvt_pk_bf16_f32 v41, v98, v99
    v_cvt_pk_bf16_f32 v42, v100, v101
    v_cvt_pk_bf16_f32 v43, v102, v103
    buffer_load_dwordx4 v127, s[8:11], s40 offen offset:2048 lds
    v_exp_f32 v104, v104
    v_exp_f32 v105, v105
    v_exp_f32 v106, v106
    v_exp_f32 v107, v107
    v_mfma_f32_32x32x16_bf16 v[64:79], v[32:35], v[40:43], v[64:79]
    buffer_load_dwordx4 v127, s[8:11], s40 offen offset:3072 lds
    v_exp_f32 v108, v108
    v_exp_f32 v109, v109
    v_exp_f32 v110, v110
    v_exp_f32 v111, v111
    v_cvt_pk_bf16_f32 v44, v104, v105
    v_cvt_pk_bf16_f32 v45, v106, v107
    v_cvt_pk_bf16_f32 v46, v108, v109
    v_cvt_pk_bf16_f32 v47, v110, v111
    s_setprio 1
    s_waitcnt lgkmcnt(0)
    v_mfma_f32_32x32x16_bf16 v[96:111], v[16:19], v[4:7], v[48:63]
    ds_read_b64_tr_b16 v[10:11], v121 offset:17920
    ds_read_b64_tr_b16 v[12:13], v121 offset:17984
    ds_read_b64_tr_b16 v[14:15], v121 offset:18048
    v_exp_f32 v80, v80
    v_exp_f32 v81, v81
    v_exp_f32 v82, v82
    v_exp_f32 v83, v83
    v_mfma_f32_32x32x16_bf16 v[64:79], v[36:39], v[44:47], v[64:79]
    s_mov_b64 exec, s[36:37]
    ds_read_b128 v[32:35], v124 offset:20480
    ds_read_b128 v[36:39], v124 offset:21120
    s_mov_b64 exec, -1
    v_exp_f32 v84, v84
    v_exp_f32 v85, v85
    v_exp_f32 v86, v86
    v_exp_f32 v87, v87
    v_mfma_f32_32x32x8bf16_1k v[96:111], v[20:21], v[8:9], v[96:111]
    v_cvt_pk_bf16_f32 v40, v80, v81
    v_cvt_pk_bf16_f32 v41, v82, v83
    v_cvt_pk_bf16_f32 v42, v84, v85
    v_cvt_pk_bf16_f32 v43, v86, v87
    s_and_b32 s58, s2, 7
    s_lshl_b32 s58, s58, 5
    s_lshr_b32 s60, s2, 3
    s_add_u32 s58, s58, s60
    s_lshl_b32 s99, s58, 15
    s_lshl_b32 s60, s16, 9
    s_add_u32 s99, s99, s60
    v_and_b32 v136, 7, v126
    v_lshrrev_b32 v137, 3, v126
    v_lshlrev_b32 v116, 12, v136
    v_lshl_add_u32 v116, v137, 4, v116
    v_lshlrev_b32 v117, 4, v136
    v_lshl_add_u32 v117, v137, 9, v117
    s_lshr_b32 s100, s58, 3
    s_lshl_b32 s100, s100, 3
    s_add_u32 s100, s100, s16
    s_lshl_b32 s100, s100, 15
    s_bfe_u32 s60, s2, 0x10005
    s_lshl_b32 s60, s60, 13
    s_add_u32 s100, s100, s60
    s_bfe_u32 s60, s2, 0x20003
    s_lshl_b32 s60, s60, 7
    s_add_u32 s100, s100, s60
    s_add_u32 s100, s100, 0x2800000
    v_exp_f32 v88, v88
    v_exp_f32 v89, v89
    v_exp_f32 v90, v90
    v_exp_f32 v91, v91
    v_mfma_f32_32x32x16_bf16 v[64:79], v[24:27], v[40:43], v[64:79]
    v_exp_f32 v92, v92
    v_exp_f32 v93, v93
    v_exp_f32 v94, v94
    v_exp_f32 v95, v95
    v_cvt_pk_bf16_f32 v44, v88, v89
    v_cvt_pk_bf16_f32 v45, v90, v91
    v_cvt_pk_bf16_f32 v46, v92, v93
    v_cvt_pk_bf16_f32 v47, v94, v95
    s_setprio 0
    s_waitcnt lgkmcnt(0)
    v_mfma_f32_32x32x16_bf16 v[80:95], v[10:13], v[4:7], v[48:63]
    ds_read_b64_tr_b16 v[16:17], v121 offset:15360
    ds_read_b64_tr_b16 v[18:19], v121 offset:15424
    ds_read_b64_tr_b16 v[20:21], v121 offset:15488
    v_exp_f32 v96, v96
    v_exp_f32 v97, v97
    v_exp_f32 v98, v98
    v_exp_f32 v99, v99
    v_mfma_f32_32x32x16_bf16 v[64:79], v[28:31], v[44:47], v[64:79]
    s_mov_b64 exec, s[36:37]
    ds_read_b128 v[24:27], v124 offset:17920
    ds_read_b128 v[28:31], v124 offset:18560
    s_mov_b64 exec, -1
    v_exp_f32 v100, v100
    v_exp_f32 v101, v101
    v_exp_f32 v102, v102
    v_exp_f32 v103, v103
    v_mfma_f32_32x32x8bf16_1k v[80:95], v[14:15], v[8:9], v[80:95]
    v_cvt_pk_bf16_f32 v40, v96, v97
    v_cvt_pk_bf16_f32 v41, v98, v99
    v_cvt_pk_bf16_f32 v42, v100, v101
    v_cvt_pk_bf16_f32 v43, v102, v103
    v_lshlrev_b32 v134, 7, v126
    s_max_u32 s58, s98, 120
    s_sub_u32 s58, s58, 120
    s_lshl_b32 s60, s58, 6
    v_add_u32 v136, s60, v126
    v_mul_u32_u24 v137, 6554, v136
    v_lshrrev_b32 v137, 16, v137
    v_lshlrev_b32 v136, 4, v136
    s_movk_i32 s60, 1120
    v_mad_u32_u24 v118, v137, s60, v136
    s_and_b32 s43, s2, 7
    s_mul_i32 s101, s43, 160
    s_mul_i32 s43, s43, 136
    s_add_u32 s43, s43, s58
    s_lshl_b32 s43, s43, 10
    s_add_u32 s43, s43, 0x2100000
    s_lshl_b32 s62, s16, 10
    s_add_u32 s62, s62, 57344
    s_and_b32 s97, s2, 7
    v_exp_f32 v104, v104
    v_exp_f32 v105, v105
    v_exp_f32 v106, v106
    v_exp_f32 v107, v107
    v_mfma_f32_32x32x16_bf16 v[64:79], v[32:35], v[40:43], v[64:79]
    v_exp_f32 v108, v108
    v_exp_f32 v109, v109
    v_exp_f32 v110, v110
    v_exp_f32 v111, v111
    v_cvt_pk_bf16_f32 v44, v104, v105
    v_cvt_pk_bf16_f32 v45, v106, v107
    v_cvt_pk_bf16_f32 v46, v108, v109
    v_cvt_pk_bf16_f32 v47, v110, v111
    s_setprio 3
    s_waitcnt lgkmcnt(0)
    s_waitcnt vmcnt(0)
    s_barrier
    s_cmp_lg_u32 s16, 7
    s_cbranch_scc1 L_cnt_21
    v_mov_b32 v135, 1
    s_mov_b32 s58, 0x78000
    s_mov_b64 exec, 1
    buffer_atomic_add v135, off, s[8:11], s58 sc1
    s_mov_b64 exec, -1
L_cnt_21:
    v_mfma_f32_32x32x16_bf16 v[96:111], v[16:19], v[4:7], v[48:63]
    ds_read_b64_tr_b16 v[10:11], v121 offset:12800
    ds_read_b64_tr_b16 v[12:13], v121 offset:12864
    ds_read_b64_tr_b16 v[14:15], v121 offset:12928
    v_exp_f32 v80, v80
    v_exp_f32 v81, v81
    v_exp_f32 v82, v82
    v_exp_f32 v83, v83
    v_mfma_f32_32x32x16_bf16 v[64:79], v[36:39], v[44:47], v[64:79]
    s_mov_b64 exec, s[36:37]
    ds_read_b128 v[32:35], v124 offset:15360
    ds_read_b128 v[36:39], v124 offset:16000
    s_mov_b64 exec, -1
    v_exp_f32 v84, v84
    v_exp_f32 v85, v85
    v_exp_f32 v86, v86
    v_exp_f32 v87, v87
    v_mfma_f32_32x32x8bf16_1k v[96:111], v[20:21], v[8:9], v[96:111]
    v_cvt_pk_bf16_f32 v40, v80, v81
    v_cvt_pk_bf16_f32 v41, v82, v83
    v_cvt_pk_bf16_f32 v42, v84, v85
    v_cvt_pk_bf16_f32 v43, v86, v87
    s_cmp_lg_u32 s18, 0
    s_cbranch_scc1 L_j_22
    buffer_load_dwordx4 v[208:211], v116, s[48:51], s99 offen offset:0
L_j_22:
    v_exp_f32 v88, v88
    v_exp_f32 v89, v89
    v_exp_f32 v90, v90
    v_exp_f32 v91, v91
    v_mfma_f32_32x32x16_bf16 v[64:79], v[24:27], v[40:43], v[64:79]
    v_exp_f32 v92, v92
    v_exp_f32 v93, v93
    v_exp_f32 v94, v94
    v_exp_f32 v95, v95
    v_cvt_pk_bf16_f32 v44, v88, v89
    v_cvt_pk_bf16_f32 v45, v90, v91
    v_cvt_pk_bf16_f32 v46, v92, v93
    v_cvt_pk_bf16_f32 v47, v94, v95
    s_setprio 2
    s_waitcnt lgkmcnt(0)
    v_mfma_f32_32x32x16_bf16 v[80:95], v[10:13], v[4:7], v[48:63]
    ds_read_b64_tr_b16 v[16:17], v121 offset:10240
    ds_read_b64_tr_b16 v[18:19], v121 offset:10304
    ds_read_b64_tr_b16 v[20:21], v121 offset:10368
    v_exp_f32 v96, v96
    v_exp_f32 v97, v97
    v_exp_f32 v98, v98
    v_exp_f32 v99, v99
    v_mfma_f32_32x32x16_bf16 v[64:79], v[28:31], v[44:47], v[64:79]
    s_mov_b64 exec, s[36:37]
    ds_read_b128 v[24:27], v124 offset:12800
    ds_read_b128 v[28:31], v124 offset:13440
    s_mov_b64 exec, -1
    v_exp_f32 v100, v100
    v_exp_f32 v101, v101
    v_exp_f32 v102, v102
    v_exp_f32 v103, v103
    v_mfma_f32_32x32x8bf16_1k v[80:95], v[14:15], v[8:9], v[80:95]
    v_cvt_pk_bf16_f32 v40, v96, v97
    v_cvt_pk_bf16_f32 v41, v98, v99
    v_cvt_pk_bf16_f32 v42, v100, v101
    v_cvt_pk_bf16_f32 v43, v102, v103
    s_cmp_lg_u32 s18, 1
    s_cbranch_scc1 L_j_23
    buffer_load_dwordx4 v[208:211], v116, s[48:51], s99 offen offset:0
L_j_23:
    v_exp_f32 v104, v104
    v_exp_f32 v105, v105
    v_exp_f32 v106, v106
    v_exp_f32 v107, v107
    v_mfma_f32_32x32x16_bf16 v[64:79], v[32:35], v[40:43], v[64:79]
    v_exp_f32 v108, v108
    v_exp_f32 v109, v109
    v_exp_f32 v110, v110
    v_exp_f32 v111, v111
    v_cvt_pk_bf16_f32 v44, v104, v105
    v_cvt_pk_bf16_f32 v45, v106, v107
    v_cvt_pk_bf16_f32 v46, v108, v109
    v_cvt_pk_bf16_f32 v47, v110, v111
    s_setprio 1
    s_waitcnt lgkmcnt(0)
    v_mfma_f32_32x32x16_bf16 v[96:111], v[16:19], v[4:7], v[48:63]
    ds_read_b64_tr_b16 v[10:11], v121 offset:7680
    ds_read_b64_tr_b16 v[12:13], v121 offset:7744
    ds_read_b64_tr_b16 v[14:15], v121 offset:7808
    v_exp_f32 v80, v80
    v_exp_f32 v81, v81
    v_exp_f32 v82, v82
    v_exp_f32 v83, v83
    v_mfma_f32_32x32x16_bf16 v[64:79], v[36:39], v[44:47], v[64:79]
    s_mov_b64 exec, s[36:37]
    ds_read_b128 v[32:35], v124 offset:10240
    ds_read_b128 v[36:39], v124 offset:10880
    s_mov_b64 exec, -1
    v_exp_f32 v84, v84
    v_exp_f32 v85, v85
    v_exp_f32 v86, v86
    v_exp_f32 v87, v87
    v_mfma_f32_32x32x8bf16_1k v[96:111], v[20:21], v[8:9], v[96:111]
    v_cvt_pk_bf16_f32 v40, v80, v81
    v_cvt_pk_bf16_f32 v41, v82, v83
    v_cvt_pk_bf16_f32 v42, v84, v85
    v_cvt_pk_bf16_f32 v43, v86, v87
    s_cmp_lg_u32 s18, 0
    s_cbranch_scc1 L_j_24
    buffer_load_dwordx4 v[212:215], v116, s[48:51], s99 offen offset:128
L_j_24:
    v_exp_f32 v88, v88
    v_exp_f32 v89, v89
    v_exp_f32 v90, v90
    v_exp_f32 v91, v91
    v_mfma_f32_32x32x16_bf16 v[64:79], v[24:27], v[40:43], v[64:79]
    v_exp_f32 v92, v92
    v_exp_f32 v93, v93
    v_exp_f32 v94, v94
    v_exp_f32 v95, v95
    v_cvt_pk_bf16_f32 v44, v88, v89
    v_cvt_pk_bf16_f32 v45, v90, v91
    v_cvt_pk_bf16_f32 v46, v92, v93
    v_cvt_pk_bf16_f32 v47, v94, v95
    s_setprio 0
    s_waitcnt lgkmcnt(0)
    v_mfma_f32_32x32x16_bf16 v[80:95], v[10:13], v[4:7], v[48:63]
    ds_read_b64_tr_b16 v[16:17], v121 offset:5120
    ds_read_b64_tr_b16 v[18:19], v121 offset:5184
    ds_read_b64_tr_b16 v[20:21], v121 offset:5248
    v_exp_f32 v96, v96
    v_exp_f32 v97, v97
    v_exp_f32 v98, v98
    v_exp_f32 v99, v99
    v_mfma_f32_32x32x16_bf16 v[64:79], v[28:31], v[44:47], v[64:79]
    s_mov_b64 exec, s[36:37]
    ds_read_b128 v[24:27], v124 offset:7680
    ds_read_b128 v[28:31], v124 offset:8320
    s_mov_b64 exec, -1
    v_exp_f32 v100, v100
    v_exp_f32 v101, v101
    v_exp_f32 v102, v102
    v_exp_f32 v103, v103
    v_mfma_f32_32x32x8bf16_1k v[80:95], v[14:15], v[8:9], v[80:95]
    v_cvt_pk_bf16_f32 v40, v96, v97
    v_cvt_pk_bf16_f32 v41, v98, v99
    v_cvt_pk_bf16_f32 v42, v100, v101
    v_cvt_pk_bf16_f32 v43, v102, v103
    s_cmp_lg_u32 s18, 1
    s_cbranch_scc1 L_j_25
    buffer_load_dwordx4 v[212:215], v116, s[48:51], s99 offen offset:128
L_j_25:
    v_exp_f32 v104, v104
    v_exp_f32 v105, v105
    v_exp_f32 v106, v106
    v_exp_f32 v107, v107
    v_mfma_f32_32x32x16_bf16 v[64:79], v[32:35], v[40:43], v[64:79]
    v_exp_f32 v108, v108
    v_exp_f32 v109, v109
    v_exp_f32 v110, v110
    v_exp_f32 v111, v111
    v_cvt_pk_bf16_f32 v44, v104, v105
    v_cvt_pk_bf16_f32 v45, v106, v107
    v_cvt_pk_bf16_f32 v46, v108, v109
    v_cvt_pk_bf16_f32 v47, v110, v111
    s_setprio 3
    s_waitcnt lgkmcnt(0)
    v_mfma_f32_32x32x16_bf16 v[96:111], v[16:19], v[4:7], v[48:63]
    ds_read_b64_tr_b16 v[10:11], v121 offset:2560
    ds_read_b64_tr_b16 v[12:13], v121 offset:2624
    ds_read_b64_tr_b16 v[14:15], v121 offset:2688
    v_exp_f32 v80, v80
    v_exp_f32 v81, v81
    v_exp_f32 v82, v82
    v_exp_f32 v83, v83
    v_mfma_f32_32x32x16_bf16 v[64:79], v[36:39], v[44:47], v[64:79]
    s_mov_b64 exec, s[36:37]
    ds_read_b128 v[32:35], v124 offset:5120
    ds_read_b128 v[36:39], v124 offset:5760
    s_mov_b64 exec, -1
    v_exp_f32 v84, v84
    v_exp_f32 v85, v85
    v_exp_f32 v86, v86
    v_exp_f32 v87, v87
    v_mfma_f32_32x32x8bf16_1k v[96:111], v[20:21], v[8:9], v[96:111]
    v_cvt_pk_bf16_f32 v40, v80, v81
    v_cvt_pk_bf16_f32 v41, v82, v83
    v_cvt_pk_bf16_f32 v42, v84, v85
    v_cvt_pk_bf16_f32 v43, v86, v87
    s_cmp_lg_u32 s18, 0
    s_cbranch_scc1 L_j_26
    buffer_load_dwordx4 v[216:219], v116, s[48:51], s99 offen offset:256
L_j_26:
    v_exp_f32 v88, v88
    v_exp_f32 v89, v89
    v_exp_f32 v90, v90
    v_exp_f32 v91, v91
    v_mfma_f32_32x32x16_bf16 v[64:79], v[24:27], v[40:43], v[64:79]
    v_exp_f32 v92, v92
    v_exp_f32 v93, v93
    v_exp_f32 v94, v94
    v_exp_f32 v95, v95
    v_cvt_pk_bf16_f32 v44, v88, v89
    v_cvt_pk_bf16_f32 v45, v90, v91
    v_cvt_pk_bf16_f32 v46, v92, v93
    v_cvt_pk_bf16_f32 v47, v94, v95
    s_setprio 2
    s_waitcnt lgkmcnt(0)
    v_mfma_f32_32x32x16_bf16 v[80:95], v[10:13], v[4:7], v[48:63]
    ds_read_b64_tr_b16 v[16:17], v121 offset:0
    ds_read_b64_tr_b16 v[18:19], v121 offset:64
    ds_read_b64_tr_b16 v[20:21], v121 offset:128
    v_exp_f32 v96, v96
    v_exp_f32 v97, v97
    v_exp_f32 v98, v98
    v_exp_f32 v99, v99
    v_mfma_f32_32x32x16_bf16 v[64:79], v[28:31], v[44:47], v[64:79]
    s_mov_b64 exec, s[36:37]
    ds_read_b128 v[24:27], v124 offset:2560
    ds_read_b128 v[28:31], v124 offset:3200
    s_mov_b64 exec, -1
    v_exp_f32 v100, v100
    v_exp_f32 v101, v101
    v_exp_f32 v102, v102
    v_exp_f32 v103, v103
    v_mfma_f32_32x32x8bf16_1k v[80:95], v[14:15], v[8:9], v[80:95]
    v_cvt_pk_bf16_f32 v40, v96, v97
    v_cvt_pk_bf16_f32 v41, v98, v99
    v_cvt_pk_bf16_f32 v42, v100, v101
    v_cvt_pk_bf16_f32 v43, v102, v103
    s_cmp_lg_u32 s18, 1
    s_cbranch_scc1 L_j_27
    buffer_load_dwordx4 v[216:219], v116, s[48:51], s99 offen offset:256
L_j_27:
    v_exp_f32 v104, v104
    v_exp_f32 v105, v105
    v_exp_f32 v106, v106
    v_exp_f32 v107, v107
    v_mfma_f32_32x32x16_bf16 v[64:79], v[32:35], v[40:43], v[64:79]
    v_exp_f32 v108, v108
    v_exp_f32 v109, v109
    v_exp_f32 v110, v110
    v_exp_f32 v111, v111
    v_cvt_pk_bf16_f32 v44, v104, v105
    v_cvt_pk_bf16_f32 v45, v106, v107
    v_cvt_pk_bf16_f32 v46, v108, v109
    v_cvt_pk_bf16_f32 v47, v110, v111
    s_setprio 1
    s_waitcnt lgkmcnt(0)
    v_mfma_f32_32x32x16_bf16 v[96:111], v[16:19], v[4:7], v[48:63]
    ds_read_b64_tr_b16 v[10:11], v120 offset:58880
    ds_read_b64_tr_b16 v[12:13], v120 offset:58944
    ds_read_b64_tr_b16 v[14:15], v120 offset:59008
    v_exp_f32 v80, v80
    v_exp_f32 v81, v81
    v_exp_f32 v82, v82
    v_exp_f32 v83, v83
    v_mfma_f32_32x32x16_bf16 v[64:79], v[36:39], v[44:47], v[64:79]
    s_mov_b64 exec, s[36:37]
    ds_read_b128 v[32:35], v124 offset:0
    ds_read_b128 v[36:39], v124 offset:640
    s_mov_b64 exec, -1
    v_exp_f32 v84, v84
    v_exp_f32 v85, v85
    v_exp_f32 v86, v86
    v_exp_f32 v87, v87
    v_mfma_f32_32x32x8bf16_1k v[96:111], v[20:21], v[8:9], v[96:111]
    v_cvt_pk_bf16_f32 v40, v80, v81
    v_cvt_pk_bf16_f32 v41, v82, v83
    v_cvt_pk_bf16_f32 v42, v84, v85
    v_cvt_pk_bf16_f32 v43, v86, v87
    s_cmp_lg_u32 s18, 0
    s_cbranch_scc1 L_j_28
    buffer_load_dwordx4 v[220:223], v116, s[48:51], s99 offen offset:384
L_j_28:
    v_exp_f32 v88, v88
    v_exp_f32 v89, v89
    v_exp_f32 v90, v90
    v_exp_f32 v91, v91
    v_mfma_f32_32x32x16_bf16 v[64:79], v[24:27], v[40:43], v[64:79]
    v_exp_f32 v92, v92
    v_exp_f32 v93, v93
    v_exp_f32 v94, v94
    v_exp_f32 v95, v95
    v_cvt_pk_bf16_f32 v44, v88, v89
    v_cvt_pk_bf16_f32 v45, v90, v91
    v_cvt_pk_bf16_f32 v46, v92, v93
    v_cvt_pk_bf16_f32 v47, v94, v95
    s_setprio 0
    s_waitcnt lgkmcnt(0)
    v_mfma_f32_32x32x16_bf16 v[80:95], v[10:13], v[4:7], v[48:63]
    ds_read_b64_tr_b16 v[16:17], v120 offset:56320
    ds_read_b64_tr_b16 v[18:19], v120 offset:56384
    ds_read_b64_tr_b16 v[20:21], v120 offset:56448
    v_exp_f32 v96, v96
    v_exp_f32 v97, v97
    v_exp_f32 v98, v98
    v_exp_f32 v99, v99
    v_mfma_f32_32x32x16_bf16 v[64:79], v[28:31], v[44:47], v[64:79]
    s_mov_b64 exec, s[36:37]
    ds_read_b128 v[24:27], v123 offset:58880
    ds_read_b128 v[28:31], v123 offset:59520
    s_mov_b64 exec, -1
    v_exp_f32 v100, v100
    v_exp_f32 v101, v101
    v_exp_f32 v102, v102
    v_exp_f32 v103, v103
    v_mfma_f32_32x32x8bf16_1k v[80:95], v[14:15], v[8:9], v[80:95]
    v_cvt_pk_bf16_f32 v40, v96, v97
    v_cvt_pk_bf16_f32 v41, v98, v99
    v_cvt_pk_bf16_f32 v42, v100, v101
    v_cvt_pk_bf16_f32 v43, v102, v103
    s_cmp_lg_u32 s18, 1
    s_cbranch_scc1 L_j_29
    buffer_load_dwordx4 v[220:223], v116, s[48:51], s99 offen offset:384
L_j_29:
    v_exp_f32 v104, v104
    v_exp_f32 v105, v105
    v_exp_f32 v106, v106
    v_exp_f32 v107, v107
    v_mfma_f32_32x32x16_bf16 v[64:79], v[32:35], v[40:43], v[64:79]
    v_exp_f32 v108, v108
    v_exp_f32 v109, v109
    v_exp_f32 v110, v110
    v_exp_f32 v111, v111
    v_cvt_pk_bf16_f32 v44, v104, v105
    v_cvt_pk_bf16_f32 v45, v106, v107
    v_cvt_pk_bf16_f32 v46, v108, v109
    v_cvt_pk_bf16_f32 v47, v110, v111
    s_setprio 3
    s_waitcnt lgkmcnt(0)
    v_mfma_f32_32x32x16_bf16 v[96:111], v[16:19], v[4:7], v[48:63]
    ds_read_b64_tr_b16 v[10:11], v120 offset:53760
    ds_read_b64_tr_b16 v[12:13], v120 offset:53824
    ds_read_b64_tr_b16 v[14:15], v120 offset:53888
    v_exp_f32 v80, v80
    v_exp_f32 v81, v81
    v_exp_f32 v82, v82
    v_exp_f32 v83, v83
    v_mfma_f32_32x32x16_bf16 v[64:79], v[36:39], v[44:47], v[64:79]
    s_mov_b64 exec, s[36:37]
    ds_read_b128 v[32:35], v123 offset:56320
    ds_read_b128 v[36:39], v123 offset:56960
    s_mov_b64 exec, -1
    v_exp_f32 v84, v84
    v_exp_f32 v85, v85
    v_exp_f32 v86, v86
    v_exp_f32 v87, v87
    v_mfma_f32_32x32x8bf16_1k v[96:111], v[20:21], v[8:9], v[96:111]
    v_cvt_pk_bf16_f32 v40, v80, v81
    v_cvt_pk_bf16_f32 v41, v82, v83
    v_cvt_pk_bf16_f32 v42, v84, v85
    v_cvt_pk_bf16_f32 v43, v86, v87
    s_cmp_lg_u32 s18, 0
    s_cbranch_scc1 L_j_30
    s_cmp_lt_u32 s98, 120
    s_cbranch_scc1 L_np_31
    buffer_load_dwordx4 v[112:115], v118, s[44:47], s101 offen
L_np_31:
L_j_30:
    v_exp_f32 v88, v88
    v_exp_f32 v89, v89
    v_exp_f32 v90, v90
    v_exp_f32 v91, v91
    v_mfma_f32_32x32x16_bf16 v[64:79], v[24:27], v[40:43], v[64:79]
    v_exp_f32 v92, v92
    v_exp_f32 v93, v93
    v_exp_f32 v94, v94
    v_exp_f32 v95, v95
    v_cvt_pk_bf16_f32 v44, v88, v89
    v_cvt_pk_bf16_f32 v45, v90, v91
    v_cvt_pk_bf16_f32 v46, v92, v93
    v_cvt_pk_bf16_f32 v47, v94, v95
    s_setprio 2
    s_waitcnt lgkmcnt(0)
    v_mfma_f32_32x32x16_bf16 v[80:95], v[10:13], v[4:7], v[48:63]
    ds_read_b64_tr_b16 v[16:17], v120 offset:51200
    ds_read_b64_tr_b16 v[18:19], v120 offset:51264
    ds_read_b64_tr_b16 v[20:21], v120 offset:51328
    v_exp_f32 v96, v96
    v_exp_f32 v97, v97
    v_exp_f32 v98, v98
    v_exp_f32 v99, v99
    v_mfma_f32_32x32x16_bf16 v[64:79], v[28:31], v[44:47], v[64:79]
    s_mov_b64 exec, s[36:37]
    ds_read_b128 v[24:27], v123 offset:53760
    ds_read_b128 v[28:31], v123 offset:54400
    s_mov_b64 exec, -1
    v_exp_f32 v100, v100
    v_exp_f32 v101, v101
    v_exp_f32 v102, v102
    v_exp_f32 v103, v103
    v_mfma_f32_32x32x8bf16_1k v[80:95], v[14:15], v[8:9], v[80:95]
    v_cvt_pk_bf16_f32 v40, v96, v97
    v_cvt_pk_bf16_f32 v41, v98, v99
    v_cvt_pk_bf16_f32 v42, v100, v101
    v_cvt_pk_bf16_f32 v43, v102, v103
    s_cmp_lg_u32 s16, 4
    s_cbranch_scc1 L_j_32
    s_sub_u32 s60, s98, 0
    s_cmp_lt_u32 s60, 54
    s_cbranch_scc0 L_pf_33
    s_lshl_b32 s60, s60, 13
    s_add_u32 s60, s60, 0xa2000
    buffer_load_dword v135, v134, s[52:55], s60 offen
L_pf_33:
    s_sub_u32 s60, s98, 54
    s_cmp_lt_u32 s60, 54
    s_cbranch_scc0 L_pf_34
    s_lshl_b32 s60, s60, 13
    s_add_u32 s60, s60, 0x1b0000
    buffer_load_dword v135, v134, s[52:55], s60 offen
L_pf_34:
    s_sub_u32 s60, s98, 128
    s_cmp_lt_u32 s60, 100
    s_cbranch_scc0 L_pf_35
    s_lshl_b32 s60, s60, 13
    buffer_load_dword v135, v134, s[4:7], s60 offen
L_pf_35:
L_j_32:
    s_cmp_lg_u32 s18, 1
    s_cbranch_scc1 L_j_36
    s_cmp_lt_u32 s98, 120
    s_cbranch_scc1 L_np_37
    buffer_load_dwordx4 v[112:115], v118, s[44:47], s101 offen
L_np_37:
L_j_36:
    v_exp_f32 v104, v104
    v_exp_f32 v105, v105
    v_exp_f32 v106, v106
    v_exp_f32 v107, v107
    v_mfma_f32_32x32x16_bf16 v[64:79], v[32:35], v[40:43], v[64:79]
    s_sub_u32 s58, s98, 108
    s_cmp_ge_u32 s58, 4
    s_cbranch_scc1 L_pc2_39
    s_getpc_b64 s[60:61]
L_pc_38:
    s_lshl_b32 s58, s58, 13
    s_add_u32 s58, s58, L_att_end-L_pc_38
    v_add_u32 v136, s58, v134
    v_min_u32 v136, L_text_end-L_pc_38-4, v136
    global_load_dword v135, v136, s[60:61]
L_pc2_39:
    v_exp_f32 v108, v108
    v_exp_f32 v109, v109
    v_exp_f32 v110, v110
    v_exp_f32 v111, v111
    v_cvt_pk_bf16_f32 v44, v104, v105
    v_cvt_pk_bf16_f32 v45, v106, v107
    v_cvt_pk_bf16_f32 v46, v108, v109
    v_cvt_pk_bf16_f32 v47, v110, v111
    s_setprio 1
    s_waitcnt lgkmcnt(0)
    v_mfma_f32_32x32x16_bf16 v[96:111], v[16:19], v[4:7], v[48:63]
    ds_read_b64_tr_b16 v[10:11], v120 offset:48640
    ds_read_b64_tr_b16 v[12:13], v120 offset:48704
    ds_read_b64_tr_b16 v[14:15], v120 offset:48768
    v_exp_f32 v80, v80
    v_exp_f32 v81, v81
    v_exp_f32 v82, v82
    v_exp_f32 v83, v83
    v_mfma_f32_32x32x16_bf16 v[64:79], v[36:39], v[44:47], v[64:79]
    s_mov_b64 exec, s[36:37]
    ds_read_b128 v[32:35], v123 offset:51200
    ds_read_b128 v[36:39], v123 offset:51840
    s_mov_b64 exec, -1
    v_exp_f32 v84, v84
    v_exp_f32 v85, v85
    v_exp_f32 v86, v86
    v_exp_f32 v87, v87
    v_mfma_f32_32x32x8bf16_1k v[96:111], v[20:21], v[8:9], v[96:111]
    v_cvt_pk_bf16_f32 v40, v80, v81
    v_cvt_pk_bf16_f32 v41, v82, v83
    v_cvt_pk_bf16_f32 v42, v84, v85
    v_cvt_pk_bf16_f32 v43, v86, v87
    s_cmp_lg_u32 s16, 0
    s_cbranch_scc1 L_j_40
    s_sub_u32 s60, s98, 0
    s_cmp_lt_u32 s60, 54
    s_cbranch_scc0 L_pf_41
    s_lshl_b32 s60, s60, 13
    s_add_u32 s60, s60, 0xa2000
    buffer_load_dword v135, v134, s[52:55], s60 offen
L_pf_41:
    s_sub_u32 s60, s98, 54
    s_cmp_lt_u32 s60, 54
    s_cbranch_scc0 L_pf_42
    s_lshl_b32 s60, s60, 13
    s_add_u32 s60, s60, 0x1b0000
    buffer_load_dword v135, v134, s[52:55], s60 offen
L_pf_42:
    s_sub_u32 s60, s98, 128
    s_cmp_lt_u32 s60, 100
    s_cbranch_scc0 L_pf_43
    s_lshl_b32 s60, s60, 13
    buffer_load_dword v135, v134, s[4:7], s60 offen
L_pf_43:
L_j_40:
    v_exp_f32 v88, v88
    v_exp_f32 v89, v89
    v_exp_f32 v90, v90
    v_exp_f32 v91, v91
    v_mfma_f32_32x32x16_bf16 v[64:79], v[24:27], v[40:43], v[64:79]
    v_exp_f32 v92, v92
    v_exp_f32 v93, v93
    v_exp_f32 v94, v94
    v_exp_f32 v95, v95
    v_cvt_pk_bf16_f32 v44, v88, v89
    v_cvt_pk_bf16_f32 v45, v90, v91
    v_cvt_pk_bf16_f32 v46, v92, v93
    v_cvt_pk_bf16_f32 v47, v94, v95
    s_setprio 0
    s_waitcnt lgkmcnt(0)
    v_mfma_f32_32x32x16_bf16 v[80:95], v[10:13], v[4:7], v[48:63]
    ds_read_b64_tr_b16 v[16:17], v120 offset:46080
    ds_read_b64_tr_b16 v[18:19], v120 offset:46144
    ds_read_b64_tr_b16 v[20:21], v120 offset:46208
    v_exp_f32 v96, v96
    v_exp_f32 v97, v97
    v_exp_f32 v98, v98
    v_exp_f32 v99, v99
    v_mfma_f32_32x32x16_bf16 v[64:79], v[28:31], v[44:47], v[64:79]
    s_mov_b64 exec, s[36:37]
    ds_read_b128 v[24:27], v123 offset:48640
    ds_read_b128 v[28:31], v123 offset:49280
    s_mov_b64 exec, -1
    v_exp_f32 v100, v100
    v_exp_f32 v101, v101
    v_exp_f32 v102, v102
    v_exp_f32 v103, v103
    v_mfma_f32_32x32x8bf16_1k v[80:95], v[14:15], v[8:9], v[80:95]
    v_cvt_pk_bf16_f32 v40, v96, v97
    v_cvt_pk_bf16_f32 v41, v98, v99
    v_cvt_pk_bf16_f32 v42, v100, v101
    v_cvt_pk_bf16_f32 v43, v102, v103
    s_cmp_lg_u32 s16, 5
    s_cbranch_scc1 L_j_44
    s_sub_u32 s60, s98, 0
    s_cmp_lt_u32 s60, 54
    s_cbranch_scc0 L_pf_45
    s_lshl_b32 s60, s60, 13
    s_add_u32 s60, s60, 0xa2000
    buffer_load_dword v135, v134, s[52:55], s60 offen
L_pf_45:
    s_sub_u32 s60, s98, 54
    s_cmp_lt_u32 s60, 54
    s_cbranch_scc0 L_pf_46
    s_lshl_b32 s60, s60, 13
    s_add_u32 s60, s60, 0x1b0000
    buffer_load_dword v135, v134, s[52:55], s60 offen
L_pf_46:
    s_sub_u32 s60, s98, 128
    s_cmp_lt_u32 s60, 100
    s_cbranch_scc0 L_pf_47
    s_lshl_b32 s60, s60, 13
    buffer_load_dword v135, v134, s[4:7], s60 offen
L_pf_47:
L_j_44:
    v_exp_f32 v104, v104
    v_exp_f32 v105, v105
    v_exp_f32 v106, v106
    v_exp_f32 v107, v107
    v_mfma_f32_32x32x16_bf16 v[64:79], v[32:35], v[40:43], v[64:79]
    v_exp_f32 v108, v108
    v_exp_f32 v109, v109
    v_exp_f32 v110, v110
    v_exp_f32 v111, v111
    v_cvt_pk_bf16_f32 v44, v104, v105
    v_cvt_pk_bf16_f32 v45, v106, v107
    v_cvt_pk_bf16_f32 v46, v108, v109
    v_cvt_pk_bf16_f32 v47, v110, v111
    s_setprio 3
    s_waitcnt lgkmcnt(0)
    v_mfma_f32_32x32x16_bf16 v[96:111], v[16:19], v[4:7], v[48:63]
    ds_read_b64_tr_b16 v[10:11], v120 offset:43520
    ds_read_b64_tr_b16 v[12:13], v120 offset:43584
    ds_read_b64_tr_b16 v[14:15], v120 offset:43648
    v_exp_f32 v80, v80
    v_exp_f32 v81, v81
    v_exp_f32 v82, v82
    v_exp_f32 v83, v83
    v_mfma_f32_32x32x16_bf16 v[64:79], v[36:39], v[44:47], v[64:79]
    s_mov_b64 exec, s[36:37]
    ds_read_b128 v[32:35], v123 offset:46080
    ds_read_b128 v[36:39], v123 offset:46720
    s_mov_b64 exec, -1
    v_exp_f32 v84, v84
    v_exp_f32 v85, v85
    v_exp_f32 v86, v86
    v_exp_f32 v87, v87
    v_mfma_f32_32x32x8bf16_1k v[96:111], v[20:21], v[8:9], v[96:111]
    v_cvt_pk_bf16_f32 v40, v80, v81
    v_cvt_pk_bf16_f32 v41, v82, v83
    v_cvt_pk_bf16_f32 v42, v84, v85
    v_cvt_pk_bf16_f32 v43, v86, v87
    s_cmp_lg_u32 s16, 1
    s_cbranch_scc1 L_j_48
    s_sub_u32 s60, s98, 0
    s_cmp_lt_u32 s60, 54
    s_cbranch_scc0 L_pf_49
    s_lshl_b32 s60, s60, 13
    s_add_u32 s60, s60, 0xa2000
    buffer_load_dword v135, v134, s[52:55], s60 offen
L_pf_49:
    s_sub_u32 s60, s98, 54
    s_cmp_lt_u32 s60, 54
    s_cbranch_scc0 L_pf_50
    s_lshl_b32 s60, s60, 13
    s_add_u32 s60, s60, 0x1b0000
    buffer_load_dword v135, v134, s[52:55], s60 offen
L_pf_50:
    s_sub_u32 s60, s98, 128
    s_cmp_lt_u32 s60, 100
    s_cbranch_scc0 L_pf_51
    s_lshl_b32 s60, s60, 13
    buffer_load_dword v135, v134, s[4:7], s60 offen
L_pf_51:
L_j_48:
    v_exp_f32 v88, v88
    v_exp_f32 v89, v89
    v_exp_f32 v90, v90
    v_exp_f32 v91, v91
    v_mfma_f32_32x32x16_bf16 v[64:79], v[24:27], v[40:43], v[64:79]
    v_exp_f32 v92, v92
    v_exp_f32 v93, v93
    v_exp_f32 v94, v94
    v_exp_f32 v95, v95
    v_cvt_pk_bf16_f32 v44, v88, v89
    v_cvt_pk_bf16_f32 v45, v90, v91
    v_cvt_pk_bf16_f32 v46, v92, v93
    v_cvt_pk_bf16_f32 v47, v94, v95
    s_setprio 2
    s_waitcnt lgkmcnt(0)
    v_mfma_f32_32x32x16_bf16 v[80:95], v[10:13], v[4:7], v[48:63]
    ds_read_b64_tr_b16 v[16:17], v120 offset:40960
    ds_read_b64_tr_b16 v[18:19], v120 offset:41024
    ds_read_b64_tr_b16 v[20:21], v120 offset:41088
    v_exp_f32 v96, v96
    v_exp_f32 v97, v97
    v_exp_f32 v98, v98
    v_exp_f32 v99, v99
    v_mfma_f32_32x32x16_bf16 v[64:79], v[28:31], v[44:47], v[64:79]
    s_mov_b64 exec, s[36:37]
    ds_read_b128 v[24:27], v123 offset:43520
    ds_read_b128 v[28:31], v123 offset:44160
    s_mov_b64 exec, -1
    v_exp_f32 v100, v100
    v_exp_f32 v101, v101
    v_exp_f32 v102, v102
    v_exp_f32 v103, v103
    v_mfma_f32_32x32x8bf16_1k v[80:95], v[14:15], v[8:9], v[80:95]
    v_cvt_pk_bf16_f32 v40, v96, v97
    v_cvt_pk_bf16_f32 v41, v98, v99
    v_cvt_pk_bf16_f32 v42, v100, v101
    v_cvt_pk_bf16_f32 v43, v102, v103
    s_cmp_lg_u32 s16, 6
    s_cbranch_scc1 L_j_52
    s_sub_u32 s60, s98, 0
    s_cmp_lt_u32 s60, 54
    s_cbranch_scc0 L_pf_53
    s_lshl_b32 s60, s60, 13
    s_add_u32 s60, s60, 0xa2000
    buffer_load_dword v135, v134, s[52:55], s60 offen
L_pf_53:
    s_sub_u32 s60, s98, 54
    s_cmp_lt_u32 s60, 54
    s_cbranch_scc0 L_pf_54
    s_lshl_b32 s60, s60, 13
    s_add_u32 s60, s60, 0x1b0000
    buffer_load_dword v135, v134, s[52:55], s60 offen
L_pf_54:
    s_sub_u32 s60, s98, 128
    s_cmp_lt_u32 s60, 100
    s_cbranch_scc0 L_pf_55
    s_lshl_b32 s60, s60, 13
    buffer_load_dword v135, v134, s[4:7], s60 offen
L_pf_55:
L_j_52:
    v_exp_f32 v104, v104
    v_exp_f32 v105, v105
    v_exp_f32 v106, v106
    v_exp_f32 v107, v107
    v_mfma_f32_32x32x16_bf16 v[64:79], v[32:35], v[40:43], v[64:79]
    v_exp_f32 v108, v108
    v_exp_f32 v109, v109
    v_exp_f32 v110, v110
    v_exp_f32 v111, v111
    v_cvt_pk_bf16_f32 v44, v104, v105
    v_cvt_pk_bf16_f32 v45, v106, v107
    v_cvt_pk_bf16_f32 v46, v108, v109
    v_cvt_pk_bf16_f32 v47, v110, v111
    s_setprio 1
    s_waitcnt lgkmcnt(0)
    v_mfma_f32_32x32x16_bf16 v[96:111], v[16:19], v[4:7], v[48:63]
    ds_read_b64_tr_b16 v[10:11], v120 offset:38400
    ds_read_b64_tr_b16 v[12:13], v120 offset:38464
    ds_read_b64_tr_b16 v[14:15], v120 offset:38528
    v_exp_f32 v80, v80
    v_exp_f32 v81, v81
    v_exp_f32 v82, v82
    v_exp_f32 v83, v83
    v_mfma_f32_32x32x16_bf16 v[64:79], v[36:39], v[44:47], v[64:79]
    s_mov_b64 exec, s[36:37]
    ds_read_b128 v[32:35], v123 offset:40960
    ds_read_b128 v[36:39], v123 offset:41600
    s_mov_b64 exec, -1
    v_exp_f32 v84, v84
    v_exp_f32 v85, v85
    v_exp_f32 v86, v86
    v_exp_f32 v87, v87
    v_mfma_f32_32x32x8bf16_1k v[96:111], v[20:21], v[8:9], v[96:111]
    v_cvt_pk_bf16_f32 v40, v80, v81
    v_cvt_pk_bf16_f32 v41, v82, v83
    v_cvt_pk_bf16_f32 v42, v84, v85
    v_cvt_pk_bf16_f32 v43, v86, v87
    s_cmp_lg_u32 s16, 2
    s_cbranch_scc1 L_j_56
    s_sub_u32 s60, s98, 0
    s_cmp_lt_u32 s60, 54
    s_cbranch_scc0 L_pf_57
    s_lshl_b32 s60, s60, 13
    s_add_u32 s60, s60, 0xa2000
    buffer_load_dword v135, v134, s[52:55], s60 offen
L_pf_57:
    s_sub_u32 s60, s98, 54
    s_cmp_lt_u32 s60, 54
    s_cbranch_scc0 L_pf_58
    s_lshl_b32 s60, s60, 13
    s_add_u32 s60, s60, 0x1b0000
    buffer_load_dword v135, v134, s[52:55], s60 offen
L_pf_58:
    s_sub_u32 s60, s98, 128
    s_cmp_lt_u32 s60, 100
    s_cbranch_scc0 L_pf_59
    s_lshl_b32 s60, s60, 13
    buffer_load_dword v135, v134, s[4:7], s60 offen
L_pf_59:
L_j_56:
    v_exp_f32 v88, v88
    v_exp_f32 v89, v89
    v_exp_f32 v90, v90
    v_exp_f32 v91, v91
    v_mfma_f32_32x32x16_bf16 v[64:79], v[24:27], v[40:43], v[64:79]
    v_exp_f32 v92, v92
    v_exp_f32 v93, v93
    v_exp_f32 v94, v94
    v_exp_f32 v95, v95
    v_cvt_pk_bf16_f32 v44, v88, v89
    v_cvt_pk_bf16_f32 v45, v90, v91
    v_cvt_pk_bf16_f32 v46, v92, v93
    v_cvt_pk_bf16_f32 v47, v94, v95
    s_setprio 0
    s_waitcnt lgkmcnt(0)
    v_mfma_f32_32x32x16_bf16 v[80:95], v[10:13], v[4:7], v[48:63]
    ds_read_b64_tr_b16 v[16:17], v120 offset:35840
    ds_read_b64_tr_b16 v[18:19], v120 offset:35904
    ds_read_b64_tr_b16 v[20:21], v120 offset:35968
    v_exp_f32 v96, v96
    v_exp_f32 v97, v97
    v_exp_f32 v98, v98
    v_exp_f32 v99, v99
    v_mfma_f32_32x32x16_bf16 v[64:79], v[28:31], v[44:47], v[64:79]
    s_mov_b64 exec, s[36:37]
    ds_read_b128 v[24:27], v123 offset:38400
    ds_read_b128 v[28:31], v123 offset:39040
    s_mov_b64 exec, -1
    v_exp_f32 v100, v100
    v_exp_f32 v101, v101
    v_exp_f32 v102, v102
    v_exp_f32 v103, v103
    v_mfma_f32_32x32x8bf16_1k v[80:95], v[14:15], v[8:9], v[80:95]
    v_cvt_pk_bf16_f32 v40, v96, v97
    v_cvt_pk_bf16_f32 v41, v98, v99
    v_cvt_pk_bf16_f32 v42, v100, v101
    v_cvt_pk_bf16_f32 v43, v102, v103
    s_cmp_lg_u32 s16, 7
    s_cbranch_scc1 L_j_60
    s_sub_u32 s60, s98, 0
    s_cmp_lt_u32 s60, 54
    s_cbranch_scc0 L_pf_61
    s_lshl_b32 s60, s60, 13
    s_add_u32 s60, s60, 0xa2000
    buffer_load_dword v135, v134, s[52:55], s60 offen
L_pf_61:
    s_sub_u32 s60, s98, 54
    s_cmp_lt_u32 s60, 54
    s_cbranch_scc0 L_pf_62
    s_lshl_b32 s60, s60, 13
    s_add_u32 s60, s60, 0x1b0000
    buffer_load_dword v135, v134, s[52:55], s60 offen
L_pf_62:
    s_sub_u32 s60, s98, 128
    s_cmp_lt_u32 s60, 100
    s_cbranch_scc0 L_pf_63
    s_lshl_b32 s60, s60, 13
    buffer_load_dword v135, v134, s[4:7], s60 offen
L_pf_63:
L_j_60:
    v_exp_f32 v104, v104
    v_exp_f32 v105, v105
    v_exp_f32 v106, v106
    v_exp_f32 v107, v107
    v_mfma_f32_32x32x16_bf16 v[64:79], v[32:35], v[40:43], v[64:79]
    v_exp_f32 v108, v108
    v_exp_f32 v109, v109
    v_exp_f32 v110, v110
    v_exp_f32 v111, v111
    v_cvt_pk_bf16_f32 v44, v104, v105
    v_cvt_pk_bf16_f32 v45, v106, v107
    v_cvt_pk_bf16_f32 v46, v108, v109
    v_cvt_pk_bf16_f32 v47, v110, v111
    s_setprio 3
    s_waitcnt lgkmcnt(0)
    v_mfma_f32_32x32x16_bf16 v[96:111], v[16:19], v[4:7], v[48:63]
    ds_read_b64_tr_b16 v[10:11], v120 offset:33280
    ds_read_b64_tr_b16 v[12:13], v120 offset:33344
    ds_read_b64_tr_b16 v[14:15], v120 offset:33408
    v_exp_f32 v80, v80
    v_exp_f32 v81, v81
    v_exp_f32 v82, v82
    v_exp_f32 v83, v83
    v_mfma_f32_32x32x16_bf16 v[64:79], v[36:39], v[44:47], v[64:79]
    s_mov_b64 exec, s[36:37]
    ds_read_b128 v[32:35], v123 offset:35840
    ds_read_b128 v[36:39], v123 offset:36480
    s_mov_b64 exec, -1
    v_exp_f32 v84, v84
    v_exp_f32 v85, v85
    v_exp_f32 v86, v86
    v_exp_f32 v87, v87
    v_mfma_f32_32x32x8bf16_1k v[96:111], v[20:21], v[8:9], v[96:111]
    v_cvt_pk_bf16_f32 v40, v80, v81
    v_cvt_pk_bf16_f32 v41, v82, v83
    v_cvt_pk_bf16_f32 v42, v84, v85
    v_cvt_pk_bf16_f32 v43, v86, v87
    s_cmp_lg_u32 s16, 3
    s_cbranch_scc1 L_j_64
    s_sub_u32 s60, s98, 0
    s_cmp_lt_u32 s60, 54
    s_cbranch_scc0 L_pf_65
    s_lshl_b32 s60, s60, 13
    s_add_u32 s60, s60, 0xa2000
    buffer_load_dword v135, v134, s[52:55], s60 offen
L_pf_65:
    s_sub_u32 s60, s98, 54
    s_cmp_lt_u32 s60, 54
    s_cbranch_scc0 L_pf_66
    s_lshl_b32 s60, s60, 13
    s_add_u32 s60, s60, 0x1b0000
    buffer_load_dword v135, v134, s[52:55], s60 offen
L_pf_66:
    s_sub_u32 s60, s98, 128
    s_cmp_lt_u32 s60, 100
    s_cbranch_scc0 L_pf_67
    s_lshl_b32 s60, s60, 13
    buffer_load_dword v135, v134, s[4:7], s60 offen
L_pf_67:
L_j_64:
    v_exp_f32 v88, v88
    v_exp_f32 v89, v89
    v_exp_f32 v90, v90
    v_exp_f32 v91, v91
    v_mfma_f32_32x32x16_bf16 v[64:79], v[24:27], v[40:43], v[64:79]
    v_exp_f32 v92, v92
    v_exp_f32 v93, v93
    v_exp_f32 v94, v94
    v_exp_f32 v95, v95
    v_cvt_pk_bf16_f32 v44, v88, v89
    v_cvt_pk_bf16_f32 v45, v90, v91
    v_cvt_pk_bf16_f32 v46, v92, v93
    v_cvt_pk_bf16_f32 v47, v94, v95
    s_setprio 2
    s_waitcnt lgkmcnt(0)
    v_mfma_f32_32x32x16_bf16 v[80:95], v[10:13], v[4:7], v[48:63]
    ds_read_b64_tr_b16 v[16:17], v120 offset:30720
    ds_read_b64_tr_b16 v[18:19], v120 offset:30784
    ds_read_b64_tr_b16 v[20:21], v120 offset:30848
    v_exp_f32 v96, v96
    v_exp_f32 v97, v97
    v_exp_f32 v98, v98
    v_exp_f32 v99, v99
    v_mfma_f32_32x32x16_bf16 v[64:79], v[28:31], v[44:47], v[64:79]
    s_mov_b64 exec, s[36:37]
    ds_read_b128 v[24:27], v123 offset:33280
    ds_read_b128 v[28:31], v123 offset:33920
    s_mov_b64 exec, -1
    v_exp_f32 v100, v100
    v_exp_f32 v101, v101
    v_exp_f32 v102, v102
    v_exp_f32 v103, v103
    v_mfma_f32_32x32x8bf16_1k v[80:95], v[14:15], v[8:9], v[80:95]
    v_cvt_pk_bf16_f32 v40, v96, v97
    v_cvt_pk_bf16_f32 v41, v98, v99
    v_cvt_pk_bf16_f32 v42, v100, v101
    v_cvt_pk_bf16_f32 v43, v102, v103
    v_exp_f32 v104, v104
    v_exp_f32 v105, v105
    v_exp_f32 v106, v106
    v_exp_f32 v107, v107
    v_mfma_f32_32x32x16_bf16 v[64:79], v[32:35], v[40:43], v[64:79]
    v_exp_f32 v108, v108
    v_exp_f32 v109, v109
    v_exp_f32 v110, v110
    v_exp_f32 v111, v111
    v_cvt_pk_bf16_f32 v44, v104, v105
    v_cvt_pk_bf16_f32 v45, v106, v107
    v_cvt_pk_bf16_f32 v46, v108, v109
    v_cvt_pk_bf16_f32 v47, v110, v111
    s_setprio 1
    s_waitcnt lgkmcnt(0)
    v_mfma_f32_32x32x16_bf16 v[96:111], v[16:19], v[4:7], v[48:63]
    ds_read_b64_tr_b16 v[10:11], v120 offset:28160
    ds_read_b64_tr_b16 v[12:13], v120 offset:28224
    ds_read_b64_tr_b16 v[14:15], v120 offset:28288
    v_exp_f32 v80, v80
    v_exp_f32 v81, v81
    v_exp_f32 v82, v82
    v_exp_f32 v83, v83
    v_mfma_f32_32x32x16_bf16 v[64:79], v[36:39], v[44:47], v[64:79]
    s_mov_b64 exec, s[36:37]
    ds_read_b128 v[32:35], v123 offset:30720
    ds_read_b128 v[36:39], v123 offset:31360
    s_mov_b64 exec, -1
    v_exp_f32 v84, v84
    v_exp_f32 v85, v85
    v_exp_f32 v86, v86
    v_exp_f32 v87, v87
    v_mfma_f32_32x32x8bf16_1k v[96:111], v[20:21], v[8:9], v[96:111]
    v_cvt_pk_bf16_f32 v40, v80, v81
    v_cvt_pk_bf16_f32 v41, v82, v83
    v_cvt_pk_bf16_f32 v42, v84, v85
    v_cvt_pk_bf16_f32 v43, v86, v87
    v_exp_f32 v88, v88
    v_exp_f32 v89, v89
    v_exp_f32 v90, v90
    v_exp_f32 v91, v91
    v_mfma_f32_32x32x16_bf16 v[64:79], v[24:27], v[40:43], v[64:79]
    v_exp_f32 v92, v92
    v_exp_f32 v93, v93
    v_exp_f32 v94, v94
    v_exp_f32 v95, v95
    v_cvt_pk_bf16_f32 v44, v88, v89
    v_cvt_pk_bf16_f32 v45, v90, v91
    v_cvt_pk_bf16_f32 v46, v92, v93
    v_cvt_pk_bf16_f32 v47, v94, v95
    s_setprio 0
    s_waitcnt lgkmcnt(0)
    v_mfma_f32_32x32x16_bf16 v[80:95], v[10:13], v[4:7], v[48:63]
    ds_read_b64_tr_b16 v[16:17], v120 offset:25600
    ds_read_b64_tr_b16 v[18:19], v120 offset:25664
    ds_read_b64_tr_b16 v[20:21], v120 offset:25728
    v_exp_f32 v96, v96
    v_exp_f32 v97, v97
    v_exp_f32 v98, v98
    v_exp_f32 v99, v99
    v_mfma_f32_32x32x16_bf16 v[64:79], v[28:31], v[44:47], v[64:79]
    s_mov_b64 exec, s[36:37]
    ds_read_b128 v[24:27], v123 offset:28160
    ds_read_b128 v[28:31], v123 offset:28800
    s_mov_b64 exec, -1
    v_exp_f32 v100, v100
    v_exp_f32 v101, v101
    v_exp_f32 v102, v102
    v_exp_f32 v103, v103
    v_mfma_f32_32x32x8bf16_1k v[80:95], v[14:15], v[8:9], v[80:95]
    v_cvt_pk_bf16_f32 v40, v96, v97
    v_cvt_pk_bf16_f32 v41, v98, v99
    v_cvt_pk_bf16_f32 v42, v100, v101
    v_cvt_pk_bf16_f32 v43, v102, v103
    v_exp_f32 v104, v104
    v_exp_f32 v105, v105
    v_exp_f32 v106, v106
    v_exp_f32 v107, v107
    v_mfma_f32_32x32x16_bf16 v[64:79], v[32:35], v[40:43], v[64:79]
    v_exp_f32 v108, v108
    v_exp_f32 v109, v109
    v_exp_f32 v110, v110
    v_exp_f32 v111, v111
    v_cvt_pk_bf16_f32 v44, v104, v105
    v_cvt_pk_bf16_f32 v45, v106, v107
    v_cvt_pk_bf16_f32 v46, v108, v109
    v_cvt_pk_bf16_f32 v47, v110, v111
    s_setprio 3
    s_waitcnt lgkmcnt(0)
    v_mfma_f32_32x32x16_bf16 v[96:111], v[16:19], v[4:7], v[48:63]
    ds_read_b64_tr_b16 v[10:11], v120 offset:23040
    ds_read_b64_tr_b16 v[12:13], v120 offset:23104
    ds_read_b64_tr_b16 v[14:15], v120 offset:23168
    v_exp_f32 v80, v80
    v_exp_f32 v81, v81
    v_exp_f32 v82, v82
    v_exp_f32 v83, v83
    v_mfma_f32_32x32x16_bf16 v[64:79], v[36:39], v[44:47], v[64:79]
    s_mov_b64 exec, s[36:37]
    ds_read_b128 v[32:35], v123 offset:25600
    ds_read_b128 v[36:39], v123 offset:26240
    s_mov_b64 exec, -1
    v_exp_f32 v84, v84
    v_exp_f32 v85, v85
    v_exp_f32 v86, v86
    v_exp_f32 v87, v87
    v_mfma_f32_32x32x8bf16_1k v[96:111], v[20:21], v[8:9], v[96:111]
    v_cvt_pk_bf16_f32 v40, v80, v81
    v_cvt_pk_bf16_f32 v41, v82, v83
    v_cvt_pk_bf16_f32 v42, v84, v85
    v_cvt_pk_bf16_f32 v43, v86, v87
    v_exp_f32 v88, v88
    v_exp_f32 v89, v89
    v_exp_f32 v90, v90
    v_exp_f32 v91, v91
    v_mfma_f32_32x32x16_bf16 v[64:79], v[24:27], v[40:43], v[64:79]
    v_exp_f32 v92, v92
    v_exp_f32 v93, v93
    v_exp_f32 v94, v94
    v_exp_f32 v95, v95
    v_cvt_pk_bf16_f32 v44, v88, v89
    v_cvt_pk_bf16_f32 v45, v90, v91
    v_cvt_pk_bf16_f32 v46, v92, v93
    v_cvt_pk_bf16_f32 v47, v94, v95
    s_setprio 2
    s_waitcnt lgkmcnt(0)
    v_mfma_f32_32x32x16_bf16 v[80:95], v[10:13], v[4:7], v[48:63]
    ds_read_b64_tr_b16 v[16:17], v120 offset:20480
    ds_read_b64_tr_b16 v[18:19], v120 offset:20544
    ds_read_b64_tr_b16 v[20:21], v120 offset:20608
    v_exp_f32 v96, v96
    v_exp_f32 v97, v97
    v_exp_f32 v98, v98
    v_exp_f32 v99, v99
    v_mfma_f32_32x32x16_bf16 v[64:79], v[28:31], v[44:47], v[64:79]
    s_mov_b64 exec, s[36:37]
    ds_read_b128 v[24:27], v123 offset:23040
    ds_read_b128 v[28:31], v123 offset:23680
    s_mov_b64 exec, -1
    v_exp_f32 v100, v100
    v_exp_f32 v101, v101
    v_exp_f32 v102, v102
    v_exp_f32 v103, v103
    v_mfma_f32_32x32x8bf16_1k v[80:95], v[14:15], v[8:9], v[80:95]
    v_cvt_pk_bf16_f32 v40, v96, v97
    v_cvt_pk_bf16_f32 v41, v98, v99
    v_cvt_pk_bf16_f32 v42, v100, v101
    v_cvt_pk_bf16_f32 v43, v102, v103
    v_exp_f32 v104, v104
    v_exp_f32 v105, v105
    v_exp_f32 v106, v106
    v_exp_f32 v107, v107
    v_mfma_f32_32x32x16_bf16 v[64:79], v[32:35], v[40:43], v[64:79]
    v_exp_f32 v108, v108
    v_exp_f32 v109, v109
    v_exp_f32 v110, v110
    v_exp_f32 v111, v111
    v_cvt_pk_bf16_f32 v44, v104, v105
    v_cvt_pk_bf16_f32 v45, v106, v107
    v_cvt_pk_bf16_f32 v46, v108, v109
    v_cvt_pk_bf16_f32 v47, v110, v111
    s_setprio 1
    s_waitcnt lgkmcnt(0)
    v_mfma_f32_32x32x16_bf16 v[96:111], v[16:19], v[4:7], v[48:63]
    ds_read_b64_tr_b16 v[10:11], v120 offset:17920
    ds_read_b64_tr_b16 v[12:13], v120 offset:17984
    ds_read_b64_tr_b16 v[14:15], v120 offset:18048
    v_exp_f32 v80, v80
    v_exp_f32 v81, v81
    v_exp_f32 v82, v82
    v_exp_f32 v83, v83
    v_mfma_f32_32x32x16_bf16 v[64:79], v[36:39], v[44:47], v[64:79]
    s_mov_b64 exec, s[36:37]
    ds_read_b128 v[32:35], v123 offset:20480
    ds_read_b128 v[36:39], v123 offset:21120
    s_mov_b64 exec, -1
    v_exp_f32 v84, v84
    v_exp_f32 v85, v85
    v_exp_f32 v86, v86
    v_exp_f32 v87, v87
    v_mfma_f32_32x32x8bf16_1k v[96:111], v[20:21], v[8:9], v[96:111]
    v_cvt_pk_bf16_f32 v40, v80, v81
    v_cvt_pk_bf16_f32 v41, v82, v83
    v_cvt_pk_bf16_f32 v42, v84, v85
    v_cvt_pk_bf16_f32 v43, v86, v87
    v_exp_f32 v88, v88
    v_exp_f32 v89, v89
    v_exp_f32 v90, v90
    v_exp_f32 v91, v91
    v_mfma_f32_32x32x16_bf16 v[64:79], v[24:27], v[40:43], v[64:79]
    v_exp_f32 v92, v92
    v_exp_f32 v93, v93
    v_exp_f32 v94, v94
    v_exp_f32 v95, v95
    v_cvt_pk_bf16_f32 v44, v88, v89
    v_cvt_pk_bf16_f32 v45, v90, v91
    v_cvt_pk_bf16_f32 v46, v92, v93
    v_cvt_pk_bf16_f32 v47, v94, v95
    s_setprio 0
    s_waitcnt lgkmcnt(0)
    v_mfma_f32_32x32x16_bf16 v[80:95], v[10:13], v[4:7], v[48:63]
    ds_read_b64_tr_b16 v[16:17], v120 offset:15360
    ds_read_b64_tr_b16 v[18:19], v120 offset:15424
    ds_read_b64_tr_b16 v[20:21], v120 offset:15488
    v_exp_f32 v96, v96
    v_exp_f32 v97, v97
    v_exp_f32 v98, v98
    v_exp_f32 v99, v99
    v_mfma_f32_32x32x16_bf16 v[64:79], v[28:31], v[44:47], v[64:79]
    s_mov_b64 exec, s[36:37]
    ds_read_b128 v[24:27], v123 offset:17920
    ds_read_b128 v[28:31], v123 offset:18560
    s_mov_b64 exec, -1
    v_exp_f32 v100, v100
    v_exp_f32 v101, v101
    v_exp_f32 v102, v102
    v_exp_f32 v103, v103
    v_mfma_f32_32x32x8bf16_1k v[80:95], v[14:15], v[8:9], v[80:95]
    v_cvt_pk_bf16_f32 v40, v96, v97
    v_cvt_pk_bf16_f32 v41, v98, v99
    v_cvt_pk_bf16_f32 v42, v100, v101
    v_cvt_pk_bf16_f32 v43, v102, v103
    v_exp_f32 v104, v104
    v_exp_f32 v105, v105
    v_exp_f32 v106, v106
    v_exp_f32 v107, v107
    v_mfma_f32_32x32x16_bf16 v[64:79], v[32:35], v[40:43], v[64:79]
    v_exp_f32 v108, v108
    v_exp_f32 v109, v109
    v_exp_f32 v110, v110
    v_exp_f32 v111, v111
    v_cvt_pk_bf16_f32 v44, v104, v105
    v_cvt_pk_bf16_f32 v45, v106, v107
    v_cvt_pk_bf16_f32 v46, v108, v109
    v_cvt_pk_bf16_f32 v47, v110, v111
    s_setprio 3
    s_waitcnt lgkmcnt(0)
    v_mfma_f32_32x32x16_bf16 v[96:111], v[16:19], v[4:7], v[48:63]
    ds_read_b64_tr_b16 v[10:11], v120 offset:12800
    ds_read_b64_tr_b16 v[12:13], v120 offset:12864
    ds_read_b64_tr_b16 v[14:15], v120 offset:12928
    v_exp_f32 v80, v80
    v_exp_f32 v81, v81
    v_exp_f32 v82, v82
    v_exp_f32 v83, v83
    v_mfma_f32_32x32x16_bf16 v[64:79], v[36:39], v[44:47], v[64:79]
    s_mov_b64 exec, s[36:37]
    ds_read_b128 v[32:35], v123 offset:15360
    ds_read_b128 v[36:39], v123 offset:16000
    s_mov_b64 exec, -1
    v_exp_f32 v84, v84
    v_exp_f32 v85, v85
    v_exp_f32 v86, v86
    v_exp_f32 v87, v87
    v_mfma_f32_32x32x8bf16_1k v[96:111], v[20:21], v[8:9], v[96:111]
    v_cvt_pk_bf16_f32 v40, v80, v81
    v_cvt_pk_bf16_f32 v41, v82, v83
    v_cvt_pk_bf16_f32 v42, v84, v85
    v_cvt_pk_bf16_f32 v43, v86, v87
    s_cmp_lg_u32 s18, 0
    s_cbranch_scc1 L_j_68
    s_waitcnt vmcnt(0)
    v_add_u32 v208, 0x03000300, v208
    v_lshlrev_b32 v137, 16, v208
    v_and_b32 v138, 0xffff0000, v208
    v_cvt_pk_f16_f32 v208, v137, v138
    v_add_u32 v209, 0x03000300, v209
    v_lshlrev_b32 v137, 16, v209
    v_and_b32 v138, 0xffff0000, v209
    v_cvt_pk_f16_f32 v209, v137, v138
    v_add_u32 v210, 0x03000300, v210
    v_lshlrev_b32 v137, 16, v210
    v_and_b32 v138, 0xffff0000, v210
    v_cvt_pk_f16_f32 v210, v137, v138
    v_add_u32 v211, 0x03000300, v211
    v_lshlrev_b32 v137, 16, v211
    v_and_b32 v138, 0xffff0000, v211
    v_cvt_pk_f16_f32 v211, v137, v138
    s_add_u32 s60, s100, 0
    buffer_store_dwordx4 v[208:211], v117, s[8:11], s60 offen sc0 sc1
L_j_68:
    v_exp_f32 v88, v88
    v_exp_f32 v89, v89
    v_exp_f32 v90, v90
    v_exp_f32 v91, v91
    v_mfma_f32_32x32x16_bf16 v[64:79], v[24:27], v[40:43], v[64:79]
    v_exp_f32 v92, v92
    v_exp_f32 v93, v93
    v_exp_f32 v94, v94
    v_exp_f32 v95, v95
    v_cvt_pk_bf16_f32 v44, v88, v89
    v_cvt_pk_bf16_f32 v45, v90, v91
    v_cvt_pk_bf16_f32 v46, v92, v93
    v_cvt_pk_bf16_f32 v47, v94, v95
    s_setprio 2
    s_waitcnt lgkmcnt(0)
    v_mfma_f32_32x32x16_bf16 v[80:95], v[10:13], v[4:7], v[48:63]
    ds_read_b64_tr_b16 v[16:17], v120 offset:10240
    ds_read_b64_tr_b16 v[18:19], v120 offset:10304
    ds_read_b64_tr_b16 v[20:21], v120 offset:10368
    v_exp_f32 v96, v96
    v_exp_f32 v97, v97
    v_exp_f32 v98, v98
    v_exp_f32 v99, v99
    v_mfma_f32_32x32x16_bf16 v[64:79], v[28:31], v[44:47], v[64:79]
    s_mov_b64 exec, s[36:37]
    ds_read_b128 v[24:27], v123 offset:12800
    ds_read_b128 v[28:31], v123 offset:13440
    s_mov_b64 exec, -1
    v_exp_f32 v100, v100
    v_exp_f32 v101, v101
    v_exp_f32 v102, v102
    v_exp_f32 v103, v103
    v_mfma_f32_32x32x8bf16_1k v[80:95], v[14:15], v[8:9], v[80:95]
    v_cvt_pk_bf16_f32 v40, v96, v97
    v_cvt_pk_bf16_f32 v41, v98, v99
    v_cvt_pk_bf16_f32 v42, v100, v101
    v_cvt_pk_bf16_f32 v43, v102, v103
    s_cmp_lg_u32 s18, 0
    s_cbranch_scc1 L_j_69
    s_cmp_lt_u32 s98, 120
    s_cbranch_scc1 L_np_70
    buffer_store_dwordx4 v[112:115], v127, s[8:11], s43 offen sc0 sc1
L_np_70:
L_j_69:
    v_exp_f32 v104, v104
    v_exp_f32 v105, v105
    v_exp_f32 v106, v106
    v_exp_f32 v107, v107
    v_mfma_f32_32x32x16_bf16 v[64:79], v[32:35], v[40:43], v[64:79]
    v_exp_f32 v108, v108
    v_exp_f32 v109, v109
    v_exp_f32 v110, v110
    v_exp_f32 v111, v111
    v_cvt_pk_bf16_f32 v44, v104, v105
    v_cvt_pk_bf16_f32 v45, v106, v107
    v_cvt_pk_bf16_f32 v46, v108, v109
    v_cvt_pk_bf16_f32 v47, v110, v111
    s_setprio 1
    s_waitcnt lgkmcnt(0)
    v_mfma_f32_32x32x16_bf16 v[96:111], v[16:19], v[4:7], v[48:63]
    ds_read_b64_tr_b16 v[10:11], v120 offset:7680
    ds_read_b64_tr_b16 v[12:13], v120 offset:7744
    ds_read_b64_tr_b16 v[14:15], v120 offset:7808
    v_exp_f32 v80, v80
    v_exp_f32 v81, v81
    v_exp_f32 v82, v82
    v_exp_f32 v83, v83
    v_mfma_f32_32x32x16_bf16 v[64:79], v[36:39], v[44:47], v[64:79]
    s_mov_b64 exec, s[36:37]
    ds_read_b128 v[32:35], v123 offset:10240
    ds_read_b128 v[36:39], v123 offset:10880
    s_mov_b64 exec, -1
    v_exp_f32 v84, v84
    v_exp_f32 v85, v85
    v_exp_f32 v86, v86
    v_exp_f32 v87, v87
    v_mfma_f32_32x32x8bf16_1k v[96:111], v[20:21], v[8:9], v[96:111]
    v_cvt_pk_bf16_f32 v40, v80, v81
    v_cvt_pk_bf16_f32 v41, v82, v83
    v_cvt_pk_bf16_f32 v42, v84, v85
    v_cvt_pk_bf16_f32 v43, v86, v87
    s_cmp_lg_u32 s18, 0
    s_cbranch_scc1 L_j_71
    v_add_u32 v212, 0x03000300, v212
    v_lshlrev_b32 v137, 16, v212
    v_and_b32 v138, 0xffff0000, v212
    v_cvt_pk_f16_f32 v212, v137, v138
    v_add_u32 v213, 0x03000300, v213
    v_lshlrev_b32 v137, 16, v213
    v_and_b32 v138, 0xffff0000, v213
    v_cvt_pk_f16_f32 v213, v137, v138
    v_add_u32 v214, 0x03000300, v214
    v_lshlrev_b32 v137, 16, v214
    v_and_b32 v138, 0xffff0000, v214
    v_cvt_pk_f16_f32 v214, v137, v138
    v_add_u32 v215, 0x03000300, v215
    v_lshlrev_b32 v137, 16, v215
    v_and_b32 v138, 0xffff0000, v215
    v_cvt_pk_f16_f32 v215, v137, v138
    s_add_u32 s60, s100, 4096
    buffer_store_dwordx4 v[212:215], v117, s[8:11], s60 offen sc0 sc1
L_j_71:
    v_exp_f32 v88, v88
    v_exp_f32 v89, v89
    v_exp_f32 v90, v90
    v_exp_f32 v91, v91
    v_mfma_f32_32x32x16_bf16 v[64:79], v[24:27], v[40:43], v[64:79]
    v_exp_f32 v92, v92
    v_exp_f32 v93, v93
    v_exp_f32 v94, v94
    v_exp_f32 v95, v95
    v_cvt_pk_bf16_f32 v44, v88, v89
    v_cvt_pk_bf16_f32 v45, v90, v91
    v_cvt_pk_bf16_f32 v46, v92, v93
    v_cvt_pk_bf16_f32 v47, v94, v95
    s_setprio 0
    s_waitcnt lgkmcnt(0)
    v_mfma_f32_32x32x16_bf16 v[80:95], v[10:13], v[4:7], v[48:63]
    ds_read_b64_tr_b16 v[16:17], v120 offset:5120
    ds_read_b64_tr_b16 v[18:19], v120 offset:5184
    ds_read_b64_tr_b16 v[20:21], v120 offset:5248
    v_exp_f32 v96, v96
    v_exp_f32 v97, v97
    v_exp_f32 v98, v98
    v_exp_f32 v99, v99
    v_mfma_f32_32x32x16_bf16 v[64:79], v[28:31], v[44:47], v[64:79]
    s_mov_b64 exec, s[36:37]
    ds_read_b128 v[24:27], v123 offset:7680
    ds_read_b128 v[28:31], v123 offset:8320
    s_mov_b64 exec, -1
    v_exp_f32 v100, v100
    v_exp_f32 v101, v101
    v_exp_f32 v102, v102
    v_exp_f32 v103, v103
    v_mfma_f32_32x32x8bf16_1k v[80:95], v[14:15], v[8:9], v[80:95]
    v_cvt_pk_bf16_f32 v40, v96, v97
    v_cvt_pk_bf16_f32 v41, v98, v99
    v_cvt_pk_bf16_f32 v42, v100, v101
    v_cvt_pk_bf16_f32 v43, v102, v103
    v_exp_f32 v104, v104
    v_exp_f32 v105, v105
    v_exp_f32 v106, v106
    v_exp_f32 v107, v107
    v_mfma_f32_32x32x16_bf16 v[64:79], v[32:35], v[40:43], v[64:79]
    v_exp_f32 v108, v108
    v_exp_f32 v109, v109
    v_exp_f32 v110, v110
    v_exp_f32 v111, v111
    v_cvt_pk_bf16_f32 v44, v104, v105
    v_cvt_pk_bf16_f32 v45, v106, v107
    v_cvt_pk_bf16_f32 v46, v108, v109
    v_cvt_pk_bf16_f32 v47, v110, v111
    s_setprio 3
    s_waitcnt lgkmcnt(0)
    v_mfma_f32_32x32x16_bf16 v[96:111], v[16:19], v[4:7], v[48:63]
    ds_read_b64_tr_b16 v[10:11], v120 offset:2560
    ds_read_b64_tr_b16 v[12:13], v120 offset:2624
    ds_read_b64_tr_b16 v[14:15], v120 offset:2688
    v_exp_f32 v80, v80
    v_exp_f32 v81, v81
    v_exp_f32 v82, v82
    v_exp_f32 v83, v83
    v_mfma_f32_32x32x16_bf16 v[64:79], v[36:39], v[44:47], v[64:79]
    s_mov_b64 exec, s[36:37]
    ds_read_b128 v[32:35], v123 offset:5120
    ds_read_b128 v[36:39], v123 offset:5760
    s_mov_b64 exec, -1
    v_exp_f32 v84, v84
    v_exp_f32 v85, v85
    v_exp_f32 v86, v86
    v_exp_f32 v87, v87
    v_mfma_f32_32x32x8bf16_1k v[96:111], v[20:21], v[8:9], v[96:111]
    v_cvt_pk_bf16_f32 v40, v80, v81
    v_cvt_pk_bf16_f32 v41, v82, v83
    v_cvt_pk_bf16_f32 v42, v84, v85
    v_cvt_pk_bf16_f32 v43, v86, v87
    s_cmp_lg_u32 s18, 0
    s_cbranch_scc1 L_j_72
    v_add_u32 v216, 0x03000300, v216
    v_lshlrev_b32 v137, 16, v216
    v_and_b32 v138, 0xffff0000, v216
    v_cvt_pk_f16_f32 v216, v137, v138
    v_add_u32 v217, 0x03000300, v217
    v_lshlrev_b32 v137, 16, v217
    v_and_b32 v138, 0xffff0000, v217
    v_cvt_pk_f16_f32 v217, v137, v138
    v_add_u32 v218, 0x03000300, v218
    v_lshlrev_b32 v137, 16, v218
    v_and_b32 v138, 0xffff0000, v218
    v_cvt_pk_f16_f32 v218, v137, v138
    v_add_u32 v219, 0x03000300, v219
    v_lshlrev_b32 v137, 16, v219
    v_and_b32 v138, 0xffff0000, v219
    v_cvt_pk_f16_f32 v219, v137, v138
    s_add_u32 s60, s100, 16384
    buffer_store_dwordx4 v[216:219], v117, s[8:11], s60 offen sc0 sc1
L_j_72:
    v_exp_f32 v88, v88
    v_exp_f32 v89, v89
    v_exp_f32 v90, v90
    v_exp_f32 v91, v91
    v_mfma_f32_32x32x16_bf16 v[64:79], v[24:27], v[40:43], v[64:79]
    v_exp_f32 v92, v92
    v_exp_f32 v93, v93
    v_exp_f32 v94, v94
    v_exp_f32 v95, v95
    v_cvt_pk_bf16_f32 v44, v88, v89
    v_cvt_pk_bf16_f32 v45, v90, v91
    v_cvt_pk_bf16_f32 v46, v92, v93
    v_cvt_pk_bf16_f32 v47, v94, v95
    s_setprio 2
    s_waitcnt lgkmcnt(0)
    v_mfma_f32_32x32x16_bf16 v[80:95], v[10:13], v[4:7], v[48:63]
    ds_read_b64_tr_b16 v[16:17], v120 offset:0
    ds_read_b64_tr_b16 v[18:19], v120 offset:64
    ds_read_b64_tr_b16 v[20:21], v120 offset:128
    v_exp_f32 v96, v96
    v_exp_f32 v97, v97
    v_exp_f32 v98, v98
    v_exp_f32 v99, v99
    v_mfma_f32_32x32x16_bf16 v[64:79], v[28:31], v[44:47], v[64:79]
    s_mov_b64 exec, s[36:37]
    ds_read_b128 v[24:27], v123 offset:2560
    ds_read_b128 v[28:31], v123 offset:3200
    s_mov_b64 exec, -1
    v_exp_f32 v100, v100
    v_exp_f32 v101, v101
    v_exp_f32 v102, v102
    v_exp_f32 v103, v103
    v_mfma_f32_32x32x8bf16_1k v[80:95], v[14:15], v[8:9], v[80:95]
    v_cvt_pk_bf16_f32 v40, v96, v97
    v_cvt_pk_bf16_f32 v41, v98, v99
    v_cvt_pk_bf16_f32 v42, v100, v101
    v_cvt_pk_bf16_f32 v43, v102, v103
    v_exp_f32 v104, v104
    v_exp_f32 v105, v105
    v_exp_f32 v106, v106
    v_exp_f32 v107, v107
    v_mfma_f32_32x32x16_bf16 v[64:79], v[32:35], v[40:43], v[64:79]
    v_exp_f32 v108, v108
    v_exp_f32 v109, v109
    v_exp_f32 v110, v110
    v_exp_f32 v111, v111
    v_cvt_pk_bf16_f32 v44, v104, v105
    v_cvt_pk_bf16_f32 v45, v106, v107
    v_cvt_pk_bf16_f32 v46, v108, v109
    v_cvt_pk_bf16_f32 v47, v110, v111
    s_setprio 1
    s_waitcnt lgkmcnt(0)
    v_mfma_f32_32x32x16_bf16 v[96:111], v[16:19], v[4:7], v[48:63]
    ds_read_b64_tr_b16 v[10:11], v119 offset:58880
    ds_read_b64_tr_b16 v[12:13], v119 offset:58944
    ds_read_b64_tr_b16 v[14:15], v119 offset:59008
    v_exp_f32 v80, v80
    v_exp_f32 v81, v81
    v_exp_f32 v82, v82
    v_exp_f32 v83, v83
    v_mfma_f32_32x32x16_bf16 v[64:79], v[36:39], v[44:47], v[64:79]
    s_mov_b64 exec, s[36:37]
    ds_read_b128 v[32:35], v123 offset:0
    ds_read_b128 v[36:39], v123 offset:640
    s_mov_b64 exec, -1
    v_exp_f32 v84, v84
    v_exp_f32 v85, v85
    v_exp_f32 v86, v86
    v_exp_f32 v87, v87
    v_mfma_f32_32x32x8bf16_1k v[96:111], v[20:21], v[8:9], v[96:111]
    v_cvt_pk_bf16_f32 v40, v80, v81
    v_cvt_pk_bf16_f32 v41, v82, v83
    v_cvt_pk_bf16_f32 v42, v84, v85
    v_cvt_pk_bf16_f32 v43, v86, v87
    s_cmp_lg_u32 s18, 0
    s_cbranch_scc1 L_j_73
    v_add_u32 v220, 0x03000300, v220
    v_lshlrev_b32 v137, 16, v220
    v_and_b32 v138, 0xffff0000, v220
    v_cvt_pk_f16_f32 v220, v137, v138
    v_add_u32 v221, 0x03000300, v221
    v_lshlrev_b32 v137, 16, v221
    v_and_b32 v138, 0xffff0000, v221
    v_cvt_pk_f16_f32 v221, v137, v138
    v_add_u32 v222, 0x03000300, v222
    v_lshlrev_b32 v137, 16, v222
    v_and_b32 v138, 0xffff0000, v222
    v_cvt_pk_f16_f32 v222, v137, v138
    v_add_u32 v223, 0x03000300, v223
    v_lshlrev_b32 v137, 16, v223
    v_and_b32 v138, 0xffff0000, v223
    v_cvt_pk_f16_f32 v223, v137, v138
    s_add_u32 s60, s100, 20480
    buffer_store_dwordx4 v[220:223], v117, s[8:11], s60 offen sc0 sc1
L_j_73:
    v_exp_f32 v88, v88
    v_exp_f32 v89, v89
    v_exp_f32 v90, v90
    v_exp_f32 v91, v91
    v_mfma_f32_32x32x16_bf16 v[64:79], v[24:27], v[40:43], v[64:79]
    v_exp_f32 v92, v92
    v_exp_f32 v93, v93
    v_exp_f32 v94, v94
    v_exp_f32 v95, v95
    v_cvt_pk_bf16_f32 v44, v88, v89
    v_cvt_pk_bf16_f32 v45, v90, v91
    v_cvt_pk_bf16_f32 v46, v92, v93
    v_cvt_pk_bf16_f32 v47, v94, v95
    s_setprio 0
    s_waitcnt lgkmcnt(0)
    v_mfma_f32_32x32x16_bf16 v[80:95], v[10:13], v[4:7], v[48:63]
    ds_read_b64_tr_b16 v[16:17], v119 offset:56320
    ds_read_b64_tr_b16 v[18:19], v119 offset:56384
    ds_read_b64_tr_b16 v[20:21], v119 offset:56448
    v_exp_f32 v96, v96
    v_exp_f32 v97, v97
    v_exp_f32 v98, v98
    v_exp_f32 v99, v99
    v_mfma_f32_32x32x16_bf16 v[64:79], v[28:31], v[44:47], v[64:79]
    s_mov_b64 exec, s[36:37]
    ds_read_b128 v[24:27], v122 offset:58880
    ds_read_b128 v[28:31], v122 offset:59520
    s_mov_b64 exec, -1
    v_exp_f32 v100, v100
    v_exp_f32 v101, v101
    v_exp_f32 v102, v102
    v_exp_f32 v103, v103
    v_mfma_f32_32x32x8bf16_1k v[80:95], v[14:15], v[8:9], v[80:95]
    v_cvt_pk_bf16_f32 v40, v96, v97
    v_cvt_pk_bf16_f32 v41, v98, v99
    v_cvt_pk_bf16_f32 v42, v100, v101
    v_cvt_pk_bf16_f32 v43, v102, v103
    v_exp_f32 v104, v104
    v_exp_f32 v105, v105
    v_exp_f32 v106, v106
    v_exp_f32 v107, v107
    v_mfma_f32_32x32x16_bf16 v[64:79], v[32:35], v[40:43], v[64:79]
    v_exp_f32 v108, v108
    v_exp_f32 v109, v109
    v_exp_f32 v110, v110
    v_exp_f32 v111, v111
    v_cvt_pk_bf16_f32 v44, v104, v105
    v_cvt_pk_bf16_f32 v45, v106, v107
    v_cvt_pk_bf16_f32 v46, v108, v109
    v_cvt_pk_bf16_f32 v47, v110, v111
    s_setprio 3
    s_waitcnt lgkmcnt(0)
    v_mfma_f32_32x32x16_bf16 v[96:111], v[16:19], v[4:7], v[48:63]
    ds_read_b64_tr_b16 v[10:11], v119 offset:53760
    ds_read_b64_tr_b16 v[12:13], v119 offset:53824
    ds_read_b64_tr_b16 v[14:15], v119 offset:53888
    v_exp_f32 v80, v80
    v_exp_f32 v81, v81
    v_exp_f32 v82, v82
    v_exp_f32 v83, v83
    v_mfma_f32_32x32x16_bf16 v[64:79], v[36:39], v[44:47], v[64:79]
    s_mov_b64 exec, s[36:37]
    ds_read_b128 v[32:35], v122 offset:56320
    ds_read_b128 v[36:39], v122 offset:56960
    s_mov_b64 exec, -1
    v_exp_f32 v84, v84
    v_exp_f32 v85, v85
    v_exp_f32 v86, v86
    v_exp_f32 v87, v87
    v_mfma_f32_32x32x8bf16_1k v[96:111], v[20:21], v[8:9], v[96:111]
    v_cvt_pk_bf16_f32 v40, v80, v81
    v_cvt_pk_bf16_f32 v41, v82, v83
    v_cvt_pk_bf16_f32 v42, v84, v85
    v_cvt_pk_bf16_f32 v43, v86, v87
    s_cmp_lg_u32 s18, 1
    s_cbranch_scc1 L_j_74
    s_waitcnt vmcnt(0)
    v_add_u32 v208, 0x03000300, v208
    v_lshlrev_b32 v137, 16, v208
    v_and_b32 v138, 0xffff0000, v208
    v_cvt_pk_f16_f32 v208, v137, v138
    v_add_u32 v209, 0x03000300, v209
    v_lshlrev_b32 v137, 16, v209
    v_and_b32 v138, 0xffff0000, v209
    v_cvt_pk_f16_f32 v209, v137, v138
    v_add_u32 v210, 0x03000300, v210
    v_lshlrev_b32 v137, 16, v210
    v_and_b32 v138, 0xffff0000, v210
    v_cvt_pk_f16_f32 v210, v137, v138
    v_add_u32 v211, 0x03000300, v211
    v_lshlrev_b32 v137, 16, v211
    v_and_b32 v138, 0xffff0000, v211
    v_cvt_pk_f16_f32 v211, v137, v138
    s_add_u32 s60, s100, 0
    buffer_store_dwordx4 v[208:211], v117, s[8:11], s60 offen sc0 sc1
L_j_74:
    v_exp_f32 v88, v88
    v_exp_f32 v89, v89
    v_exp_f32 v90, v90
    v_exp_f32 v91, v91
    v_mfma_f32_32x32x16_bf16 v[64:79], v[24:27], v[40:43], v[64:79]
    v_exp_f32 v92, v92
    v_exp_f32 v93, v93
    v_exp_f32 v94, v94
    v_exp_f32 v95, v95
    v_cvt_pk_bf16_f32 v44, v88, v89
    v_cvt_pk_bf16_f32 v45, v90, v91
    v_cvt_pk_bf16_f32 v46, v92, v93
    v_cvt_pk_bf16_f32 v47, v94, v95
    s_setprio 2
    s_waitcnt lgkmcnt(0)
    v_mfma_f32_32x32x16_bf16 v[80:95], v[10:13], v[4:7], v[48:63]
    ds_read_b64_tr_b16 v[16:17], v119 offset:51200
    ds_read_b64_tr_b16 v[18:19], v119 offset:51264
    ds_read_b64_tr_b16 v[20:21], v119 offset:51328
    v_exp_f32 v96, v96
    v_exp_f32 v97, v97
    v_exp_f32 v98, v98
    v_exp_f32 v99, v99
    v_mfma_f32_32x32x16_bf16 v[64:79], v[28:31], v[44:47], v[64:79]
    s_mov_b64 exec, s[36:37]
    ds_read_b128 v[24:27], v122 offset:53760
    ds_read_b128 v[28:31], v122 offset:54400
    s_mov_b64 exec, -1
    v_exp_f32 v100, v100
    v_exp_f32 v101, v101
    v_exp_f32 v102, v102
    v_exp_f32 v103, v103
    v_mfma_f32_32x32x8bf16_1k v[80:95], v[14:15], v[8:9], v[80:95]
    v_cvt_pk_bf16_f32 v40, v96, v97
    v_cvt_pk_bf16_f32 v41, v98, v99
    v_cvt_pk_bf16_f32 v42, v100, v101
    v_cvt_pk_bf16_f32 v43, v102, v103
    s_cmp_lg_u32 s18, 1
    s_cbranch_scc1 L_j_75
    s_cmp_lt_u32 s98, 120
    s_cbranch_scc1 L_np_76
    buffer_store_dwordx4 v[112:115], v127, s[8:11], s43 offen sc0 sc1
L_np_76:
L_j_75:
    s_cmp_lg_u32 s18, 0
    s_cbranch_scc1 L_nox_77
    buffer_load_dwordx2 v[144:145], v168, s[12:15], s94 offen offset:0
    buffer_load_dwordx2 v[146:147], v168, s[12:15], s94 offen offset:32
    buffer_load_dwordx2 v[148:149], v168, s[12:15], s94 offen offset:64
    buffer_load_dwordx2 v[150:151], v168, s[12:15], s94 offen offset:96
    buffer_load_dwordx2 v[152:153], v168, s[12:15], s94 offen offset:128
L_nox_77:
    v_exp_f32 v104, v104
    v_exp_f32 v105, v105
    v_exp_f32 v106, v106
    v_exp_f32 v107, v107
    v_mfma_f32_32x32x16_bf16 v[64:79], v[32:35], v[40:43], v[64:79]
    s_mul_i32 s58, s18, 13824
    v_add_u32 v154, s58, v180
    s_lshl_b32 s39, s18, 10
    s_add_u32 s39, s39, s24
    v_add_u32 v156, s39, v182
    v_add_u32 v157, 49152, v156
    v_exp_f32 v108, v108
    v_exp_f32 v109, v109
    v_exp_f32 v110, v110
    v_exp_f32 v111, v111
    v_cvt_pk_bf16_f32 v44, v104, v105
    v_cvt_pk_bf16_f32 v45, v106, v107
    v_cvt_pk_bf16_f32 v46, v108, v109
    v_cvt_pk_bf16_f32 v47, v110, v111
    s_setprio 1
    s_waitcnt lgkmcnt(0)
    s_barrier
    v_mfma_f32_32x32x16_bf16 v[96:111], v[16:19], v[4:7], v[48:63]
    ds_read_b64_tr_b16 v[10:11], v119 offset:48640
    ds_read_b64_tr_b16 v[12:13], v119 offset:48704
    ds_read_b64_tr_b16 v[14:15], v119 offset:48768
    v_exp_f32 v80, v80
    v_exp_f32 v81, v81
    v_exp_f32 v82, v82
    v_exp_f32 v83, v83
    v_mfma_f32_32x32x16_bf16 v[64:79], v[36:39], v[44:47], v[64:79]
    s_mov_b64 exec, s[36:37]
    ds_read_b128 v[32:35], v122 offset:51200
    ds_read_b128 v[36:39], v122 offset:51840
    s_mov_b64 exec, -1
    v_exp_f32 v84, v84
    v_exp_f32 v85, v85
    v_exp_f32 v86, v86
    v_exp_f32 v87, v87
    v_mfma_f32_32x32x8bf16_1k v[96:111], v[20:21], v[8:9], v[96:111]
    v_cvt_pk_bf16_f32 v40, v80, v81
    v_cvt_pk_bf16_f32 v41, v82, v83
    v_cvt_pk_bf16_f32 v42, v84, v85
    v_cvt_pk_bf16_f32 v43, v86, v87
    s_cmp_lg_u32 s18, 1
    s_cbranch_scc1 L_j_78
    v_add_u32 v212, 0x03000300, v212
    v_lshlrev_b32 v137, 16, v212
    v_and_b32 v138, 0xffff0000, v212
    v_cvt_pk_f16_f32 v212, v137, v138
    v_add_u32 v213, 0x03000300, v213
    v_lshlrev_b32 v137, 16, v213
    v_and_b32 v138, 0xffff0000, v213
    v_cvt_pk_f16_f32 v213, v137, v138
    v_add_u32 v214, 0x03000300, v214
    v_lshlrev_b32 v137, 16, v214
    v_and_b32 v138, 0xffff0000, v214
    v_cvt_pk_f16_f32 v214, v137, v138
    v_add_u32 v215, 0x03000300, v215
    v_lshlrev_b32 v137, 16, v215
    v_and_b32 v138, 0xffff0000, v215
    v_cvt_pk_f16_f32 v215, v137, v138
    s_add_u32 s60, s100, 4096
    buffer_store_dwordx4 v[212:215], v117, s[8:11], s60 offen sc0 sc1
L_j_78:
    v_exp_f32 v88, v88
    v_exp_f32 v89, v89
    v_exp_f32 v90, v90
    v_exp_f32 v91, v91
    v_mfma_f32_32x32x16_bf16 v[64:79], v[24:27], v[40:43], v[64:79]
    s_cmp_lg_u32 s18, 0
    s_cbranch_scc1 L_j_79
    s_add_u32 m0, s62, 0
    s_nop 0
    buffer_load_dwordx4 v128, s[4:7], s96 offen lds
    s_add_u32 m0, s62, 8192
    s_nop 0
    buffer_load_dwordx4 v129, s[4:7], s96 offen lds
L_j_79:
    v_exp_f32 v92, v92
    v_exp_f32 v93, v93
    v_exp_f32 v94, v94
    v_exp_f32 v95, v95
    v_cvt_pk_bf16_f32 v44, v88, v89
    v_cvt_pk_bf16_f32 v45, v90, v91
    v_cvt_pk_bf16_f32 v46, v92, v93
    v_cvt_pk_bf16_f32 v47, v94, v95
    s_setprio 0
    s_waitcnt lgkmcnt(0)
    v_mfma_f32_32x32x16_bf16 v[80:95], v[10:13], v[4:7], v[48:63]
    ds_read_b64_tr_b16 v[16:17], v119 offset:46080
    ds_read_b64_tr_b16 v[18:19], v119 offset:46144
    ds_read_b64_tr_b16 v[20:21], v119 offset:46208
    v_exp_f32 v96, v96
    v_exp_f32 v97, v97
    v_exp_f32 v98, v98
    v_exp_f32 v99, v99
    v_mfma_f32_32x32x16_bf16 v[64:79], v[28:31], v[44:47], v[64:79]
    s_mov_b64 exec, s[36:37]
    ds_read_b128 v[24:27], v122 offset:48640
    ds_read_b128 v[28:31], v122 offset:49280
    s_mov_b64 exec, -1
    v_exp_f32 v100, v100
    v_exp_f32 v101, v101
    v_exp_f32 v102, v102
    v_exp_f32 v103, v103
    v_mfma_f32_32x32x8bf16_1k v[80:95], v[14:15], v[8:9], v[80:95]
    v_cvt_pk_bf16_f32 v40, v96, v97
    v_cvt_pk_bf16_f32 v41, v98, v99
    v_cvt_pk_bf16_f32 v42, v100, v101
    v_cvt_pk_bf16_f32 v43, v102, v103
    s_cmp_lg_u32 s18, 0
    s_cbranch_scc1 L_j_80
    s_add_u32 m0, s62, 16384
    s_nop 0
    buffer_load_dwordx4 v130, s[4:7], s96 offen lds
    s_add_u32 m0, s62, 24576
    s_nop 0
    buffer_load_dwordx4 v131, s[4:7], s96 offen lds
L_j_80:
    v_exp_f32 v104, v104
    v_exp_f32 v105, v105
    v_exp_f32 v106, v106
    v_exp_f32 v107, v107
    v_mfma_f32_32x32x16_bf16 v[64:79], v[32:35], v[40:43], v[64:79]
    v_exp_f32 v108, v108
    v_exp_f32 v109, v109
    v_exp_f32 v110, v110
    v_exp_f32 v111, v111
    v_cvt_pk_bf16_f32 v44, v104, v105
    v_cvt_pk_bf16_f32 v45, v106, v107
    v_cvt_pk_bf16_f32 v46, v108, v109
    v_cvt_pk_bf16_f32 v47, v110, v111
    s_setprio 3
    s_waitcnt lgkmcnt(0)
    v_mfma_f32_32x32x16_bf16 v[96:111], v[16:19], v[4:7], v[48:63]
    ds_read_b64_tr_b16 v[10:11], v119 offset:43520
    ds_read_b64_tr_b16 v[12:13], v119 offset:43584
    ds_read_b64_tr_b16 v[14:15], v119 offset:43648
    v_exp_f32 v80, v80
    v_exp_f32 v81, v81
    v_exp_f32 v82, v82
    v_exp_f32 v83, v83
    v_mfma_f32_32x32x16_bf16 v[64:79], v[36:39], v[44:47], v[64:79]
    s_mov_b64 exec, s[36:37]
    ds_read_b128 v[32:35], v122 offset:46080
    ds_read_b128 v[36:39], v122 offset:46720
    s_mov_b64 exec, -1
    v_exp_f32 v84, v84
    v_exp_f32 v85, v85
    v_exp_f32 v86, v86
    v_exp_f32 v87, v87
    v_mfma_f32_32x32x8bf16_1k v[96:111], v[20:21], v[8:9], v[96:111]
    v_cvt_pk_bf16_f32 v40, v80, v81
    v_cvt_pk_bf16_f32 v41, v82, v83
    v_cvt_pk_bf16_f32 v42, v84, v85
    v_cvt_pk_bf16_f32 v43, v86, v87
    s_cmp_lg_u32 s18, 1
    s_cbranch_scc1 L_j_81
    v_add_u32 v216, 0x03000300, v216
    v_lshlrev_b32 v137, 16, v216
    v_and_b32 v138, 0xffff0000, v216
    v_cvt_pk_f16_f32 v216, v137, v138
    v_add_u32 v217, 0x03000300, v217
    v_lshlrev_b32 v137, 16, v217
    v_and_b32 v138, 0xffff0000, v217
    v_cvt_pk_f16_f32 v217, v137, v138
    v_add_u32 v218, 0x03000300, v218
    v_lshlrev_b32 v137, 16, v218
    v_and_b32 v138, 0xffff0000, v218
    v_cvt_pk_f16_f32 v218, v137, v138
    v_add_u32 v219, 0x03000300, v219
    v_lshlrev_b32 v137, 16, v219
    v_and_b32 v138, 0xffff0000, v219
    v_cvt_pk_f16_f32 v219, v137, v138
    s_add_u32 s60, s100, 16384
    buffer_store_dwordx4 v[216:219], v117, s[8:11], s60 offen sc0 sc1
L_j_81:
    v_exp_f32 v88, v88
    v_exp_f32 v89, v89
    v_exp_f32 v90, v90
    v_exp_f32 v91, v91
    v_mfma_f32_32x32x16_bf16 v[64:79], v[24:27], v[40:43], v[64:79]
    s_cmp_lg_u32 s18, 0
    s_cbranch_scc1 L_j_82
    s_add_u32 m0, s62, 32768
    s_nop 0
    buffer_load_dwordx4 v132, s[4:7], s96 offen lds
    s_add_u32 s96, s96, 327680
    s_add_u32 m0, s62, 40960
    s_nop 0
    buffer_load_dwordx4 v128, s[4:7], s96 offen lds
L_j_82:
    v_exp_f32 v92, v92
    v_exp_f32 v93, v93
    v_exp_f32 v94, v94
    v_exp_f32 v95, v95
    v_cvt_pk_bf16_f32 v44, v88, v89
    v_cvt_pk_bf16_f32 v45, v90, v91
    v_cvt_pk_bf16_f32 v46, v92, v93
    v_cvt_pk_bf16_f32 v47, v94, v95
    s_setprio 2
    s_waitcnt lgkmcnt(0)
    v_mfma_f32_32x32x16_bf16 v[80:95], v[10:13], v[4:7], v[48:63]
    ds_read_b64_tr_b16 v[16:17], v119 offset:40960
    ds_read_b64_tr_b16 v[18:19], v119 offset:41024
    ds_read_b64_tr_b16 v[20:21], v119 offset:41088
    v_exp_f32 v96, v96
    v_exp_f32 v97, v97
    v_exp_f32 v98, v98
    v_exp_f32 v99, v99
    v_mfma_f32_32x32x16_bf16 v[64:79], v[28:31], v[44:47], v[64:79]
    s_mov_b64 exec, s[36:37]
    ds_read_b128 v[24:27], v122 offset:43520
    ds_read_b128 v[28:31], v122 offset:44160
    s_mov_b64 exec, -1
    v_exp_f32 v100, v100
    v_exp_f32 v101, v101
    v_exp_f32 v102, v102
    v_exp_f32 v103, v103
    v_mfma_f32_32x32x8bf16_1k v[80:95], v[14:15], v[8:9], v[80:95]
    v_cvt_pk_bf16_f32 v40, v96, v97
    v_cvt_pk_bf16_f32 v41, v98, v99
    v_cvt_pk_bf16_f32 v42, v100, v101
    v_cvt_pk_bf16_f32 v43, v102, v103
    s_cmp_lg_u32 s18, 0
    s_cbranch_scc1 L_j_83
    s_add_u32 m0, s62, 49152
    s_nop 0
    buffer_load_dwordx4 v129, s[4:7], s96 offen lds
    s_add_u32 m0, s62, 57344
    s_nop 0
    buffer_load_dwordx4 v130, s[4:7], s96 offen lds
L_j_83:
    v_exp_f32 v104, v104
    v_exp_f32 v105, v105
    v_exp_f32 v106, v106
    v_exp_f32 v107, v107
    v_mfma_f32_32x32x16_bf16 v[64:79], v[32:35], v[40:43], v[64:79]
    v_exp_f32 v108, v108
    v_exp_f32 v109, v109
    v_exp_f32 v110, v110
    v_exp_f32 v111, v111
    v_cvt_pk_bf16_f32 v44, v104, v105
    v_cvt_pk_bf16_f32 v45, v106, v107
    v_cvt_pk_bf16_f32 v46, v108, v109
    v_cvt_pk_bf16_f32 v47, v110, v111
    s_setprio 1
    s_waitcnt lgkmcnt(0)
    v_mfma_f32_32x32x16_bf16 v[96:111], v[16:19], v[4:7], v[48:63]
    ds_read_b64_tr_b16 v[10:11], v119 offset:38400
    ds_read_b64_tr_b16 v[12:13], v119 offset:38464
    ds_read_b64_tr_b16 v[14:15], v119 offset:38528
    v_exp_f32 v80, v80
    v_exp_f32 v81, v81
    v_exp_f32 v82, v82
    v_exp_f32 v83, v83
    v_mfma_f32_32x32x16_bf16 v[64:79], v[36:39], v[44:47], v[64:79]
    s_mov_b64 exec, s[36:37]
    ds_read_b128 v[32:35], v122 offset:40960
    ds_read_b128 v[36:39], v122 offset:41600
    s_mov_b64 exec, -1
    v_exp_f32 v84, v84
    v_exp_f32 v85, v85
    v_exp_f32 v86, v86
    v_exp_f32 v87, v87
    v_mfma_f32_32x32x8bf16_1k v[96:111], v[20:21], v[8:9], v[96:111]
    v_cvt_pk_bf16_f32 v40, v80, v81
    v_cvt_pk_bf16_f32 v41, v82, v83
    v_cvt_pk_bf16_f32 v42, v84, v85
    v_cvt_pk_bf16_f32 v43, v86, v87
    s_cmp_lg_u32 s18, 1
    s_cbranch_scc1 L_j_84
    v_add_u32 v220, 0x03000300, v220
    v_lshlrev_b32 v137, 16, v220
    v_and_b32 v138, 0xffff0000, v220
    v_cvt_pk_f16_f32 v220, v137, v138
    v_add_u32 v221, 0x03000300, v221
    v_lshlrev_b32 v137, 16, v221
    v_and_b32 v138, 0xffff0000, v221
    v_cvt_pk_f16_f32 v221, v137, v138
    v_add_u32 v222, 0x03000300, v222
    v_lshlrev_b32 v137, 16, v222
    v_and_b32 v138, 0xffff0000, v222
    v_cvt_pk_f16_f32 v222, v137, v138
    v_add_u32 v223, 0x03000300, v223
    v_lshlrev_b32 v137, 16, v223
    v_and_b32 v138, 0xffff0000, v223
    v_cvt_pk_f16_f32 v223, v137, v138
    s_add_u32 s60, s100, 20480
    buffer_store_dwordx4 v[220:223], v117, s[8:11], s60 offen sc0 sc1
L_j_84:
    v_exp_f32 v88, v88
    v_exp_f32 v89, v89
    v_exp_f32 v90, v90
    v_exp_f32 v91, v91
    v_mfma_f32_32x32x16_bf16 v[64:79], v[24:27], v[40:43], v[64:79]
    s_cmp_lg_u32 s18, 0
    s_cbranch_scc1 L_j_85
    s_add_u32 m0, s62, 65536
    s_nop 0
    buffer_load_dwordx4 v131, s[4:7], s96 offen lds
    s_add_u32 m0, s62, 73728
    s_nop 0
    buffer_load_dwordx4 v132, s[4:7], s96 offen lds
    s_add_u32 s96, s96, 327680
L_j_85:
    v_exp_f32 v92, v92
    v_exp_f32 v93, v93
    v_exp_f32 v94, v94
    v_exp_f32 v95, v95
    v_cvt_pk_bf16_f32 v44, v88, v89
    v_cvt_pk_bf16_f32 v45, v90, v91
    v_cvt_pk_bf16_f32 v46, v92, v93
    v_cvt_pk_bf16_f32 v47, v94, v95
    s_setprio 0
    s_waitcnt lgkmcnt(0)
    v_mfma_f32_32x32x16_bf16 v[80:95], v[10:13], v[4:7], v[48:63]
    ds_read_b64_tr_b16 v[16:17], v119 offset:35840
    ds_read_b64_tr_b16 v[18:19], v119 offset:35904
    ds_read_b64_tr_b16 v[20:21], v119 offset:35968
    v_exp_f32 v96, v96
    v_exp_f32 v97, v97
    v_exp_f32 v98, v98
    v_exp_f32 v99, v99
    v_mfma_f32_32x32x16_bf16 v[64:79], v[28:31], v[44:47], v[64:79]
    s_mov_b64 exec, s[36:37]
    ds_read_b128 v[24:27], v122 offset:38400
    ds_read_b128 v[28:31], v122 offset:39040
    s_mov_b64 exec, -1
    v_exp_f32 v100, v100
    v_exp_f32 v101, v101
    v_exp_f32 v102, v102
    v_exp_f32 v103, v103
    v_mfma_f32_32x32x8bf16_1k v[80:95], v[14:15], v[8:9], v[80:95]
    v_cvt_pk_bf16_f32 v40, v96, v97
    v_cvt_pk_bf16_f32 v41, v98, v99
    v_cvt_pk_bf16_f32 v42, v100, v101
    v_cvt_pk_bf16_f32 v43, v102, v103
    s_cmp_lg_u32 s18, 0
    s_cbranch_scc1 L_j_86
    s_add_u32 m0, s62, 81920
    s_nop 0
    buffer_load_dwordx4 v128, s[4:7], s96 offen lds
    s_add_u32 m0, s62, 90112
    s_nop 0
    buffer_load_dwordx4 v129, s[4:7], s96 offen lds
L_j_86:
    v_exp_f32 v104, v104
    v_exp_f32 v105, v105
    v_exp_f32 v106, v106
    v_exp_f32 v107, v107
    v_mfma_f32_32x32x16_bf16 v[64:79], v[32:35], v[40:43], v[64:79]
    v_exp_f32 v108, v108
    v_exp_f32 v109, v109
    v_exp_f32 v110, v110
    v_exp_f32 v111, v111
    v_cvt_pk_bf16_f32 v44, v104, v105
    v_cvt_pk_bf16_f32 v45, v106, v107
    v_cvt_pk_bf16_f32 v46, v108, v109
    v_cvt_pk_bf16_f32 v47, v110, v111
    s_setprio 3
    s_waitcnt lgkmcnt(0)
    v_mfma_f32_32x32x16_bf16 v[96:111], v[16:19], v[4:7], v[48:63]
    ds_read_b64_tr_b16 v[10:11], v119 offset:33280
    ds_read_b64_tr_b16 v[12:13], v119 offset:33344
    ds_read_b64_tr_b16 v[14:15], v119 offset:33408
    v_exp_f32 v80, v80
    v_exp_f32 v81, v81
    v_exp_f32 v82, v82
    v_exp_f32 v83, v83
    v_mfma_f32_32x32x16_bf16 v[64:79], v[36:39], v[44:47], v[64:79]
    s_mov_b64 exec, s[36:37]
    ds_read_b128 v[32:35], v122 offset:35840
    ds_read_b128 v[36:39], v122 offset:36480
    s_mov_b64 exec, -1
    v_exp_f32 v84, v84
    v_exp_f32 v85, v85
    v_exp_f32 v86, v86
    v_exp_f32 v87, v87
    v_mfma_f32_32x32x8bf16_1k v[96:111], v[20:21], v[8:9], v[96:111]
    v_cvt_pk_bf16_f32 v40, v80, v81
    v_cvt_pk_bf16_f32 v41, v82, v83
    v_cvt_pk_bf16_f32 v42, v84, v85
    v_cvt_pk_bf16_f32 v43, v86, v87
    s_cmp_lg_u32 s18, 1
    s_cbranch_scc1 L_j_87
    s_add_u32 m0, s62, 0
    s_nop 0
    buffer_load_dwordx4 v128, s[4:7], s96 offen lds
    s_add_u32 m0, s62, 8192
    s_nop 0
    buffer_load_dwordx4 v129, s[4:7], s96 offen lds
L_j_87:
    v_exp_f32 v88, v88
    v_exp_f32 v89, v89
    v_exp_f32 v90, v90
    v_exp_f32 v91, v91
    v_mfma_f32_32x32x16_bf16 v[64:79], v[24:27], v[40:43], v[64:79]
    s_cmp_lg_u32 s18, 0
    s_cbranch_scc1 L_j_88
    s_add_u32 m0, s62, 98304
    s_nop 0
    buffer_load_dwordx4 v130, s[4:7], s96 offen lds
L_j_88:
    v_exp_f32 v92, v92
    v_exp_f32 v93, v93
    v_exp_f32 v94, v94
    v_exp_f32 v95, v95
    v_cvt_pk_bf16_f32 v44, v88, v89
    v_cvt_pk_bf16_f32 v45, v90, v91
    v_cvt_pk_bf16_f32 v46, v92, v93
    v_cvt_pk_bf16_f32 v47, v94, v95
    s_setprio 2
    s_waitcnt lgkmcnt(0)
    v_mfma_f32_32x32x16_bf16 v[80:95], v[10:13], v[4:7], v[48:63]
    ds_read_b64_tr_b16 v[16:17], v119 offset:30720
    ds_read_b64_tr_b16 v[18:19], v119 offset:30784
    ds_read_b64_tr_b16 v[20:21], v119 offset:30848
    v_exp_f32 v96, v96
    v_exp_f32 v97, v97
    v_exp_f32 v98, v98
    v_exp_f32 v99, v99
    v_mfma_f32_32x32x16_bf16 v[64:79], v[28:31], v[44:47], v[64:79]
    s_mov_b64 exec, s[36:37]
    ds_read_b128 v[24:27], v122 offset:33280
    ds_read_b128 v[28:31], v122 offset:33920
    s_mov_b64 exec, -1
    v_exp_f32 v100, v100
    v_exp_f32 v101, v101
    v_exp_f32 v102, v102
    v_exp_f32 v103, v103
    v_mfma_f32_32x32x8bf16_1k v[80:95], v[14:15], v[8:9], v[80:95]
    v_cvt_pk_bf16_f32 v40, v96, v97
    v_cvt_pk_bf16_f32 v41, v98, v99
    v_cvt_pk_bf16_f32 v42, v100, v101
    v_cvt_pk_bf16_f32 v43, v102, v103
    s_cmp_lg_u32 s18, 1
    s_cbranch_scc1 L_j_89
    s_add_u32 m0, s62, 16384
    s_nop 0
    buffer_load_dwordx4 v130, s[4:7], s96 offen lds
    s_add_u32 m0, s62, 24576
    s_nop 0
    buffer_load_dwordx4 v131, s[4:7], s96 offen lds
L_j_89:
    v_exp_f32 v104, v104
    v_exp_f32 v105, v105
    v_exp_f32 v106, v106
    v_exp_f32 v107, v107
    v_mfma_f32_32x32x16_bf16 v[64:79], v[32:35], v[40:43], v[64:79]
    v_exp_f32 v108, v108
    v_exp_f32 v109, v109
    v_exp_f32 v110, v110
    v_exp_f32 v111, v111
    v_cvt_pk_bf16_f32 v44, v104, v105
    v_cvt_pk_bf16_f32 v45, v106, v107
    v_cvt_pk_bf16_f32 v46, v108, v109
    v_cvt_pk_bf16_f32 v47, v110, v111
    s_setprio 1
    s_waitcnt lgkmcnt(0)
    v_mfma_f32_32x32x16_bf16 v[96:111], v[16:19], v[4:7], v[48:63]
    ds_read_b64_tr_b16 v[10:11], v119 offset:28160
    ds_read_b64_tr_b16 v[12:13], v119 offset:28224
    ds_read_b64_tr_b16 v[14:15], v119 offset:28288
    v_exp_f32 v80, v80
    v_exp_f32 v81, v81
    v_exp_f32 v82, v82
    v_exp_f32 v83, v83
    v_mfma_f32_32x32x16_bf16 v[64:79], v[36:39], v[44:47], v[64:79]
    s_mov_b64 exec, s[36:37]
    ds_read_b128 v[32:35], v122 offset:30720
    ds_read_b128 v[36:39], v122 offset:31360
    s_mov_b64 exec, -1
    v_exp_f32 v84, v84
    v_exp_f32 v85, v85
    v_exp_f32 v86, v86
    v_exp_f32 v87, v87
    v_mfma_f32_32x32x8bf16_1k v[96:111], v[20:21], v[8:9], v[96:111]
    v_cvt_pk_bf16_f32 v40, v80, v81
    v_cvt_pk_bf16_f32 v41, v82, v83
    v_cvt_pk_bf16_f32 v42, v84, v85
    v_cvt_pk_bf16_f32 v43, v86, v87
    s_cmp_lg_u32 s18, 1
    s_cbranch_scc1 L_j_90
    s_add_u32 m0, s62, 32768
    s_nop 0
    buffer_load_dwordx4 v132, s[4:7], s96 offen lds
    s_add_u32 s96, s96, 327680
    s_add_u32 m0, s62, 40960
    s_nop 0
    buffer_load_dwordx4 v128, s[4:7], s96 offen lds
L_j_90:
    v_exp_f32 v88, v88
    v_exp_f32 v89, v89
    v_exp_f32 v90, v90
    v_exp_f32 v91, v91
    v_mfma_f32_32x32x16_bf16 v[64:79], v[24:27], v[40:43], v[64:79]
    s_add_u32 s60, s19, 1105920
    buffer_load_dwordx4 v[208:211], v154, s[52:55], s60 offen
    v_exp_f32 v92, v92
    v_exp_f32 v93, v93
    v_exp_f32 v94, v94
    v_exp_f32 v95, v95
    v_cvt_pk_bf16_f32 v44, v88, v89
    v_cvt_pk_bf16_f32 v45, v90, v91
    v_cvt_pk_bf16_f32 v46, v92, v93
    v_cvt_pk_bf16_f32 v47, v94, v95
    s_setprio 0
    s_waitcnt lgkmcnt(0)
    v_mfma_f32_32x32x16_bf16 v[80:95], v[10:13], v[4:7], v[48:63]
    ds_read_b64_tr_b16 v[16:17], v119 offset:25600
    ds_read_b64_tr_b16 v[18:19], v119 offset:25664
    ds_read_b64_tr_b16 v[20:21], v119 offset:25728
    v_exp_f32 v96, v96
    v_exp_f32 v97, v97
    v_exp_f32 v98, v98
    v_exp_f32 v99, v99
    v_mfma_f32_32x32x16_bf16 v[64:79], v[28:31], v[44:47], v[64:79]
    s_mov_b64 exec, s[36:37]
    ds_read_b128 v[24:27], v122 offset:28160
    ds_read_b128 v[28:31], v122 offset:28800
    s_mov_b64 exec, -1
    v_exp_f32 v100, v100
    v_exp_f32 v101, v101
    v_exp_f32 v102, v102
    v_exp_f32 v103, v103
    v_mfma_f32_32x32x8bf16_1k v[80:95], v[14:15], v[8:9], v[80:95]
    v_cvt_pk_bf16_f32 v40, v96, v97
    v_cvt_pk_bf16_f32 v41, v98, v99
    v_cvt_pk_bf16_f32 v42, v100, v101
    v_cvt_pk_bf16_f32 v43, v102, v103
    s_cmp_lg_u32 s18, 1
    s_cbranch_scc1 L_j_91
    s_add_u32 m0, s62, 49152
    s_nop 0
    buffer_load_dwordx4 v129, s[4:7], s96 offen lds
    s_add_u32 m0, s62, 57344
    s_nop 0
    buffer_load_dwordx4 v130, s[4:7], s96 offen lds
L_j_91:
    v_exp_f32 v104, v104
    v_exp_f32 v105, v105
    v_exp_f32 v106, v106
    v_exp_f32 v107, v107
    v_mfma_f32_32x32x16_bf16 v[64:79], v[32:35], v[40:43], v[64:79]
    s_add_u32 s60, s19, 110592
    buffer_load_dwordx4 v[212:215], v154, s[52:55], s60 offen
    v_exp_f32 v108, v108
    v_exp_f32 v109, v109
    v_exp_f32 v110, v110
    v_exp_f32 v111, v111
    v_cvt_pk_bf16_f32 v44, v104, v105
    v_cvt_pk_bf16_f32 v45, v106, v107
    v_cvt_pk_bf16_f32 v46, v108, v109
    v_cvt_pk_bf16_f32 v47, v110, v111
    s_setprio 3
    s_waitcnt lgkmcnt(0)
    v_mfma_f32_32x32x16_bf16 v[96:111], v[16:19], v[4:7], v[48:63]
    ds_read_b64_tr_b16 v[10:11], v119 offset:23040
    ds_read_b64_tr_b16 v[12:13], v119 offset:23104
    ds_read_b64_tr_b16 v[14:15], v119 offset:23168
    v_exp_f32 v80, v80
    v_exp_f32 v81, v81
    v_exp_f32 v82, v82
    v_exp_f32 v83, v83
    v_mfma_f32_32x32x16_bf16 v[64:79], v[36:39], v[44:47], v[64:79]
    s_mov_b64 exec, s[36:37]
    ds_read_b128 v[32:35], v122 offset:25600
    ds_read_b128 v[36:39], v122 offset:26240
    s_mov_b64 exec, -1
    v_exp_f32 v84, v84
    v_exp_f32 v85, v85
    v_exp_f32 v86, v86
    v_exp_f32 v87, v87
    v_mfma_f32_32x32x8bf16_1k v[96:111], v[20:21], v[8:9], v[96:111]
    v_cvt_pk_bf16_f32 v40, v80, v81
    v_cvt_pk_bf16_f32 v41, v82, v83
    v_cvt_pk_bf16_f32 v42, v84, v85
    v_cvt_pk_bf16_f32 v43, v86, v87
    s_cmp_lg_u32 s18, 1
    s_cbranch_scc1 L_j_92
    s_add_u32 m0, s62, 65536
    s_nop 0
    buffer_load_dwordx4 v131, s[4:7], s96 offen lds
    s_add_u32 m0, s62, 73728
    s_nop 0
    buffer_load_dwordx4 v132, s[4:7], s96 offen lds
    s_add_u32 s96, s96, 327680
L_j_92:
    v_exp_f32 v88, v88
    v_exp_f32 v89, v89
    v_exp_f32 v90, v90
    v_exp_f32 v91, v91
    v_mfma_f32_32x32x16_bf16 v[64:79], v[24:27], v[40:43], v[64:79]
    s_add_u32 s60, s19, 221184
    buffer_load_dwordx4 v[216:219], v154, s[52:55], s60 offen
    v_exp_f32 v92, v92
    v_exp_f32 v93, v93
    v_exp_f32 v94, v94
    v_exp_f32 v95, v95
    v_cvt_pk_bf16_f32 v44, v88, v89
    v_cvt_pk_bf16_f32 v45, v90, v91
    v_cvt_pk_bf16_f32 v46, v92, v93
    v_cvt_pk_bf16_f32 v47, v94, v95
    s_setprio 2
    s_waitcnt lgkmcnt(0)
    v_mfma_f32_32x32x16_bf16 v[80:95], v[10:13], v[4:7], v[48:63]
    ds_read_b64_tr_b16 v[16:17], v119 offset:20480
    ds_read_b64_tr_b16 v[18:19], v119 offset:20544
    ds_read_b64_tr_b16 v[20:21], v119 offset:20608
    v_exp_f32 v96, v96
    v_exp_f32 v97, v97
    v_exp_f32 v98, v98
    v_exp_f32 v99, v99
    v_mfma_f32_32x32x16_bf16 v[64:79], v[28:31], v[44:47], v[64:79]
    s_mov_b64 exec, s[36:37]
    ds_read_b128 v[24:27], v122 offset:23040
    ds_read_b128 v[28:31], v122 offset:23680
    s_mov_b64 exec, -1
    v_exp_f32 v100, v100
    v_exp_f32 v101, v101
    v_exp_f32 v102, v102
    v_exp_f32 v103, v103
    v_mfma_f32_32x32x8bf16_1k v[80:95], v[14:15], v[8:9], v[80:95]
    v_cvt_pk_bf16_f32 v40, v96, v97
    v_cvt_pk_bf16_f32 v41, v98, v99
    v_cvt_pk_bf16_f32 v42, v100, v101
    v_cvt_pk_bf16_f32 v43, v102, v103
    s_cmp_lg_u32 s18, 1
    s_cbranch_scc1 L_j_93
    s_add_u32 m0, s62, 81920
    s_nop 0
    buffer_load_dwordx4 v128, s[4:7], s96 offen lds
    s_add_u32 m0, s62, 90112
    s_nop 0
    buffer_load_dwordx4 v129, s[4:7], s96 offen lds
L_j_93:
    v_exp_f32 v104, v104
    v_exp_f32 v105, v105
    v_exp_f32 v106, v106
    v_exp_f32 v107, v107
    v_mfma_f32_32x32x16_bf16 v[64:79], v[32:35], v[40:43], v[64:79]
    s_add_u32 s60, s19, 331776
    buffer_load_dwordx4 v[220:223], v154, s[52:55], s60 offen
    v_exp_f32 v108, v108
    v_exp_f32 v109, v109
    v_exp_f32 v110, v110
    v_exp_f32 v111, v111
    v_cvt_pk_bf16_f32 v44, v104, v105
    v_cvt_pk_bf16_f32 v45, v106, v107
    v_cvt_pk_bf16_f32 v46, v108, v109
    v_cvt_pk_bf16_f32 v47, v110, v111
    s_setprio 1
    s_waitcnt lgkmcnt(0)
    v_mfma_f32_32x32x16_bf16 v[96:111], v[16:19], v[4:7], v[48:63]
    ds_read_b64_tr_b16 v[10:11], v119 offset:17920
    ds_read_b64_tr_b16 v[12:13], v119 offset:17984
    ds_read_b64_tr_b16 v[14:15], v119 offset:18048
    v_exp_f32 v80, v80
    v_exp_f32 v81, v81
    v_exp_f32 v82, v82
    v_exp_f32 v83, v83
    v_mfma_f32_32x32x16_bf16 v[64:79], v[36:39], v[44:47], v[64:79]
    s_mov_b64 exec, s[36:37]
    ds_read_b128 v[32:35], v122 offset:20480
    ds_read_b128 v[36:39], v122 offset:21120
    s_mov_b64 exec, -1
    v_exp_f32 v84, v84
    v_exp_f32 v85, v85
    v_exp_f32 v86, v86
    v_exp_f32 v87, v87
    v_mfma_f32_32x32x8bf16_1k v[96:111], v[20:21], v[8:9], v[96:111]
    v_cvt_pk_bf16_f32 v40, v80, v81
    v_cvt_pk_bf16_f32 v41, v82, v83
    v_cvt_pk_bf16_f32 v42, v84, v85
    v_cvt_pk_bf16_f32 v43, v86, v87
    s_cmp_lg_u32 s18, 1
    s_cbranch_scc1 L_j_94
    s_add_u32 m0, s62, 98304
    s_nop 0
    buffer_load_dwordx4 v130, s[4:7], s96 offen lds
L_j_94:
    v_exp_f32 v88, v88
    v_exp_f32 v89, v89
    v_exp_f32 v90, v90
    v_exp_f32 v91, v91
    v_mfma_f32_32x32x16_bf16 v[64:79], v[24:27], v[40:43], v[64:79]
    s_add_u32 s60, s19, 442368
    buffer_load_dwordx4 v[224:227], v154, s[52:55], s60 offen
    v_exp_f32 v92, v92
    v_exp_f32 v93, v93
    v_exp_f32 v94, v94
    v_exp_f32 v95, v95
    v_cvt_pk_bf16_f32 v44, v88, v89
    v_cvt_pk_bf16_f32 v45, v90, v91
    v_cvt_pk_bf16_f32 v46, v92, v93
    v_cvt_pk_bf16_f32 v47, v94, v95
    s_setprio 0
    s_waitcnt lgkmcnt(0)
    v_mfma_f32_32x32x16_bf16 v[80:95], v[10:13], v[4:7], v[48:63]
    ds_read_b64_tr_b16 v[16:17], v119 offset:15360
    ds_read_b64_tr_b16 v[18:19], v119 offset:15424
    ds_read_b64_tr_b16 v[20:21], v119 offset:15488
    v_exp_f32 v96, v96
    v_exp_f32 v97, v97
    v_exp_f32 v98, v98
    v_exp_f32 v99, v99
    v_mfma_f32_32x32x16_bf16 v[64:79], v[28:31], v[44:47], v[64:79]
    s_mov_b64 exec, s[36:37]
    ds_read_b128 v[24:27], v122 offset:17920
    ds_read_b128 v[28:31], v122 offset:18560
    s_mov_b64 exec, -1
    v_exp_f32 v100, v100
    v_exp_f32 v101, v101
    v_exp_f32 v102, v102
    v_exp_f32 v103, v103
    v_mfma_f32_32x32x8bf16_1k v[80:95], v[14:15], v[8:9], v[80:95]
    v_cvt_pk_bf16_f32 v40, v96, v97
    v_cvt_pk_bf16_f32 v41, v98, v99
    v_cvt_pk_bf16_f32 v42, v100, v101
    v_cvt_pk_bf16_f32 v43, v102, v103
    s_add_u32 s60, s19, 552960
    buffer_load_dwordx4 v[228:231], v154, s[52:55], s60 offen
    v_exp_f32 v104, v104
    v_exp_f32 v105, v105
    v_exp_f32 v106, v106
    v_exp_f32 v107, v107
    v_mfma_f32_32x32x16_bf16 v[64:79], v[32:35], v[40:43], v[64:79]
    v_exp_f32 v108, v108
    v_exp_f32 v109, v109
    v_exp_f32 v110, v110
    v_exp_f32 v111, v111
    v_cvt_pk_bf16_f32 v44, v104, v105
    v_cvt_pk_bf16_f32 v45, v106, v107
    v_cvt_pk_bf16_f32 v46, v108, v109
    v_cvt_pk_bf16_f32 v47, v110, v111
    s_setprio 3
    s_waitcnt lgkmcnt(0)
    v_mfma_f32_32x32x16_bf16 v[96:111], v[16:19], v[4:7], v[48:63]
    ds_read_b64_tr_b16 v[10:11], v119 offset:12800
    ds_read_b64_tr_b16 v[12:13], v119 offset:12864
    ds_read_b64_tr_b16 v[14:15], v119 offset:12928
    v_exp_f32 v80, v80
    v_exp_f32 v81, v81
    v_exp_f32 v82, v82
    v_exp_f32 v83, v83
    v_mfma_f32_32x32x16_bf16 v[64:79], v[36:39], v[44:47], v[64:79]
    s_mov_b64 exec, s[36:37]
    ds_read_b128 v[32:35], v122 offset:15360
    ds_read_b128 v[36:39], v122 offset:16000
    s_mov_b64 exec, -1
    v_exp_f32 v84, v84
    v_exp_f32 v85, v85
    v_exp_f32 v86, v86
    v_exp_f32 v87, v87
    v_mfma_f32_32x32x8bf16_1k v[96:111], v[20:21], v[8:9], v[96:111]
    v_cvt_pk_bf16_f32 v40, v80, v81
    v_cvt_pk_bf16_f32 v41, v82, v83
    v_cvt_pk_bf16_f32 v42, v84, v85
    v_cvt_pk_bf16_f32 v43, v86, v87
    v_exp_f32 v88, v88
    v_exp_f32 v89, v89
    v_exp_f32 v90, v90
    v_exp_f32 v91, v91
    v_mfma_f32_32x32x16_bf16 v[64:79], v[24:27], v[40:43], v[64:79]
    v_exp_f32 v92, v92
    v_exp_f32 v93, v93
    v_exp_f32 v94, v94
    v_exp_f32 v95, v95
    v_cvt_pk_bf16_f32 v44, v88, v89
    v_cvt_pk_bf16_f32 v45, v90, v91
    v_cvt_pk_bf16_f32 v46, v92, v93
    v_cvt_pk_bf16_f32 v47, v94, v95
    s_setprio 2
    s_waitcnt lgkmcnt(0)
    v_mfma_f32_32x32x16_bf16 v[80:95], v[10:13], v[4:7], v[48:63]
    ds_read_b64_tr_b16 v[16:17], v119 offset:10240
    ds_read_b64_tr_b16 v[18:19], v119 offset:10304
    ds_read_b64_tr_b16 v[20:21], v119 offset:10368
    v_exp_f32 v96, v96
    v_exp_f32 v97, v97
    v_exp_f32 v98, v98
    v_exp_f32 v99, v99
    v_mfma_f32_32x32x16_bf16 v[64:79], v[28:31], v[44:47], v[64:79]
    s_mov_b64 exec, s[36:37]
    ds_read_b128 v[24:27], v122 offset:12800
    ds_read_b128 v[28:31], v122 offset:13440
    s_mov_b64 exec, -1
    v_exp_f32 v100, v100
    v_exp_f32 v101, v101
    v_exp_f32 v102, v102
    v_exp_f32 v103, v103
    v_mfma_f32_32x32x8bf16_1k v[80:95], v[14:15], v[8:9], v[80:95]
    v_cvt_pk_bf16_f32 v40, v96, v97
    v_cvt_pk_bf16_f32 v41, v98, v99
    v_cvt_pk_bf16_f32 v42, v100, v101
    v_cvt_pk_bf16_f32 v43, v102, v103
    s_mov_b32 s58, 0x78000
    buffer_load_dword v135, off, s[8:11], s58 sc1
    v_exp_f32 v104, v104
    v_exp_f32 v105, v105
    v_exp_f32 v106, v106
    v_exp_f32 v107, v107
    v_mfma_f32_32x32x16_bf16 v[64:79], v[32:35], v[40:43], v[64:79]
    v_exp_f32 v108, v108
    v_exp_f32 v109, v109
    v_exp_f32 v110, v110
    v_exp_f32 v111, v111
    v_cvt_pk_bf16_f32 v44, v104, v105
    v_cvt_pk_bf16_f32 v45, v106, v107
    v_cvt_pk_bf16_f32 v46, v108, v109
    v_cvt_pk_bf16_f32 v47, v110, v111
    s_setprio 1
    s_waitcnt lgkmcnt(0)
    v_mfma_f32_32x32x16_bf16 v[96:111], v[16:19], v[4:7], v[48:63]
    ds_read_b64_tr_b16 v[10:11], v119 offset:7680
    ds_read_b64_tr_b16 v[12:13], v119 offset:7744
    ds_read_b64_tr_b16 v[14:15], v119 offset:7808
    v_exp_f32 v80, v80
    v_exp_f32 v81, v81
    v_exp_f32 v82, v82
    v_exp_f32 v83, v83
    v_mfma_f32_32x32x16_bf16 v[64:79], v[36:39], v[44:47], v[64:79]
    s_mov_b64 exec, s[36:37]
    ds_read_b128 v[32:35], v122 offset:10240
    ds_read_b128 v[36:39], v122 offset:10880
    s_mov_b64 exec, -1
    v_exp_f32 v84, v84
    v_exp_f32 v85, v85
    v_exp_f32 v86, v86
    v_exp_f32 v87, v87
    v_mfma_f32_32x32x8bf16_1k v[96:111], v[20:21], v[8:9], v[96:111]
    v_cvt_pk_bf16_f32 v40, v80, v81
    v_cvt_pk_bf16_f32 v41, v82, v83
    v_cvt_pk_bf16_f32 v42, v84, v85
    v_cvt_pk_bf16_f32 v43, v86, v87
    v_exp_f32 v88, v88
    v_exp_f32 v89, v89
    v_exp_f32 v90, v90
    v_exp_f32 v91, v91
    v_mfma_f32_32x32x16_bf16 v[64:79], v[24:27], v[40:43], v[64:79]
    v_exp_f32 v92, v92
    v_exp_f32 v93, v93
    v_exp_f32 v94, v94
    v_exp_f32 v95, v95
    v_cvt_pk_bf16_f32 v44, v88, v89
    v_cvt_pk_bf16_f32 v45, v90, v91
    v_cvt_pk_bf16_f32 v46, v92, v93
    v_cvt_pk_bf16_f32 v47, v94, v95
    s_setprio 0
    s_waitcnt lgkmcnt(0)
    v_mfma_f32_32x32x16_bf16 v[80:95], v[10:13], v[4:7], v[48:63]
    ds_read_b64_tr_b16 v[16:17], v119 offset:5120
    ds_read_b64_tr_b16 v[18:19], v119 offset:5184
    ds_read_b64_tr_b16 v[20:21], v119 offset:5248
    v_exp_f32 v96, v96
    v_exp_f32 v97, v97
    v_exp_f32 v98, v98
    v_exp_f32 v99, v99
    v_mfma_f32_32x32x16_bf16 v[64:79], v[28:31], v[44:47], v[64:79]
    s_mov_b64 exec, s[36:37]
    ds_read_b128 v[24:27], v122 offset:7680
    ds_read_b128 v[28:31], v122 offset:8320
    s_mov_b64 exec, -1
    v_exp_f32 v100, v100
    v_exp_f32 v101, v101
    v_exp_f32 v102, v102
    v_exp_f32 v103, v103
    v_mfma_f32_32x32x8bf16_1k v[80:95], v[14:15], v[8:9], v[80:95]
    v_cvt_pk_bf16_f32 v40, v96, v97
    v_cvt_pk_bf16_f32 v41, v98, v99
    v_cvt_pk_bf16_f32 v42, v100, v101
    v_cvt_pk_bf16_f32 v43, v102, v103
    v_exp_f32 v104, v104
    v_exp_f32 v105, v105
    v_exp_f32 v106, v106
    v_exp_f32 v107, v107
    v_mfma_f32_32x32x16_bf16 v[64:79], v[32:35], v[40:43], v[64:79]
    v_exp_f32 v108, v108
    v_exp_f32 v109, v109
    v_exp_f32 v110, v110
    v_exp_f32 v111, v111
    v_cvt_pk_bf16_f32 v44, v104, v105
    v_cvt_pk_bf16_f32 v45, v106, v107
    v_cvt_pk_bf16_f32 v46, v108, v109
    v_cvt_pk_bf16_f32 v47, v110, v111
    s_setprio 3
    s_waitcnt lgkmcnt(0)
    s_waitcnt vmcnt(0)
    s_barrier
    s_cmp_lg_u32 s16, 7
    s_cbranch_scc1 L_cnt_95
    v_mov_b32 v136, 1
    s_and_b32 s58, s2, 7
    s_lshl_b32 s58, s58, 2
    s_lshr_b32 s60, s2, 6
    s_add_u32 s58, s58, s60
    s_lshl_b32 s58, s58, 7
    s_add_u32 s58, s58, 0x7a000
    s_mov_b64 exec, 1
    buffer_atomic_add v136, off, s[8:11], s58 sc1
    s_mov_b64 exec, -1
L_cnt_95:
L_spinb_19:
    v_readfirstlane_b32 s58, v135
    s_nop 0
    s_cmp_lt_u32 s58, 256
    s_cbranch_scc1 L_spin_18
L_spino_20:
    s_lshl_b32 s58, s17, 10
    s_add_u32 m0, s58, 159744
    s_nop 0
    buffer_load_dwordx4 v169, s[8:11], s95 offen sc1 lds
    v_mfma_f32_32x32x16_bf16 v[96:111], v[16:19], v[4:7], v[48:63]
    ds_read_b64_tr_b16 v[10:11], v119 offset:2560
    ds_read_b64_tr_b16 v[12:13], v119 offset:2624
    ds_read_b64_tr_b16 v[14:15], v119 offset:2688
    v_exp_f32 v80, v80
    v_exp_f32 v81, v81
    v_exp_f32 v82, v82
    v_exp_f32 v83, v83
    v_mfma_f32_32x32x16_bf16 v[64:79], v[36:39], v[44:47], v[64:79]
    s_mov_b64 exec, s[36:37]
    ds_read_b128 v[32:35], v122 offset:5120
    ds_read_b128 v[36:39], v122 offset:5760
    s_mov_b64 exec, -1
    v_exp_f32 v84, v84
    v_exp_f32 v85, v85
    v_exp_f32 v86, v86
    v_exp_f32 v87, v87
    v_mfma_f32_32x32x8bf16_1k v[96:111], v[20:21], v[8:9], v[96:111]
    v_cvt_pk_bf16_f32 v40, v80, v81
    v_cvt_pk_bf16_f32 v41, v82, v83
    v_cvt_pk_bf16_f32 v42, v84, v85
    v_cvt_pk_bf16_f32 v43, v86, v87
    s_add_u32 m0, s39, 49152
    s_add_u32 s60, s19, 0
    buffer_load_dwordx4 v154, s[52:55], s60 offen lds
    v_exp_f32 v88, v88
    v_exp_f32 v89, v89
    v_exp_f32 v90, v90
    v_exp_f32 v91, v91
    v_mfma_f32_32x32x16_bf16 v[64:79], v[24:27], v[40:43], v[64:79]
    s_add_u32 m0, s39, 40960
    s_add_u32 s60, s19, 1658880
    buffer_load_dwordx4 v154, s[52:55], s60 offen lds
    v_exp_f32 v92, v92
    v_exp_f32 v93, v93
    v_exp_f32 v94, v94
    v_exp_f32 v95, v95
    v_cvt_pk_bf16_f32 v44, v88, v89
    v_cvt_pk_bf16_f32 v45, v90, v91
    v_cvt_pk_bf16_f32 v46, v92, v93
    v_cvt_pk_bf16_f32 v47, v94, v95
    s_setprio 2
    s_waitcnt lgkmcnt(0)
    v_mfma_f32_32x32x16_bf16 v[80:95], v[10:13], v[4:7], v[48:63]
    ds_read_b64_tr_b16 v[16:17], v119 offset:0
    ds_read_b64_tr_b16 v[18:19], v119 offset:64
    ds_read_b64_tr_b16 v[20:21], v119 offset:128
    v_exp_f32 v96, v96
    v_exp_f32 v97, v97
    v_exp_f32 v98, v98
    v_exp_f32 v99, v99
    v_mfma_f32_32x32x16_bf16 v[64:79], v[28:31], v[44:47], v[64:79]
    s_mov_b64 exec, s[36:37]
    ds_read_b128 v[24:27], v122 offset:2560
    ds_read_b128 v[28:31], v122 offset:3200
    s_mov_b64 exec, -1
    v_exp_f32 v100, v100
    v_exp_f32 v101, v101
    v_exp_f32 v102, v102
    v_exp_f32 v103, v103
    v_mfma_f32_32x32x8bf16_1k v[80:95], v[14:15], v[8:9], v[80:95]
    v_cvt_pk_bf16_f32 v40, v96, v97
    v_cvt_pk_bf16_f32 v41, v98, v99
    v_cvt_pk_bf16_f32 v42, v100, v101
    v_cvt_pk_bf16_f32 v43, v102, v103
    s_add_u32 m0, s39, 32768
    s_add_u32 s60, s19, 1548288
    buffer_load_dwordx4 v154, s[52:55], s60 offen lds
    v_exp_f32 v104, v104
    v_exp_f32 v105, v105
    v_exp_f32 v106, v106
    v_exp_f32 v107, v107
    v_mfma_f32_32x32x16_bf16 v[64:79], v[32:35], v[40:43], v[64:79]
    v_exp_f32 v108, v108
    v_exp_f32 v109, v109
    v_exp_f32 v110, v110
    v_exp_f32 v111, v111
    v_cvt_pk_bf16_f32 v44, v104, v105
    v_cvt_pk_bf16_f32 v45, v106, v107
    v_cvt_pk_bf16_f32 v46, v108, v109
    v_cvt_pk_bf16_f32 v47, v110, v111
    s_setprio 1
    s_waitcnt lgkmcnt(0)
    v_mfma_f32_32x32x16_bf16 v[96:111], v[16:19], v[4:7], v[48:63]
    v_exp_f32 v80, v80
    v_exp_f32 v81, v81
    v_exp_f32 v82, v82
    v_exp_f32 v83, v83
    v_mfma_f32_32x32x16_bf16 v[64:79], v[36:39], v[44:47], v[64:79]
    s_mov_b64 exec, s[36:37]
    ds_read_b128 v[32:35], v122 offset:0
    ds_read_b128 v[36:39], v122 offset:640
    s_mov_b64 exec, -1
    v_exp_f32 v84, v84
    v_exp_f32 v85, v85
    v_exp_f32 v86, v86
    v_exp_f32 v87, v87
    v_mfma_f32_32x32x8bf16_1k v[96:111], v[20:21], v[8:9], v[96:111]
    v_cvt_pk_bf16_f32 v40, v80, v81
    v_cvt_pk_bf16_f32 v41, v82, v83
    v_cvt_pk_bf16_f32 v42, v84, v85
    v_cvt_pk_bf16_f32 v43, v86, v87
    s_add_u32 m0, s39, 24576
    s_add_u32 s60, s19, 1437696
    buffer_load_dwordx4 v154, s[52:55], s60 offen lds
    v_exp_f32 v88, v88
    v_exp_f32 v89, v89
    v_exp_f32 v90, v90
    v_exp_f32 v91, v91
    v_mfma_f32_32x32x16_bf16 v[64:79], v[24:27], v[40:43], v[64:79]
    s_add_u32 m0, s39, 16384
    s_add_u32 s60, s19, 1327104
    buffer_load_dwordx4 v154, s[52:55], s60 offen lds
    v_exp_f32 v92, v92
    v_exp_f32 v93, v93
    v_exp_f32 v94, v94
    v_exp_f32 v95, v95
    v_cvt_pk_bf16_f32 v44, v88, v89
    v_cvt_pk_bf16_f32 v45, v90, v91
    v_cvt_pk_bf16_f32 v46, v92, v93
    v_cvt_pk_bf16_f32 v47, v94, v95
    s_setprio 0
    s_waitcnt lgkmcnt(0)
    v_exp_f32 v96, v96
    v_exp_f32 v97, v97
    v_exp_f32 v98, v98
    v_exp_f32 v99, v99
    v_mfma_f32_32x32x16_bf16 v[64:79], v[28:31], v[44:47], v[64:79]
    v_exp_f32 v100, v100
    v_exp_f32 v101, v101
    v_exp_f32 v102, v102
    v_exp_f32 v103, v103
    v_cvt_pk_bf16_f32 v40, v96, v97
    v_cvt_pk_bf16_f32 v41, v98, v99
    v_cvt_pk_bf16_f32 v42, v100, v101
    v_cvt_pk_bf16_f32 v43, v102, v103
    s_add_u32 m0, s39, 8192
    s_add_u32 s60, s19, 1216512
    buffer_load_dwordx4 v154, s[52:55], s60 offen lds
    v_exp_f32 v104, v104
    v_exp_f32 v105, v105
    v_exp_f32 v106, v106
    v_exp_f32 v107, v107
    v_mfma_f32_32x32x16_bf16 v[64:79], v[32:35], v[40:43], v[64:79]
    v_exp_f32 v108, v108
    v_exp_f32 v109, v109
    v_exp_f32 v110, v110
    v_exp_f32 v111, v111
    v_cvt_pk_bf16_f32 v44, v104, v105
    v_cvt_pk_bf16_f32 v45, v106, v107
    v_cvt_pk_bf16_f32 v46, v108, v109
    v_cvt_pk_bf16_f32 v47, v110, v111
    s_nop 1
    v_mfma_f32_32x32x16_bf16 v[64:79], v[36:39], v[44:47], v[64:79]
    s_setprio 3
    s_mov_b32 s22, 0x53800000
    s_mov_b32 s23, 0x7f61b1e6
    s_nop 8
    v_add_f32 v136, abs(v64), abs(v65)
    v_add_f32 v136, v136, abs(v66)
    v_add_f32 v136, v136, abs(v67)
    v_add_f32 v136, v136, abs(v68)
    v_add_f32 v136, v136, abs(v69)
    v_add_f32 v136, v136, abs(v70)
    v_add_f32 v136, v136, abs(v71)
    v_add_f32 v136, v136, abs(v72)
    v_add_f32 v136, v136, abs(v73)
    v_add_f32 v136, v136, abs(v74)
    v_add_f32 v136, v136, abs(v75)
    v_cmp_nle_f32 s[60:61], v76, s22
    v_cmp_nle_f32 vcc, v136, s23
    s_nop 0
    s_or_b64 vcc, vcc, s[60:61]
    s_cbranch_vccnz L_fallback_96
L_done_97:
    v_rcp_f32 v136, v76
    s_nop 0
    v_mul_f32 v64, v64, v136
    v_mul_f32 v65, v65, v136
    v_mul_f32 v66, v66, v136
    v_mul_f32 v67, v67, v136
    v_mul_f32 v68, v68, v136
    v_mul_f32 v69, v69, v136
    v_mul_f32 v70, v70, v136
    v_mul_f32 v71, v71, v136
    v_mul_f32 v72, v72, v136
    v_mul_f32 v73, v73, v136
    v_mul_f32 v74, v74, v136
    v_mul_f32 v75, v75, v136
    v_and_b32 v64, 0xffff0000, v64
    v_cvt_pk_bf16_f32 v40, v64, v65
    v_or_b32 v40, 1, v40
    v_cvt_pk_bf16_f32 v41, v66, v67
    v_cvt_pk_bf16_f32 v42, v68, v69
    v_cvt_pk_bf16_f32 v43, v70, v71
    v_and_b32 v72, 0xffff0000, v72
    v_cvt_pk_bf16_f32 v44, v72, v73
    v_or_b32 v44, 1, v44
    v_cvt_pk_bf16_f32 v45, v74, v75
    buffer_store_dwordx4 v[40:43], v173, s[8:11], s92 offen sc0 sc1
    s_mov_b32 exec_hi, 0
    buffer_store_dwordx2 v[44:45], v172, s[8:11], s93 offen sc0 sc1
    s_mov_b64 exec, -1
L_att_end:
    v_bfe_u32 v176, v0, 2, 2
    v_mul_u32_u24 v176, 160, v176
    v_and_b32 v177, 3, v0
    v_lshl_add_u32 v176, v177, 3, v176
    s_mul_i32 s58, s18, 51200
    s_add_u32 s58, s58, 57344
    v_add_u32 v176, s58, v176
    v_bfe_u32 v177, v0, 4, 1
    v_bfe_u32 v178, v0, 5, 1
    s_movk_i32 s58, 640
    v_mad_u32_u24 v164, v177, s58, v176
    s_movk_i32 s58, 3200
    v_mad_u32_u24 v164, v178, s58, v164
    s_movk_i32 s58, 6400
    v_mad_u32_u24 v165, v177, s58, v176
    s_movk_i32 s58, 12800
    v_mad_u32_u24 v165, v178, s58, v165
    ds_read_b64_tr_b16 v[64:65], v164 offset:0
    ds_read_b64_tr_b16 v[66:67], v164 offset:1280
    ds_read_b64_tr_b16 v[68:69], v164 offset:32
    ds_read_b64_tr_b16 v[70:71], v164 offset:1312
    ds_read_b64_tr_b16 v[72:73], v164 offset:64
    ds_read_b64_tr_b16 v[74:75], v164 offset:1344
    ds_read_b64_tr_b16 v[76:77], v164 offset:96
    ds_read_b64_tr_b16 v[78:79], v164 offset:1376
    ds_read_b64_tr_b16 v[80:81], v164 offset:128
    ds_read_b64_tr_b16 v[82:83], v164 offset:1408
    ds_read_b64_tr_b16 v[84:85], v164 offset:6400
    ds_read_b64_tr_b16 v[86:87], v164 offset:7680
    ds_read_b64_tr_b16 v[88:89], v164 offset:6432
    ds_read_b64_tr_b16 v[90:91], v164 offset:7712
    ds_read_b64_tr_b16 v[92:93], v164 offset:6464
    ds_read_b64_tr_b16 v[94:95], v164 offset:7744
    ds_read_b64_tr_b16 v[96:97], v164 offset:6496
    ds_read_b64_tr_b16 v[98:99], v164 offset:7776
    ds_read_b64_tr_b16 v[100:101], v164 offset:6528
    ds_read_b64_tr_b16 v[102:103], v164 offset:7808
    ds_read_b64_tr_b16 v[104:105], v164 offset:12800
    ds_read_b64_tr_b16 v[106:107], v164 offset:14080
    ds_read_b64_tr_b16 v[108:109], v164 offset:12832
    ds_read_b64_tr_b16 v[110:111], v164 offset:14112
    ds_read_b64_tr_b16 v[112:113], v164 offset:12864
    ds_read_b64_tr_b16 v[114:115], v164 offset:14144
    ds_read_b64_tr_b16 v[116:117], v164 offset:12896
    ds_read_b64_tr_b16 v[118:119], v164 offset:14176
    ds_read_b64_tr_b16 v[120:121], v164 offset:12928
    ds_read_b64_tr_b16 v[122:123], v164 offset:14208
    ds_read_b64_tr_b16 v[124:125], v164 offset:19200
    ds_read_b64_tr_b16 v[126:127], v164 offset:20480
    ds_read_b64_tr_b16 v[128:129], v164 offset:19232
    ds_read_b64_tr_b16 v[130:131], v164 offset:20512
    ds_read_b64_tr_b16 v[132:133], v164 offset:19264
    ds_read_b64_tr_b16 v[134:135], v164 offset:20544
    ds_read_b64_tr_b16 v[136:137], v164 offset:19296
    ds_read_b64_tr_b16 v[138:139], v164 offset:20576
    ds_read_b64_tr_b16 v[140:141], v164 offset:19328
    ds_read_b64_tr_b16 v[142:143], v164 offset:20608
    v_mul_u32_u24 v178, 496, v178
    v_and_b32 v176, 15, v0
    v_bfe_u32 v177, v0, 4, 2
    v_lshlrev_b32 v254, 4, v176
    v_lshl_add_u32 v255, v177, 3, v254
    v_lshl_add_u32 v254, v177, 9, v254
    v_add_u32 v255, v255, v178
    v_lshlrev_b32 v169, 3, v176
    s_lshl_b32 s58, s17, 10
    s_add_u32 s58, s58, 159744
    v_lshl_add_u32 v170, v177, 4, s58
    s_lshr_b32 s58, s17, 1
    s_lshl_b32 s58, s58, 15
    s_and_b32 s60, s17, 1
    s_mul_i32 s60, s60, 5120
    s_add_u32 s58, s58, s60
    s_add_u32 s58, s58, 114688
    v_add_u32 v166, s58, v182
    s_waitcnt vmcnt(0)
    s_barrier
    buffer_load_dwordx4 v[24:27], v182, s[8:11], s88 offen offset:0 sc1
    buffer_load_dwordx4 v[28:31], v182, s[8:11], s88 offen offset:1024 sc1
    buffer_load_dwordx4 v[32:35], v182, s[8:11], s88 offen offset:2048 sc1
    buffer_load_dwordx4 v[36:39], v182, s[8:11], s88 offen offset:3072 sc1
    buffer_load_dwordx4 v[40:43], v182, s[8:11], s65 offen offset:0 sc1
    buffer_load_dwordx4 v[44:47], v182, s[8:11], s3 offen offset:0 sc1
    buffer_load_dwordx4 v[48:51], v182, s[8:11], s3 offen offset:1024 sc1
    buffer_load_dwordx4 v[52:55], v182, s[8:11], s3 offen offset:2048 sc1
    buffer_load_dwordx4 v[56:59], v182, s[8:11], s3 offen offset:3072 sc1
    buffer_load_dwordx4 v[60:63], v182, s[8:11], s65 offen offset:1024 sc1
    s_waitcnt vmcnt(8)
    v_bitop3_b32 v176, v24, v28, 1 bitop3:0x80
    v_cmp_eq_u32 vcc, 0, v176
    s_cbranch_vccnz L_stub_98
L_ok_99:
    s_waitcnt lgkmcnt(15)
    v_mfma_f32_16x16x32_bf16 v[4:7], v[64:67], v[24:27], 0
    ds_read_b64_tr_b16 v[64:65], v165 offset:2560
    ds_read_b64_tr_b16 v[66:67], v165 offset:5760
    v_mfma_f32_16x16x32_bf16 v[8:11], v[68:71], v[24:27], 0
    ds_read_b64_tr_b16 v[68:69], v165 offset:2592
    ds_read_b64_tr_b16 v[70:71], v165 offset:5792
    v_mfma_f32_16x16x32_bf16 v[12:15], v[72:75], v[24:27], 0
    ds_read_b64_tr_b16 v[72:73], v165 offset:2624
    ds_read_b64_tr_b16 v[74:75], v165 offset:5824
    v_mfma_f32_16x16x32_bf16 v[16:19], v[76:79], v[24:27], 0
    ds_read_b64_tr_b16 v[76:77], v165 offset:2656
    ds_read_b64_tr_b16 v[78:79], v165 offset:5856
    v_mfma_f32_16x16x32_bf16 v[20:23], v[80:83], v[24:27], 0
    ds_read_b64_tr_b16 v[80:81], v165 offset:2688
    ds_read_b64_tr_b16 v[82:83], v165 offset:5888
    v_mfma_f32_16x16x32_bf16 v[4:7], v[84:87], v[28:31], v[4:7]
    ds_read_b64_tr_b16 v[84:85], v164 offset:25600
    ds_read_b64_tr_b16 v[86:87], v164 offset:26880
    v_mfma_f32_16x16x32_bf16 v[8:11], v[88:91], v[28:31], v[8:11]
    ds_read_b64_tr_b16 v[88:89], v164 offset:25632
    ds_read_b64_tr_b16 v[90:91], v164 offset:26912
    v_mfma_f32_16x16x32_bf16 v[12:15], v[92:95], v[28:31], v[12:15]
    ds_read_b64_tr_b16 v[92:93], v164 offset:25664
    ds_read_b64_tr_b16 v[94:95], v164 offset:26944
    v_mfma_f32_16x16x32_bf16 v[16:19], v[96:99], v[28:31], v[16:19]
    ds_read_b64_tr_b16 v[96:97], v164 offset:25696
    ds_read_b64_tr_b16 v[98:99], v164 offset:26976
    s_waitcnt vmcnt(5)
    v_bitop3_b32 v176, v32, v36, v40 bitop3:0x80
    v_bitop3_b32 v176, v176, v42, 1 bitop3:0x80
    v_cmp_eq_u32 vcc, 0, v176
    s_cbranch_vccnz L_stub_100
L_ok_101:
    v_mfma_f32_16x16x32_bf16 v[20:23], v[100:103], v[28:31], v[20:23]
    ds_read_b64_tr_b16 v[100:101], v164 offset:25728
    ds_read_b64_tr_b16 v[102:103], v164 offset:27008
    v_mfma_f32_16x16x32_bf16 v[4:7], v[104:107], v[32:35], v[4:7]
    ds_read_b64_tr_b16 v[104:105], v164 offset:32000
    ds_read_b64_tr_b16 v[106:107], v164 offset:33280
    v_mfma_f32_16x16x32_bf16 v[8:11], v[108:111], v[32:35], v[8:11]
    ds_read_b64_tr_b16 v[108:109], v164 offset:32032
    ds_read_b64_tr_b16 v[110:111], v164 offset:33312
    s_waitcnt lgkmcnt(15)
    v_mfma_f32_16x16x32_bf16 v[12:15], v[112:115], v[32:35], v[12:15]
    ds_read_b64_tr_b16 v[112:113], v164 offset:32064
    ds_read_b64_tr_b16 v[114:115], v164 offset:33344
    v_mfma_f32_16x16x32_bf16 v[16:19], v[116:119], v[32:35], v[16:19]
    ds_read_b64_tr_b16 v[116:117], v164 offset:32096
    ds_read_b64_tr_b16 v[118:119], v164 offset:33376
    v_mfma_f32_16x16x32_bf16 v[20:23], v[120:123], v[32:35], v[20:23]
    ds_read_b64_tr_b16 v[120:121], v164 offset:32128
    ds_read_b64_tr_b16 v[122:123], v164 offset:33408
    v_mfma_f32_16x16x32_bf16 v[4:7], v[124:127], v[36:39], v[4:7]
    ds_read_b64_tr_b16 v[124:125], v164 offset:38400
    ds_read_b64_tr_b16 v[126:127], v164 offset:39680
    v_mfma_f32_16x16x32_bf16 v[8:11], v[128:131], v[36:39], v[8:11]
    ds_read_b64_tr_b16 v[128:129], v164 offset:38432
    ds_read_b64_tr_b16 v[130:131], v164 offset:39712
    v_mfma_f32_16x16x32_bf16 v[12:15], v[132:135], v[36:39], v[12:15]
    ds_read_b64_tr_b16 v[132:133], v164 offset:38464
    ds_read_b64_tr_b16 v[134:135], v164 offset:39744
    v_mfma_f32_16x16x32_bf16 v[16:19], v[136:139], v[36:39], v[16:19]
    ds_read_b64_tr_b16 v[136:137], v164 offset:38496
    ds_read_b64_tr_b16 v[138:139], v164 offset:39776
    v_mfma_f32_16x16x32_bf16 v[20:23], v[140:143], v[36:39], v[20:23]
    ds_read_b64_tr_b16 v[140:141], v164 offset:38528
    ds_read_b64_tr_b16 v[142:143], v164 offset:39808
    v_mfma_f32_16x16x32_bf16 v[4:7], v[64:67], v[40:43], v[4:7]
    ds_read_b64_tr_b16 v[64:65], v164 offset:44800
    ds_read_b64_tr_b16 v[66:67], v164 offset:46080
    v_mfma_f32_16x16x32_bf16 v[8:11], v[68:71], v[40:43], v[8:11]
    ds_read_b64_tr_b16 v[68:69], v164 offset:44832
    ds_read_b64_tr_b16 v[70:71], v164 offset:46112
    v_mfma_f32_16x16x32_bf16 v[12:15], v[72:75], v[40:43], v[12:15]
    ds_read_b64_tr_b16 v[72:73], v164 offset:44864
    ds_read_b64_tr_b16 v[74:75], v164 offset:46144
    v_mfma_f32_16x16x32_bf16 v[16:19], v[76:79], v[40:43], v[16:19]
    ds_read_b64_tr_b16 v[76:77], v164 offset:44896
    ds_read_b64_tr_b16 v[78:79], v164 offset:46176
    s_waitcnt vmcnt(3)
    v_bitop3_b32 v176, v44, v48, 1 bitop3:0x80
    v_cmp_eq_u32 vcc, 0, v176
    s_cbranch_vccnz L_stub_102
L_ok_103:
    s_waitcnt lgkmcnt(15)
    v_mfma_f32_16x16x32_bf16 v[20:23], v[80:83], v[40:43], v[20:23]
    ds_read_b64_tr_b16 v[80:81], v164 offset:44928
    ds_read_b64_tr_b16 v[82:83], v164 offset:46208
    v_mfma_f32_16x16x32_bf16 v[4:7], v[84:87], v[44:47], v[4:7]
    ds_read_b64_tr_b16 v[84:85], v165 offset:28160
    ds_read_b64_tr_b16 v[86:87], v165 offset:31360
    v_mfma_f32_16x16x32_bf16 v[8:11], v[88:91], v[44:47], v[8:11]
    ds_read_b64_tr_b16 v[88:89], v165 offset:28192
    ds_read_b64_tr_b16 v[90:91], v165 offset:31392
    v_mfma_f32_16x16x32_bf16 v[12:15], v[92:95], v[44:47], v[12:15]
    ds_read_b64_tr_b16 v[92:93], v165 offset:28224
    ds_read_b64_tr_b16 v[94:95], v165 offset:31424
    v_mfma_f32_16x16x32_bf16 v[16:19], v[96:99], v[44:47], v[16:19]
    ds_read_b64_tr_b16 v[96:97], v165 offset:28256
    ds_read_b64_tr_b16 v[98:99], v165 offset:31456
    v_mfma_f32_16x16x32_bf16 v[20:23], v[100:103], v[44:47], v[20:23]
    ds_read_b64_tr_b16 v[100:101], v165 offset:28288
    ds_read_b64_tr_b16 v[102:103], v165 offset:31488
    v_mfma_f32_16x16x32_bf16 v[4:7], v[104:107], v[48:51], v[4:7]
    ds_read_b128 v[104:107], v170 offset:0
    v_mfma_f32_16x16x32_bf16 v[8:11], v[108:111], v[48:51], v[8:11]
    ds_read_b128 v[108:111], v170 offset:64
    v_mfma_f32_16x16x32_bf16 v[12:15], v[112:115], v[48:51], v[12:15]
    ds_read_b128 v[112:115], v170 offset:128
    v_mfma_f32_16x16x32_bf16 v[16:19], v[116:119], v[48:51], v[16:19]
    ds_read_b128 v[116:119], v170 offset:192
    s_waitcnt vmcnt(0)
    v_bitop3_b32 v176, v52, v56, v60 bitop3:0x80
    v_bitop3_b32 v176, v176, v62, 1 bitop3:0x80
    v_cmp_eq_u32 vcc, 0, v176
    s_cbranch_vccnz L_stub_104
L_ok_105:
    v_mfma_f32_16x16x32_bf16 v[20:23], v[120:123], v[48:51], v[20:23]
    ds_read_b128 v[120:123], v170 offset:256
    s_waitcnt lgkmcnt(0)
    s_barrier
    v_mfma_f32_16x16x32_bf16 v[4:7], v[124:127], v[52:55], v[4:7]
    ds_read_b128 v[124:127], v170 offset:320
    ds_write_b128 v156, v[208:211] offset:0
    v_mfma_f32_16x16x32_bf16 v[8:11], v[128:131], v[52:55], v[8:11]
    ds_read_b128 v[128:131], v170 offset:384
    ds_write_b128 v157, v[212:215] offset:8192
    v_mfma_f32_16x16x32_bf16 v[12:15], v[132:135], v[52:55], v[12:15]
    ds_read_b128 v[132:135], v170 offset:448
    ds_write_b128 v157, v[216:219] offset:16384
    v_mfma_f32_16x16x32_bf16 v[16:19], v[136:139], v[52:55], v[16:19]
    ds_read_b128 v[136:139], v170 offset:512
    ds_write_b128 v157, v[220:223] offset:24576
    v_mfma_f32_16x16x32_bf16 v[20:23], v[140:143], v[52:55], v[20:23]
    ds_read_b128 v[140:143], v170 offset:576
    ds_write_b128 v157, v[224:227] offset:32768
    v_mfma_f32_16x16x32_bf16 v[4:7], v[64:67], v[56:59], v[4:7]
    ds_write_b128 v157, v[228:231] offset:40960
    v_mfma_f32_16x16x32_bf16 v[8:11], v[68:71], v[56:59], v[8:11]
    v_mfma_f32_16x16x32_bf16 v[12:15], v[72:75], v[56:59], v[12:15]
    v_mfma_f32_16x16x32_bf16 v[16:19], v[76:79], v[56:59], v[16:19]
    v_mfma_f32_16x16x32_bf16 v[20:23], v[80:83], v[56:59], v[20:23]
    v_mfma_f32_16x16x32_bf16 v[4:7], v[84:87], v[60:63], v[4:7]
    v_mfma_f32_16x16x32_bf16 v[8:11], v[88:91], v[60:63], v[8:11]
    v_mfma_f32_16x16x32_bf16 v[12:15], v[92:95], v[60:63], v[12:15]
    v_mfma_f32_16x16x32_bf16 v[16:19], v[96:99], v[60:63], v[16:19]
    v_mfma_f32_16x16x32_bf16 v[20:23], v[100:103], v[60:63], v[20:23]
    s_cmp_lg_u32 s18, 0
    s_nop 1
    s_cbranch_scc1 L_upper_13
    v_lshlrev_b32 v24, 16, v144
    v_and_b32 v25, 0xffff0000, v144
    v_lshlrev_b32 v26, 16, v145
    v_and_b32 v27, 0xffff0000, v145
    v_lshlrev_b32 v28, 16, v146
    v_and_b32 v29, 0xffff0000, v146
    v_lshlrev_b32 v30, 16, v147
    v_and_b32 v31, 0xffff0000, v147
    v_lshlrev_b32 v32, 16, v148
    v_and_b32 v33, 0xffff0000, v148
    v_lshlrev_b32 v34, 16, v149
    v_and_b32 v35, 0xffff0000, v149
    v_lshlrev_b32 v36, 16, v150
    v_and_b32 v37, 0xffff0000, v150
    v_lshlrev_b32 v38, 16, v151
    v_and_b32 v39, 0xffff0000, v151
    v_lshlrev_b32 v40, 16, v152
    v_and_b32 v41, 0xffff0000, v152
    v_lshlrev_b32 v42, 16, v153
    v_and_b32 v43, 0xffff0000, v153
    v_pk_fma_f32 v[4:5], v[4:5], v[104:105], v[24:25]
    v_pk_fma_f32 v[6:7], v[6:7], v[106:107], v[26:27]
    v_pk_fma_f32 v[8:9], v[8:9], v[108:109], v[28:29]
    v_pk_fma_f32 v[10:11], v[10:11], v[110:111], v[30:31]
    v_pk_fma_f32 v[12:13], v[12:13], v[112:113], v[32:33]
    v_pk_fma_f32 v[14:15], v[14:15], v[114:115], v[34:35]
    v_pk_fma_f32 v[16:17], v[16:17], v[116:117], v[36:37]
    v_pk_fma_f32 v[18:19], v[18:19], v[118:119], v[38:39]
    v_pk_fma_f32 v[20:21], v[20:21], v[120:121], v[40:41]
    v_pk_fma_f32 v[22:23], v[22:23], v[122:123], v[42:43]
    s_waitcnt lgkmcnt(0)
    s_barrier
    ds_read_b128 v[64:67], v166 offset:0
    ds_read_b128 v[68:71], v166 offset:1024
    ds_read_b128 v[72:75], v166 offset:2048
    ds_read_b128 v[76:79], v166 offset:3072
    ds_read_b128 v[80:83], v166 offset:4096
    s_waitcnt lgkmcnt(4)
    v_pk_fma_f32 v[4:5], v[64:65], v[104:105], v[4:5]
    v_pk_fma_f32 v[6:7], v[66:67], v[106:107], v[6:7]
    s_waitcnt lgkmcnt(3)
    v_pk_fma_f32 v[8:9], v[68:69], v[108:109], v[8:9]
    v_pk_fma_f32 v[10:11], v[70:71], v[110:111], v[10:11]
    s_waitcnt lgkmcnt(2)
    v_pk_fma_f32 v[12:13], v[72:73], v[112:113], v[12:13]
    v_pk_fma_f32 v[14:15], v[74:75], v[114:115], v[14:15]
    s_waitcnt lgkmcnt(1)
    v_pk_fma_f32 v[16:17], v[76:77], v[116:117], v[16:17]
    v_pk_fma_f32 v[18:19], v[78:79], v[118:119], v[18:19]
    s_waitcnt lgkmcnt(0)
    v_pk_fma_f32 v[20:21], v[80:81], v[120:121], v[20:21]
    v_pk_fma_f32 v[22:23], v[82:83], v[122:123], v[22:23]
    v_pk_mul_f32 v[124:125], v[4:5], v[124:125]
    v_pk_mul_f32 v[126:127], v[6:7], v[126:127]
    v_pk_mul_f32 v[128:129], v[8:9], v[128:129]
    v_pk_mul_f32 v[130:131], v[10:11], v[130:131]
    v_pk_mul_f32 v[132:133], v[12:13], v[132:133]
    v_pk_mul_f32 v[134:135], v[14:15], v[134:135]
    v_pk_mul_f32 v[136:137], v[16:17], v[136:137]
    v_pk_mul_f32 v[138:139], v[18:19], v[138:139]
    v_pk_mul_f32 v[140:141], v[20:21], v[140:141]
    v_pk_mul_f32 v[142:143], v[22:23], v[142:143]
    v_and_b32 v124, 0xffff0000, v124
    v_cvt_pk_bf16_f32 v24, v124, v125
    v_or_b32 v24, 1, v24
    v_cvt_pk_bf16_f32 v25, v126, v127
    v_cvt_pk_bf16_f32 v26, v128, v129
    v_cvt_pk_bf16_f32 v27, v130, v131
    v_and_b32 v132, 0xffff0000, v132
    v_cvt_pk_bf16_f32 v28, v132, v133
    v_or_b32 v28, 1, v28
    v_cvt_pk_bf16_f32 v29, v134, v135
    v_cvt_pk_bf16_f32 v30, v136, v137
    v_cvt_pk_bf16_f32 v31, v138, v139
    v_and_b32 v140, 0xffff0000, v140
    v_cvt_pk_bf16_f32 v32, v140, v141
    v_or_b32 v32, 1, v32
    v_cvt_pk_bf16_f32 v33, v142, v143
    buffer_store_dwordx4 v[24:27], v254, s[8:11], s89 offen sc0 sc1
    buffer_store_dwordx4 v[28:31], v254, s[8:11], s89 offen offset:2048 sc0 sc1
    buffer_store_dwordx2 v[32:33], v255, s[8:11], s90 offen sc0 sc1
    v_pk_add_f32 v[104:105], v[4:5], v[6:7]
    v_pk_mul_f32 v[106:107], v[4:5], v[4:5]
    v_pk_fma_f32 v[106:107], v[6:7], v[6:7], v[106:107]
    v_pk_add_f32 v[104:105], v[104:105], v[8:9]
    v_pk_fma_f32 v[106:107], v[8:9], v[8:9], v[106:107]
    v_pk_add_f32 v[104:105], v[104:105], v[10:11]
    v_pk_fma_f32 v[106:107], v[10:11], v[10:11], v[106:107]
    v_pk_add_f32 v[104:105], v[104:105], v[12:13]
    v_pk_fma_f32 v[106:107], v[12:13], v[12:13], v[106:107]
    v_pk_add_f32 v[104:105], v[104:105], v[14:15]
    v_pk_fma_f32 v[106:107], v[14:15], v[14:15], v[106:107]
    v_pk_add_f32 v[104:105], v[104:105], v[16:17]
    v_pk_fma_f32 v[106:107], v[16:17], v[16:17], v[106:107]
    v_pk_add_f32 v[104:105], v[104:105], v[18:19]
    v_pk_fma_f32 v[106:107], v[18:19], v[18:19], v[106:107]
    v_pk_add_f32 v[104:105], v[104:105], v[20:21]
    v_pk_fma_f32 v[106:107], v[20:21], v[20:21], v[106:107]
    v_pk_add_f32 v[104:105], v[104:105], v[22:23]
    v_pk_fma_f32 v[106:107], v[22:23], v[22:23], v[106:107]
    v_add_f32 v174, v104, v105
    v_add_f32 v175, v106, v107
    v_mov_b32 v176, v174
    s_nop 1
    v_permlane16_swap_b32 v174, v176
    v_add_f32 v174, v174, v176
    v_mov_b32 v176, v174
    s_nop 1
    v_permlane32_swap_b32 v174, v176
    v_add_f32 v174, v174, v176
    v_mov_b32 v176, v175
    s_nop 1
    v_permlane16_swap_b32 v175, v176
    v_add_f32 v175, v175, v176
    v_mov_b32 v176, v175
    s_nop 1
    v_permlane32_swap_b32 v175, v176
    v_add_f32 v175, v175, v176
    s_mov_b64 exec, 0xffff
    buffer_store_dwordx2 v[174:175], v169, s[8:11], s91 offen sc0 sc1
    s_mov_b64 exec, -1
    v_cvt_pk_bf16_f32 v244, v4, v5
    v_cvt_pk_bf16_f32 v245, v6, v7
    v_cvt_pk_bf16_f32 v246, v8, v9
    v_cvt_pk_bf16_f32 v247, v10, v11
    v_cvt_pk_bf16_f32 v248, v12, v13
    v_cvt_pk_bf16_f32 v249, v14, v15
    v_cvt_pk_bf16_f32 v250, v16, v17
    v_cvt_pk_bf16_f32 v251, v18, v19
    v_cvt_pk_bf16_f32 v252, v20, v21
    v_cvt_pk_bf16_f32 v253, v22, v23
    s_setprio 0
    s_waitcnt vmcnt(0)
    s_branch L_join_14
L_spin_18:
    s_add_u32 s59, s59, 1
    s_cmp_gt_u32 s59, 3000
    s_cbranch_scc1 L_spino_20
    s_sleep 4
    s_mov_b32 s58, 0x78000
    buffer_load_dword v135, off, s[8:11], s58 sc1
    s_waitcnt vmcnt(0)
    s_branch L_spinb_19
L_fallback_96:
    v_bfe_u32 v136, v126, 4, 1
    v_mul_u32_u24 v119, 640, v136
    v_bfe_u32 v136, v126, 2, 1
    v_mul_u32_u24 v136, 320, v136
    v_add_u32 v119, v119, v136
    v_bfe_u32 v136, v126, 3, 1
    v_lshl_add_u32 v119, v136, 3, v119
    v_and_b32 v136, 3, v126
    v_lshl_add_u32 v119, v136, 1, v119
    v_lshrrev_b32 v136, 5, v126
    v_lshl_add_u32 v119, v136, 7, v119
    s_mul_i32 s22, s41, 163840
    s_add_u32 s22, s22, 0x680000
    s_add_u32 s23, s22, 163840
    s_mov_b32 s27, s22
L_maxloop_106:
    buffer_load_ushort v96, v119, s[8:11], s27 offen offset:0
    buffer_load_ushort v97, v119, s[8:11], s27 offen offset:16
    buffer_load_ushort v98, v119, s[8:11], s27 offen offset:32
    buffer_load_ushort v99, v119, s[8:11], s27 offen offset:48
    buffer_load_ushort v100, v119, s[8:11], s27 offen offset:64
    buffer_load_ushort v101, v119, s[8:11], s27 offen offset:80
    buffer_load_ushort v102, v119, s[8:11], s27 offen offset:96
    buffer_load_ushort v103, v119, s[8:11], s27 offen offset:112
    buffer_load_ushort v104, v119, s[8:11], s27 offen offset:128
    buffer_load_ushort v105, v119, s[8:11], s27 offen offset:144
    buffer_load_ushort v106, v119, s[8:11], s27 offen offset:160
    buffer_load_ushort v107, v119, s[8:11], s27 offen offset:176
    s_waitcnt vmcnt(0)
    v_lshl_or_b32 v10, v97, 16, v96
    v_lshl_or_b32 v11, v99, 16, v98
    v_lshl_or_b32 v12, v101, 16, v100
    v_lshl_or_b32 v13, v103, 16, v102
    v_lshl_or_b32 v14, v105, 16, v104
    v_lshl_or_b32 v15, v107, 16, v106
    v_mfma_f32_32x32x16_bf16 v[80:95], v[10:13], v[4:7], 0
    s_nop 0
    v_mfma_f32_32x32x8bf16_1k v[80:95], v[14:15], v[8:9], v[80:95]
    s_nop 11
    v_max3_f32 v125, v125, v80, v81
    v_max3_f32 v125, v125, v82, v83
    v_max3_f32 v125, v125, v84, v85
    v_max3_f32 v125, v125, v86, v87
    v_max3_f32 v125, v125, v88, v89
    v_max3_f32 v125, v125, v90, v91
    v_max3_f32 v125, v125, v92, v93
    v_max3_f32 v125, v125, v94, v95
    s_add_u32 s27, s27, 2560
    s_cmp_lt_u32 s27, s23
    s_cbranch_scc1 L_maxloop_106
    v_mov_b32 v136, v125
    s_nop 1
    v_permlane32_swap_b32 v125, v136
    v_max_f32 v125, v125, v136
    v_sub_f32 v48, 0, v125
    v_sub_f32 v49, 0, v125
    v_sub_f32 v50, 0, v125
    v_sub_f32 v51, 0, v125
    v_sub_f32 v52, 0, v125
    v_sub_f32 v53, 0, v125
    v_sub_f32 v54, 0, v125
    v_sub_f32 v55, 0, v125
    v_sub_f32 v56, 0, v125
    v_sub_f32 v57, 0, v125
    v_sub_f32 v58, 0, v125
    v_sub_f32 v59, 0, v125
    v_sub_f32 v60, 0, v125
    v_sub_f32 v61, 0, v125
    v_sub_f32 v62, 0, v125
    v_sub_f32 v63, 0, v125
    v_mov_b32 v64, 0
    v_mov_b32 v65, 0
    v_mov_b32 v66, 0
    v_mov_b32 v67, 0
    v_mov_b32 v68, 0
    v_mov_b32 v69, 0
    v_mov_b32 v70, 0
    v_mov_b32 v71, 0
    v_mov_b32 v72, 0
    v_mov_b32 v73, 0
    v_mov_b32 v74, 0
    v_mov_b32 v75, 0
    v_mov_b32 v76, 0
    v_mov_b32 v77, 0
    v_mov_b32 v78, 0
    v_mov_b32 v79, 0
    s_mov_b32 s27, s22
L_rerun_107:
    buffer_load_ushort v96, v119, s[8:11], s27 offen offset:0
    buffer_load_ushort v97, v119, s[8:11], s27 offen offset:16
    buffer_load_ushort v98, v119, s[8:11], s27 offen offset:32
    buffer_load_ushort v99, v119, s[8:11], s27 offen offset:48
    buffer_load_ushort v100, v119, s[8:11], s27 offen offset:64
    buffer_load_ushort v101, v119, s[8:11], s27 offen offset:80
    buffer_load_ushort v102, v119, s[8:11], s27 offen offset:96
    buffer_load_ushort v103, v119, s[8:11], s27 offen offset:112
    buffer_load_ushort v104, v119, s[8:11], s27 offen offset:128
    buffer_load_ushort v105, v119, s[8:11], s27 offen offset:144
    buffer_load_ushort v106, v119, s[8:11], s27 offen offset:160
    buffer_load_ushort v107, v119, s[8:11], s27 offen offset:176
    s_mov_b64 exec, s[36:37]
    buffer_load_dwordx4 v[24:27], v122, s[8:11], s27 offen offset:0
    buffer_load_dwordx4 v[28:31], v122, s[8:11], s27 offen offset:640
    s_mov_b64 exec, -1
    s_waitcnt vmcnt(0)
    v_lshl_or_b32 v10, v97, 16, v96
    v_lshl_or_b32 v11, v99, 16, v98
    v_lshl_or_b32 v12, v101, 16, v100
    v_lshl_or_b32 v13, v103, 16, v102
    v_lshl_or_b32 v14, v105, 16, v104
    v_lshl_or_b32 v15, v107, 16, v106
    v_mfma_f32_32x32x16_bf16 v[80:95], v[10:13], v[4:7], v[48:63]
    s_nop 0
    v_mfma_f32_32x32x8bf16_1k v[80:95], v[14:15], v[8:9], v[80:95]
    s_nop 11
    v_exp_f32 v80, v80
    v_exp_f32 v81, v81
    v_exp_f32 v82, v82
    v_exp_f32 v83, v83
    v_exp_f32 v84, v84
    v_exp_f32 v85, v85
    v_exp_f32 v86, v86
    v_exp_f32 v87, v87
    v_exp_f32 v88, v88
    v_exp_f32 v89, v89
    v_exp_f32 v90, v90
    v_exp_f32 v91, v91
    v_exp_f32 v92, v92
    v_exp_f32 v93, v93
    v_exp_f32 v94, v94
    v_exp_f32 v95, v95
    v_cvt_pk_bf16_f32 v40, v80, v81
    v_cvt_pk_bf16_f32 v41, v82, v83
    v_cvt_pk_bf16_f32 v42, v84, v85
    v_cvt_pk_bf16_f32 v43, v86, v87
    v_cvt_pk_bf16_f32 v44, v88, v89
    v_cvt_pk_bf16_f32 v45, v90, v91
    v_cvt_pk_bf16_f32 v46, v92, v93
    v_cvt_pk_bf16_f32 v47, v94, v95
    v_mfma_f32_32x32x16_bf16 v[64:79], v[24:27], v[40:43], v[64:79]
    s_nop 0
    v_mfma_f32_32x32x16_bf16 v[64:79], v[28:31], v[44:47], v[64:79]
    s_add_u32 s27, s27, 2560
    s_cmp_lt_u32 s27, s23
    s_cbranch_scc1 L_rerun_107
    s_nop 7
    s_branch L_done_97
L_upper_13:
    ds_write_b128 v166, v[4:7] offset:0
    ds_write_b128 v166, v[8:11] offset:1024
    ds_write_b128 v166, v[12:15] offset:2048
    ds_write_b128 v166, v[16:19] offset:3072
    ds_write_b128 v166, v[20:23] offset:4096
    s_waitcnt lgkmcnt(0)
    s_setprio 0
    s_barrier
    s_add_u32 m0, s24, 98304
    s_add_u32 s22, s19, 1769472
    buffer_load_dwordx4 v180, s[52:55], s22 offen offset:0 lds
    buffer_load_dwordx4 v181, s[52:55], s22 offen offset:1024 lds
    s_add_u32 m0, s24, 131072
    s_add_u32 s22, s19, 663552
    buffer_load_dwordx4 v180, s[52:55], s22 offen offset:0 lds
    buffer_load_dwordx4 v181, s[52:55], s22 offen offset:1024 lds
    s_add_u32 m0, s24, 106496
    s_add_u32 s22, s19, 1880064
    buffer_load_dwordx4 v180, s[52:55], s22 offen offset:0 lds
    buffer_load_dwordx4 v181, s[52:55], s22 offen offset:1024 lds
    s_add_u32 m0, s24, 139264
    s_add_u32 s22, s19, 774144
    buffer_load_dwordx4 v180, s[52:55], s22 offen offset:0 lds
    buffer_load_dwordx4 v181, s[52:55], s22 offen offset:1024 lds
    s_setprio 1
L_join_14:
    s_barrier
    s_add_u32 m0, s63, 16384
    s_nop 0
    buffer_load_dwordx4 v180, s[52:55], s64 offen lds
    buffer_load_dwordx4 v181, s[52:55], s64 offen offset:1024 lds
    s_add_u32 s64, s64, 110592
    s_add_u32 m0, s63, 24576
    s_nop 0
    buffer_load_dwordx4 v180, s[52:55], s64 offen lds
    buffer_load_dwordx4 v181, s[52:55], s64 offen offset:1024 lds
    s_add_u32 s64, s64, 110592
    s_add_u32 s58, s20, 0
    buffer_load_dwordx4 v[68:71], v182, s[8:11], s58 offen offset:0 sc1
    buffer_load_dwordx4 v[72:75], v182, s[8:11], s58 offen offset:1024 sc1
    buffer_load_dwordx4 v[76:79], v182, s[8:11], s58 offen offset:2048 sc1
    buffer_load_dwordx4 v[80:83], v182, s[8:11], s58 offen offset:3072 sc1
    s_setprio 0
    s_add_u32 s58, s20, 4096
    buffer_load_dwordx4 v[84:87], v182, s[8:11], s58 offen offset:0 sc1
    buffer_load_dwordx4 v[88:91], v182, s[8:11], s58 offen offset:1024 sc1
    buffer_load_dwordx4 v[92:95], v182, s[8:11], s58 offen offset:2048 sc1
    buffer_load_dwordx4 v[96:99], v182, s[8:11], s58 offen offset:3072 sc1
    ds_read_b64_tr_b16 v[148:149], v184 offset:0
    ds_read_b64_tr_b16 v[150:151], v184 offset:4096
    ds_read_b64_tr_b16 v[152:153], v185 offset:0
    ds_read_b64_tr_b16 v[154:155], v185 offset:4096
    ds_read_b64_tr_b16 v[156:157], v186 offset:0
    ds_read_b64_tr_b16 v[158:159], v186 offset:4096
    ds_read_b64_tr_b16 v[160:161], v187 offset:0
    ds_read_b64_tr_b16 v[162:163], v187 offset:4096
    ds_read_b64_tr_b16 v[164:165], v184 offset:2048
    ds_read_b64_tr_b16 v[166:167], v184 offset:6144
    s_waitcnt vmcnt(7)
L_chk_108:
    v_and_b32 v207, 1, v68
    v_cmp_eq_u32 vcc, 0, v207
    s_cbranch_vccnz L_stub_109
L_ok_110:
    s_waitcnt lgkmcnt(8)
    v_mfma_f32_32x32x16_bf16 v[4:19], v[148:151], v[68:71], 0
    ds_read_b64_tr_b16 v[168:169], v185 offset:2048
    ds_read_b64_tr_b16 v[170:171], v185 offset:6144
    s_waitcnt lgkmcnt(8)
    v_mfma_f32_32x32x16_bf16 v[20:35], v[152:155], v[68:71], 0
    ds_read_b64_tr_b16 v[172:173], v186 offset:2048
    ds_read_b64_tr_b16 v[174:175], v186 offset:6144
    s_add_u32 s58, s20, 8192
    buffer_load_dwordx4 v[100:103], v182, s[8:11], s58 offen offset:0 sc1
    s_waitcnt lgkmcnt(8)
    v_mfma_f32_32x32x16_bf16 v[36:51], v[156:159], v[68:71], 0
    ds_read_b64_tr_b16 v[176:177], v187 offset:2048
    ds_read_b64_tr_b16 v[178:179], v187 offset:6144
    s_waitcnt vmcnt(7)
L_chk_111:
    v_and_b32 v207, 1, v72
    v_cmp_eq_u32 vcc, 0, v207
    s_cbranch_vccnz L_stub_112
L_ok_113:
    s_waitcnt lgkmcnt(8)
    v_mfma_f32_32x32x16_bf16 v[52:67], v[160:163], v[68:71], 0
    ds_read_b64_tr_b16 v[148:149], v184 offset:8192
    ds_read_b64_tr_b16 v[150:151], v184 offset:12288
    buffer_load_dwordx4 v[104:107], v182, s[8:11], s58 offen offset:1024 sc1
    s_waitcnt lgkmcnt(8)
    v_mfma_f32_32x32x16_bf16 v[4:19], v[164:167], v[72:75], v[4:19]
    ds_read_b64_tr_b16 v[152:153], v185 offset:8192
    ds_read_b64_tr_b16 v[154:155], v185 offset:12288
    s_waitcnt lgkmcnt(8)
    v_mfma_f32_32x32x16_bf16 v[20:35], v[168:171], v[72:75], v[20:35]
    ds_read_b64_tr_b16 v[156:157], v186 offset:8192
    ds_read_b64_tr_b16 v[158:159], v186 offset:12288
    buffer_load_dwordx4 v[108:111], v182, s[8:11], s58 offen offset:2048 sc1
    s_waitcnt lgkmcnt(8)
    v_mfma_f32_32x32x16_bf16 v[36:51], v[172:175], v[72:75], v[36:51]
    ds_read_b64_tr_b16 v[160:161], v187 offset:8192
    ds_read_b64_tr_b16 v[162:163], v187 offset:12288
    s_waitcnt vmcnt(8)
L_chk_114:
    v_and_b32 v207, 1, v76
    v_cmp_eq_u32 vcc, 0, v207
    s_cbranch_vccnz L_stub_115
L_ok_116:
    s_waitcnt lgkmcnt(8)
    v_mfma_f32_32x32x16_bf16 v[52:67], v[176:179], v[72:75], v[52:67]
    ds_read_b64_tr_b16 v[164:165], v184 offset:10240
    ds_read_b64_tr_b16 v[166:167], v184 offset:14336
    buffer_load_dwordx4 v[112:115], v182, s[8:11], s58 offen offset:3072 sc1
    s_waitcnt lgkmcnt(8)
    v_mfma_f32_32x32x16_bf16 v[4:19], v[148:151], v[76:79], v[4:19]
    ds_read_b64_tr_b16 v[168:169], v185 offset:10240
    ds_read_b64_tr_b16 v[170:171], v185 offset:14336
    s_waitcnt lgkmcnt(8)
    v_mfma_f32_32x32x16_bf16 v[20:35], v[152:155], v[76:79], v[20:35]
    ds_read_b64_tr_b16 v[172:173], v186 offset:10240
    ds_read_b64_tr_b16 v[174:175], v186 offset:14336
    s_add_u32 s58, s20, 12288
    buffer_load_dwordx4 v[116:119], v182, s[8:11], s58 offen offset:0 sc1
    s_waitcnt lgkmcnt(8)
    v_mfma_f32_32x32x16_bf16 v[36:51], v[156:159], v[76:79], v[36:51]
    ds_read_b64_tr_b16 v[176:177], v187 offset:10240
    ds_read_b64_tr_b16 v[178:179], v187 offset:14336
    s_waitcnt vmcnt(9)
L_chk_117:
    v_and_b32 v207, 1, v80
    v_cmp_eq_u32 vcc, 0, v207
    s_cbranch_vccnz L_stub_118
L_ok_119:
    s_waitcnt lgkmcnt(8)
    v_mfma_f32_32x32x16_bf16 v[52:67], v[160:163], v[76:79], v[52:67]
    ds_read_b64_tr_b16 v[148:149], v188 offset:16384
    ds_read_b64_tr_b16 v[150:151], v188 offset:17408
    buffer_load_dwordx4 v[120:123], v182, s[8:11], s58 offen offset:1024 sc1
    s_waitcnt lgkmcnt(8)
    v_mfma_f32_32x32x16_bf16 v[4:19], v[164:167], v[80:83], v[4:19]
    ds_read_b64_tr_b16 v[152:153], v189 offset:16384
    ds_read_b64_tr_b16 v[154:155], v189 offset:17408
    s_waitcnt lgkmcnt(8)
    v_mfma_f32_32x32x16_bf16 v[20:35], v[168:171], v[80:83], v[20:35]
    ds_read_b64_tr_b16 v[156:157], v190 offset:16384
    ds_read_b64_tr_b16 v[158:159], v190 offset:17408
    buffer_load_dwordx4 v[124:127], v182, s[8:11], s58 offen offset:2048 sc1
    s_waitcnt lgkmcnt(8)
    v_mfma_f32_32x32x16_bf16 v[36:51], v[172:175], v[80:83], v[36:51]
    ds_read_b64_tr_b16 v[160:161], v191 offset:16384
    ds_read_b64_tr_b16 v[162:163], v191 offset:17408
    s_waitcnt vmcnt(10)
L_chk_120:
    v_bitop3_b32 v207, v84, v86, 1 bitop3:0x80
    v_cmp_eq_u32 vcc, 0, v207
    s_cbranch_vccnz L_stub_121
L_ok_122:
    s_waitcnt lgkmcnt(8)
    v_mfma_f32_32x32x16_bf16 v[52:67], v[176:179], v[80:83], v[52:67]
    ds_read_b64_tr_b16 v[164:165], v184 offset:20480
    ds_read_b64_tr_b16 v[166:167], v184 offset:24576
    buffer_load_dwordx4 v[128:131], v182, s[8:11], s58 offen offset:3072 sc1
    s_waitcnt lgkmcnt(8)
    v_mfma_f32_32x32x16_bf16 v[4:19], v[148:151], v[84:87], v[4:19]
    ds_read_b64_tr_b16 v[168:169], v185 offset:20480
    ds_read_b64_tr_b16 v[170:171], v185 offset:24576
    s_waitcnt lgkmcnt(8)
    v_mfma_f32_32x32x16_bf16 v[20:35], v[152:155], v[84:87], v[20:35]
    ds_read_b64_tr_b16 v[172:173], v186 offset:20480
    ds_read_b64_tr_b16 v[174:175], v186 offset:24576
    s_add_u32 s58, s20, 16384
    buffer_load_dwordx4 v[132:135], v182, s[8:11], s58 offen offset:0 sc1
    s_waitcnt lgkmcnt(8)
    v_mfma_f32_32x32x16_bf16 v[36:51], v[156:159], v[84:87], v[36:51]
    ds_read_b64_tr_b16 v[176:177], v187 offset:20480
    ds_read_b64_tr_b16 v[178:179], v187 offset:24576
    s_waitcnt vmcnt(11)
L_chk_123:
    v_and_b32 v207, 1, v88
    v_cmp_eq_u32 vcc, 0, v207
    s_cbranch_vccnz L_stub_124
L_ok_125:
    s_waitcnt lgkmcnt(8)
    v_mfma_f32_32x32x16_bf16 v[52:67], v[160:163], v[84:87], v[52:67]
    ds_read_b64_tr_b16 v[148:149], v184 offset:22528
    ds_read_b64_tr_b16 v[150:151], v184 offset:26624
    buffer_load_dwordx4 v[136:139], v182, s[8:11], s58 offen offset:1024 sc1
    s_waitcnt lgkmcnt(8)
    v_mfma_f32_32x32x16_bf16 v[4:19], v[164:167], v[88:91], v[4:19]
    ds_read_b64_tr_b16 v[152:153], v185 offset:22528
    ds_read_b64_tr_b16 v[154:155], v185 offset:26624
    s_waitcnt lgkmcnt(8)
    v_mfma_f32_32x32x16_bf16 v[20:35], v[168:171], v[88:91], v[20:35]
    ds_read_b64_tr_b16 v[156:157], v186 offset:22528
    ds_read_b64_tr_b16 v[158:159], v186 offset:26624
    buffer_load_dwordx4 v[140:143], v182, s[8:11], s58 offen offset:2048 sc1
    s_waitcnt lgkmcnt(8)
    v_mfma_f32_32x32x16_bf16 v[36:51], v[172:175], v[88:91], v[36:51]
    ds_read_b64_tr_b16 v[160:161], v187 offset:22528
    ds_read_b64_tr_b16 v[162:163], v187 offset:26624
    s_waitcnt vmcnt(12)
L_chk_126:
    v_and_b32 v207, 1, v92
    v_cmp_eq_u32 vcc, 0, v207
    s_cbranch_vccnz L_stub_127
L_ok_128:
    s_waitcnt lgkmcnt(8)
    v_mfma_f32_32x32x16_bf16 v[52:67], v[176:179], v[88:91], v[52:67]
    ds_read_b64_tr_b16 v[164:165], v184 offset:28672
    ds_read_b64_tr_b16 v[166:167], v184 offset:32768
    buffer_load_dwordx4 v[144:147], v182, s[8:11], s58 offen offset:3072 sc1
    s_waitcnt lgkmcnt(8)
    v_mfma_f32_32x32x16_bf16 v[4:19], v[148:151], v[92:95], v[4:19]
    ds_read_b64_tr_b16 v[168:169], v185 offset:28672
    ds_read_b64_tr_b16 v[170:171], v185 offset:32768
    s_waitcnt lgkmcnt(8)
    v_mfma_f32_32x32x16_bf16 v[20:35], v[152:155], v[92:95], v[20:35]
    ds_read_b64_tr_b16 v[172:173], v186 offset:28672
    ds_read_b64_tr_b16 v[174:175], v186 offset:32768
    s_add_u32 s58, s29, 0
    buffer_load_dwordx2 v[216:217], v206, s[8:11], s58 offen sc1
    s_waitcnt lgkmcnt(8)
    v_mfma_f32_32x32x16_bf16 v[36:51], v[156:159], v[92:95], v[36:51]
    ds_read_b64_tr_b16 v[176:177], v187 offset:28672
    ds_read_b64_tr_b16 v[178:179], v187 offset:32768
    s_waitcnt vmcnt(13)
L_chk_129:
    v_and_b32 v207, 1, v96
    v_cmp_eq_u32 vcc, 0, v207
    s_cbranch_vccnz L_stub_130
L_ok_131:
    s_waitcnt lgkmcnt(8)
    v_mfma_f32_32x32x16_bf16 v[52:67], v[160:163], v[92:95], v[52:67]
    ds_read_b64_tr_b16 v[148:149], v184 offset:30720
    ds_read_b64_tr_b16 v[150:151], v184 offset:34816
    s_add_u32 s58, s29, 16384
    buffer_load_dwordx2 v[218:219], v206, s[8:11], s58 offen sc1
    s_waitcnt lgkmcnt(8)
    v_mfma_f32_32x32x16_bf16 v[4:19], v[164:167], v[96:99], v[4:19]
    ds_read_b64_tr_b16 v[152:153], v185 offset:30720
    ds_read_b64_tr_b16 v[154:155], v185 offset:34816
    s_waitcnt lgkmcnt(8)
    v_mfma_f32_32x32x16_bf16 v[20:35], v[168:171], v[96:99], v[20:35]
    ds_read_b64_tr_b16 v[156:157], v186 offset:30720
    ds_read_b64_tr_b16 v[158:159], v186 offset:34816
    s_add_u32 s58, s29, 32768
    buffer_load_dwordx2 v[220:221], v206, s[8:11], s58 offen sc1
    s_waitcnt lgkmcnt(8)
    v_mfma_f32_32x32x16_bf16 v[36:51], v[172:175], v[96:99], v[36:51]
    ds_read_b64_tr_b16 v[160:161], v187 offset:30720
    ds_read_b64_tr_b16 v[162:163], v187 offset:34816
    s_waitcnt vmcnt(14)
L_chk_132:
    v_and_b32 v207, 1, v100
    v_cmp_eq_u32 vcc, 0, v207
    s_cbranch_vccnz L_stub_133
L_ok_134:
    s_cmp_lg_u32 s18, 0
    s_cbranch_scc1 L_nox1_135
    buffer_store_dwordx4 v[244:247], v254, s[8:11], s56 offen sc0 sc1
    buffer_store_dwordx4 v[248:251], v254, s[8:11], s56 offen offset:2048 sc0 sc1
    buffer_store_dwordx2 v[252:253], v255, s[8:11], s57 offen sc0 sc1
L_nox1_135:
    s_waitcnt lgkmcnt(8)
    v_mfma_f32_32x32x16_bf16 v[52:67], v[176:179], v[96:99], v[52:67]
    ds_read_b64_tr_b16 v[164:165], v188 offset:36864
    ds_read_b64_tr_b16 v[166:167], v188 offset:37888
    s_add_u32 s58, s29, 49152
    buffer_load_dwordx2 v[222:223], v206, s[8:11], s58 offen sc1
    s_waitcnt lgkmcnt(8)
    v_mfma_f32_32x32x16_bf16 v[4:19], v[148:151], v[100:103], v[4:19]
    ds_read_b64_tr_b16 v[168:169], v189 offset:36864
    ds_read_b64_tr_b16 v[170:171], v189 offset:37888
    s_waitcnt lgkmcnt(8)
    v_mfma_f32_32x32x16_bf16 v[20:35], v[152:155], v[100:103], v[20:35]
    ds_read_b64_tr_b16 v[172:173], v190 offset:36864
    ds_read_b64_tr_b16 v[174:175], v190 offset:37888
    buffer_load_dwordx4 v[224:227], v182, s[8:11], s30 offen offset:0
    s_waitcnt lgkmcnt(8)
    v_mfma_f32_32x32x16_bf16 v[36:51], v[156:159], v[100:103], v[36:51]
    ds_read_b64_tr_b16 v[176:177], v191 offset:36864
    ds_read_b64_tr_b16 v[178:179], v191 offset:37888
    s_waitcnt vmcnt(15)
L_chk_136:
    v_bitop3_b32 v207, v104, v106, 1 bitop3:0x80
    v_cmp_eq_u32 vcc, 0, v207
    s_cbranch_vccnz L_stub_137
L_ok_138:
    s_waitcnt lgkmcnt(8)
    v_mfma_f32_32x32x16_bf16 v[52:67], v[160:163], v[100:103], v[52:67]
    ds_read_b64_tr_b16 v[148:149], v186 offset:40960
    ds_read_b64_tr_b16 v[150:151], v186 offset:45056
    buffer_load_dwordx4 v[228:231], v182, s[8:11], s30 offen offset:1024
    s_waitcnt lgkmcnt(8)
    v_mfma_f32_32x32x16_bf16 v[4:19], v[164:167], v[104:107], v[4:19]
    ds_read_b64_tr_b16 v[152:153], v187 offset:40960
    ds_read_b64_tr_b16 v[154:155], v187 offset:45056
    s_waitcnt lgkmcnt(8)
    v_mfma_f32_32x32x16_bf16 v[20:35], v[168:171], v[104:107], v[20:35]
    ds_read_b64_tr_b16 v[156:157], v186 offset:43008
    ds_read_b64_tr_b16 v[158:159], v186 offset:47104
    s_lshr_b32 s58, s2, 6
    s_lshl_b32 s58, s58, 3
    s_add_u32 s58, s58, s16
    s_cmp_ge_u32 s58, 16
    s_cbranch_scc1 L_nopf_139
    s_cmp_ge_u32 s58, 8
    s_cselect_b32 s60, 10, 0
    s_add_u32 s58, s58, s60
    s_bfe_u32 s60, s2, 0x30003
    s_xor_b32 s60, s60, 2
    s_lshl_b32 s60, s60, 5
    s_add_u32 s58, s58, s60
    s_bfe_u32 s60, s2, 0x20001
    s_lshl_b32 s60, s60, 8
    s_add_u32 s58, s58, s60
    s_lshl_b32 s58, s58, 13
    s_add_u32 s58, s58, 0x2800000
    v_lshlrev_b32 v202, 3, v182
    buffer_load_dword v203, v202, s[8:11], s58 offen
L_nopf_139:
    s_waitcnt lgkmcnt(8)
    v_mfma_f32_32x32x16_bf16 v[36:51], v[172:175], v[104:107], v[36:51]
    ds_read_b64_tr_b16 v[160:161], v187 offset:43008
    ds_read_b64_tr_b16 v[162:163], v187 offset:47104
    s_waitcnt vmcnt(15)
L_chk_140:
    v_and_b32 v207, 1, v108
    v_cmp_eq_u32 vcc, 0, v207
    s_cbranch_vccnz L_stub_141
L_ok_142:
    s_waitcnt lgkmcnt(8)
    v_mfma_f32_32x32x16_bf16 v[52:67], v[176:179], v[104:107], v[52:67]
    s_barrier
    ds_read_b64_tr_b16 v[164:165], v194 offset:0
    ds_read_b64_tr_b16 v[166:167], v194 offset:4096
    s_waitcnt lgkmcnt(8)
    v_mfma_f32_32x32x16_bf16 v[36:51], v[148:151], v[108:111], v[36:51]
    ds_read_b64_tr_b16 v[168:169], v195 offset:0
    ds_read_b64_tr_b16 v[170:171], v195 offset:4096
    s_waitcnt vmcnt(14)
L_chk_143:
    v_and_b32 v207, 1, v112
    v_cmp_eq_u32 vcc, 0, v207
    s_cbranch_vccnz L_stub_144
L_ok_145:
    s_waitcnt lgkmcnt(8)
    v_mfma_f32_32x32x16_bf16 v[52:67], v[152:155], v[108:111], v[52:67]
    ds_read_b64_tr_b16 v[172:173], v194 offset:2048
    ds_read_b64_tr_b16 v[174:175], v194 offset:6144
    s_waitcnt lgkmcnt(8)
    v_mfma_f32_32x32x16_bf16 v[36:51], v[156:159], v[112:115], v[36:51]
    ds_read_b64_tr_b16 v[176:177], v195 offset:2048
    ds_read_b64_tr_b16 v[178:179], v195 offset:6144
    s_waitcnt vmcnt(13)
L_chk_146:
    v_and_b32 v207, 1, v116
    v_cmp_eq_u32 vcc, 0, v207
    s_cbranch_vccnz L_stub_147
L_ok_148:
    s_waitcnt lgkmcnt(8)
    v_mfma_f32_32x32x16_bf16 v[52:67], v[160:163], v[112:115], v[52:67]
    ds_read_b64_tr_b16 v[148:149], v198 offset:8192
    ds_read_b64_tr_b16 v[150:151], v198 offset:9216
    s_waitcnt lgkmcnt(8)
    v_mfma_f32_32x32x16_bf16 v[36:51], v[164:167], v[116:119], v[36:51]
    ds_read_b64_tr_b16 v[152:153], v199 offset:8192
    ds_read_b64_tr_b16 v[154:155], v199 offset:9216
    s_waitcnt vmcnt(12)
L_chk_149:
    v_and_b32 v207, 1, v120
    v_cmp_eq_u32 vcc, 0, v207
    s_cbranch_vccnz L_stub_150
L_ok_151:
    s_waitcnt vmcnt(2)
L_chk_152:
    v_max3_u32 v207, v216, v217, v218
    v_max3_u32 v207, v207, v219, v220
    v_max3_u32 v207, v207, v221, v222
    v_max_u32 v207, v207, v223
    v_cmp_eq_u32 vcc, -1, v207
    s_cbranch_vccnz L_stub_153
L_ok_154:
    s_waitcnt lgkmcnt(8)
    v_mfma_f32_32x32x16_bf16 v[52:67], v[168:171], v[116:119], v[52:67]
    ds_read_b64_tr_b16 v[156:157], v194 offset:12288
    ds_read_b64_tr_b16 v[158:159], v194 offset:16384
    v_pk_add_f32 v[216:217], v[216:217], v[218:219]
    v_pk_add_f32 v[216:217], v[216:217], v[220:221]
    v_pk_add_f32 v[216:217], v[216:217], v[222:223]
    s_waitcnt lgkmcnt(8)
    v_mfma_f32_32x32x16_bf16 v[36:51], v[172:175], v[120:123], v[36:51]
    ds_read_b64_tr_b16 v[160:161], v195 offset:12288
    ds_read_b64_tr_b16 v[162:163], v195 offset:16384
L_chk_155:
    v_bitop3_b32 v207, v124, v126, 1 bitop3:0x80
    v_cmp_eq_u32 vcc, 0, v207
    s_cbranch_vccnz L_stub_156
L_ok_157:
    v_mov_b32 v218, v216
    s_nop 1
    v_permlane32_swap_b32 v216, v218
    v_add_f32 v216, v216, v218
    v_mov_b32 v219, v217
    s_nop 1
    v_permlane32_swap_b32 v217, v219
    v_add_f32 v217, v217, v219
    v_mul_f32 v218, 0xbacccccd, v216
    s_waitcnt lgkmcnt(8)
    v_mfma_f32_32x32x16_bf16 v[52:67], v[176:179], v[120:123], v[52:67]
    ds_read_b64_tr_b16 v[164:165], v194 offset:14336
    ds_read_b64_tr_b16 v[166:167], v194 offset:18432
    v_mov_b32 v204, 0x3727c5ac
    v_fmac_f32 v204, 0x3acccccd, v217
    v_fma_f32 v204, -v218, v218, v204
    s_waitcnt lgkmcnt(8)
    v_mfma_f32_32x32x16_bf16 v[36:51], v[148:151], v[124:127], v[36:51]
    ds_read_b64_tr_b16 v[168:169], v195 offset:14336
    ds_read_b64_tr_b16 v[170:171], v195 offset:18432
L_chk_158:
    v_and_b32 v207, 1, v128
    v_cmp_eq_u32 vcc, 0, v207
    s_cbranch_vccnz L_stub_159
L_ok_160:
    v_max_f32 v204, 0x3727c5ac, v204
    v_rsq_f32 v216, v204
    s_nop 0
    v_mul_f32 v208, v216, v204
    s_waitcnt lgkmcnt(8)
    v_mfma_f32_32x32x16_bf16 v[52:67], v[152:155], v[124:127], v[52:67]
    ds_read_b64_tr_b16 v[172:173], v194 offset:20480
    ds_read_b64_tr_b16 v[174:175], v194 offset:24576
    v_cvt_pk_bf16_f32 v232, v208, v208
    v_and_b32 v232, 0xffff0000, v232
    v_sub_f32 v233, v208, v232
    s_waitcnt lgkmcnt(8)
    v_mfma_f32_32x32x16_bf16 v[36:51], v[156:159], v[128:131], v[36:51]
    ds_read_b64_tr_b16 v[176:177], v195 offset:20480
    ds_read_b64_tr_b16 v[178:179], v195 offset:24576
L_chk_161:
    v_and_b32 v207, 1, v132
    v_cmp_eq_u32 vcc, 0, v207
    s_cbranch_vccnz L_stub_162
L_ok_163:
    v_cvt_pk_bf16_f32 v232, v232, v233
    v_mov_b32 v233, v232
    v_cvt_pk_bf16_f32 v234, v218, v218
    s_waitcnt lgkmcnt(8)
    v_mfma_f32_32x32x16_bf16 v[52:67], v[160:163], v[128:131], v[52:67]
    ds_read_b64_tr_b16 v[148:149], v194 offset:22528
    ds_read_b64_tr_b16 v[150:151], v194 offset:26624
    v_and_b32 v234, 0xffff0000, v234
    v_sub_f32 v235, v218, v234
    v_cvt_pk_bf16_f32 v234, v234, v235
    s_waitcnt lgkmcnt(8)
    v_mfma_f32_32x32x16_bf16 v[36:51], v[164:167], v[132:135], v[36:51]
    ds_read_b64_tr_b16 v[152:153], v195 offset:22528
    ds_read_b64_tr_b16 v[154:155], v195 offset:26624
L_chk_164:
    v_and_b32 v207, 1, v136
    v_cmp_eq_u32 vcc, 0, v207
    s_cbranch_vccnz L_stub_165
L_ok_166:
    v_mov_b32 v235, v234
    v_mov_b32 v209, v208
    v_mul_f32 v210, 0xc0135761, v216
    s_waitcnt lgkmcnt(8)
    v_mfma_f32_32x32x16_bf16 v[52:67], v[168:171], v[132:135], v[52:67]
    ds_read_b64_tr_b16 v[156:157], v198 offset:28672
    ds_read_b64_tr_b16 v[158:159], v198 offset:29696
    v_mul_f32 v212, v216, v216
    v_mul_f32 v212, v212, v216
    v_mul_f32 v212, 0xbdd2d3e8, v212
    s_waitcnt lgkmcnt(8)
    v_mfma_f32_32x32x16_bf16 v[36:51], v[172:175], v[136:139], v[36:51]
    ds_read_b64_tr_b16 v[160:161], v199 offset:28672
    ds_read_b64_tr_b16 v[162:163], v199 offset:29696
L_chk_167:
    v_and_b32 v207, 1, v140
    v_cmp_eq_u32 vcc, 0, v207
    s_cbranch_vccnz L_stub_168
L_ok_169:
    v_mov_b32 v211, v210
    v_mov_b32 v213, v212
    s_lshl_b32 s22, s17, 13
    s_waitcnt lgkmcnt(8)
    v_mfma_f32_32x32x16_bf16 v[52:67], v[176:179], v[136:139], v[52:67]
    ds_read_b64_tr_b16 v[164:165], v184 offset:40960
    ds_read_b64_tr_b16 v[166:167], v184 offset:45056
    s_add_u32 s22, s22, 8192
    s_add_u32 s23, s22, s21
    s_sub_u32 s24, 49152, s21
    s_waitcnt lgkmcnt(8)
    v_mfma_f32_32x32x16_bf16 v[36:51], v[148:151], v[140:143], v[36:51]
    ds_read_b64_tr_b16 v[168:169], v184 offset:43008
    ds_read_b64_tr_b16 v[170:171], v184 offset:47104
L_chk_170:
    v_bitop3_b32 v207, v144, v146, 1 bitop3:0x80
    v_cmp_eq_u32 vcc, 0, v207
    s_cbranch_vccnz L_stub_171
L_ok_172:
    s_add_u32 s24, s22, s24
    v_add_u32 v200, s23, v182
    v_add_u32 v201, s24, v182
    s_waitcnt lgkmcnt(8)
    v_mfma_f32_32x32x16_bf16 v[52:67], v[152:155], v[140:143], v[52:67]
    ds_read_b64_tr_b16 v[172:173], v192 offset:0
    ds_read_b64_tr_b16 v[174:175], v192 offset:4096
    s_sub_u32 s37, 0, s18
    s_mov_b32 s36, 0
    s_waitcnt lgkmcnt(8)
    v_mfma_f32_32x32x16_bf16 v[36:51], v[156:159], v[144:147], v[36:51]
    ds_read_b64_tr_b16 v[176:177], v192 offset:2048
    ds_read_b64_tr_b16 v[178:179], v192 offset:6144
    s_waitcnt lgkmcnt(8)
    v_mfma_f32_32x32x16_bf16 v[52:67], v[160:163], v[144:147], v[52:67]
    ds_read_b64_tr_b16 v[148:149], v196 offset:8192
    ds_read_b64_tr_b16 v[150:151], v196 offset:9216
    s_waitcnt lgkmcnt(8)
    v_mfma_f32_32x32x16_bf16 v[4:19], v[164:167], v[108:111], v[4:19]
    ds_read_b64_tr_b16 v[152:153], v192 offset:12288
    ds_read_b64_tr_b16 v[154:155], v192 offset:16384
    s_waitcnt lgkmcnt(8)
    v_mfma_f32_32x32x16_bf16 v[4:19], v[168:171], v[112:115], v[4:19]
    ds_read_b64_tr_b16 v[156:157], v192 offset:14336
    ds_read_b64_tr_b16 v[158:159], v192 offset:18432
    ds_write_b128 v200, v[36:39] offset:0
    ds_write_b128 v200, v[40:43] offset:1024
    s_waitcnt lgkmcnt(10)
    v_mfma_f32_32x32x16_bf16 v[4:19], v[172:175], v[116:119], v[4:19]
    ds_read_b64_tr_b16 v[160:161], v192 offset:20480
    ds_read_b64_tr_b16 v[162:163], v192 offset:24576
    ds_write_b128 v200, v[44:47] offset:2048
    ds_write_b128 v200, v[48:51] offset:3072
    s_waitcnt lgkmcnt(12)
    v_mfma_f32_32x32x16_bf16 v[4:19], v[176:179], v[120:123], v[4:19]
    ds_read_b64_tr_b16 v[164:165], v192 offset:22528
    ds_read_b64_tr_b16 v[166:167], v192 offset:26624
    ds_write_b128 v200, v[52:55] offset:4096
    ds_write_b128 v200, v[56:59] offset:5120
    s_waitcnt lgkmcnt(14)
    v_mfma_f32_32x32x16_bf16 v[4:19], v[148:151], v[124:127], v[4:19]
    ds_read_b64_tr_b16 v[168:169], v196 offset:28672
    ds_read_b64_tr_b16 v[170:171], v196 offset:29696
    ds_write_b128 v200, v[60:63] offset:6144
    ds_write_b128 v200, v[64:67] offset:7168
    s_waitcnt lgkmcnt(15)
    v_mfma_f32_32x32x16_bf16 v[4:19], v[152:155], v[128:131], v[4:19]
    ds_read_b64_tr_b16 v[172:173], v185 offset:40960
    ds_read_b64_tr_b16 v[174:175], v185 offset:45056
    s_waitcnt lgkmcnt(15)
    v_mfma_f32_32x32x16_bf16 v[4:19], v[156:159], v[132:135], v[4:19]
    ds_read_b64_tr_b16 v[176:177], v185 offset:43008
    ds_read_b64_tr_b16 v[178:179], v185 offset:47104
    s_waitcnt lgkmcnt(4)
    s_barrier
    ds_read_b128 v[68:71], v201 offset:0
    ds_read_b128 v[72:75], v201 offset:1024
    ds_read_b128 v[76:79], v201 offset:2048
    ds_read_b128 v[80:83], v201 offset:3072
    v_mfma_f32_32x32x16_bf16 v[4:19], v[160:163], v[136:139], v[4:19]
    ds_read_b64_tr_b16 v[148:149], v193 offset:0
    ds_read_b64_tr_b16 v[150:151], v193 offset:4096
    ds_read_b128 v[84:87], v201 offset:4096
    ds_read_b128 v[88:91], v201 offset:5120
    ds_read_b128 v[92:95], v201 offset:6144
    ds_read_b128 v[96:99], v201 offset:7168
    v_mfma_f32_32x32x16_bf16 v[4:19], v[164:167], v[140:143], v[4:19]
    ds_read_b64_tr_b16 v[152:153], v193 offset:2048
    ds_read_b64_tr_b16 v[154:155], v193 offset:6144
    v_mfma_f32_32x32x16_bf16 v[4:19], v[168:171], v[144:147], v[4:19]
    ds_read_b64_tr_b16 v[156:157], v197 offset:8192
    ds_read_b64_tr_b16 v[158:159], v197 offset:9216
    s_waitcnt vmcnt(1)
    v_mfma_f32_32x32x16_bf16 v[4:19], v[224:227], v[232:235], v[4:19]
    s_waitcnt vmcnt(0)
    v_mfma_f32_32x32x16_bf16 v[20:35], v[228:231], v[232:235], v[20:35]
    s_waitcnt lgkmcnt(15)
    v_mfma_f32_32x32x16_bf16 v[20:35], v[172:175], v[108:111], v[20:35]
    ds_read_b64_tr_b16 v[160:161], v193 offset:12288
    ds_read_b64_tr_b16 v[162:163], v193 offset:16384
    s_waitcnt lgkmcnt(15)
    s_nop 4
    v_pk_add_f32 v[4:5], v[4:5], v[68:69]
    v_pk_add_f32 v[6:7], v[6:7], v[70:71]
    s_waitcnt lgkmcnt(14)
    v_pk_add_f32 v[8:9], v[8:9], v[72:73]
    v_pk_add_f32 v[10:11], v[10:11], v[74:75]
    v_pk_mul_f32 v[36:37], v[4:5], v[4:5]
    v_pk_mul_f32 v[38:39], v[6:7], v[6:7]
    v_pk_mul_f32 v[40:41], v[8:9], v[8:9]
    v_pk_mul_f32 v[42:43], v[10:11], v[10:11]
    v_pk_fma_f32 v[36:37], v[36:37], v[212:213], v[210:211]
    v_mfma_f32_32x32x16_bf16 v[20:35], v[176:179], v[112:115], v[20:35]
    ds_read_b64_tr_b16 v[164:165], v193 offset:14336
    ds_read_b64_tr_b16 v[166:167], v193 offset:18432
    v_pk_fma_f32 v[38:39], v[38:39], v[212:213], v[210:211]
    v_pk_fma_f32 v[40:41], v[40:41], v[212:213], v[210:211]
    v_pk_fma_f32 v[42:43], v[42:43], v[212:213], v[210:211]
    v_pk_mul_f32 v[36:37], v[36:37], v[4:5]
    v_pk_mul_f32 v[38:39], v[38:39], v[6:7]
    v_pk_mul_f32 v[40:41], v[40:41], v[8:9]
    v_pk_mul_f32 v[42:43], v[42:43], v[10:11]
    v_exp_f32 v36, v36
    v_exp_f32 v37, v37
    s_waitcnt lgkmcnt(12)
    v_mfma_f32_32x32x16_bf16 v[20:35], v[148:151], v[116:119], v[20:35]
    ds_read_b64_tr_b16 v[168:169], v193 offset:20480
    ds_read_b64_tr_b16 v[170:171], v193 offset:24576
    v_exp_f32 v38, v38
    v_exp_f32 v39, v39
    v_exp_f32 v40, v40
    v_exp_f32 v41, v41
    v_exp_f32 v42, v42
    v_exp_f32 v43, v43
    v_pk_fma_f32 v[36:37], v[36:37], v[208:209], v[208:209]
    v_pk_fma_f32 v[38:39], v[38:39], v[208:209], v[208:209]
    v_pk_fma_f32 v[40:41], v[40:41], v[208:209], v[208:209]
    s_waitcnt lgkmcnt(8)
    v_mfma_f32_32x32x16_bf16 v[20:35], v[152:155], v[120:123], v[20:35]
    ds_read_b64_tr_b16 v[172:173], v193 offset:22528
    ds_read_b64_tr_b16 v[174:175], v193 offset:26624
    v_pk_fma_f32 v[42:43], v[42:43], v[208:209], v[208:209]
    v_rcp_f32 v36, v36
    v_rcp_f32 v37, v37
    v_rcp_f32 v38, v38
    v_rcp_f32 v39, v39
    v_rcp_f32 v40, v40
    v_rcp_f32 v41, v41
    v_rcp_f32 v42, v42
    v_rcp_f32 v43, v43
    s_waitcnt lgkmcnt(8)
    v_mfma_f32_32x32x16_bf16 v[20:35], v[156:159], v[124:127], v[20:35]
    ds_read_b64_tr_b16 v[176:177], v197 offset:28672
    ds_read_b64_tr_b16 v[178:179], v197 offset:29696
    v_pk_mul_f32 v[4:5], v[4:5], v[36:37]
    v_pk_mul_f32 v[6:7], v[6:7], v[38:39]
    v_pk_mul_f32 v[8:9], v[8:9], v[40:41]
    v_pk_mul_f32 v[10:11], v[10:11], v[42:43]
    v_cvt_pk_f16_f32 v52, v4, v5
    v_cvt_pk_f16_f32 v53, v6, v7
    v_cvt_pk_f16_f32 v54, v8, v9
    v_cvt_pk_f16_f32 v55, v10, v11
    buffer_store_dwordx4 v[52:55], v182, s[8:11], s31 offen offset:0 sc0 sc1
    s_waitcnt lgkmcnt(8)
    v_mfma_f32_32x32x16_bf16 v[20:35], v[160:163], v[128:131], v[20:35]
    v_pk_add_f32 v[12:13], v[12:13], v[76:77]
    v_pk_add_f32 v[14:15], v[14:15], v[78:79]
    v_pk_add_f32 v[16:17], v[16:17], v[80:81]
    v_pk_add_f32 v[18:19], v[18:19], v[82:83]
    v_pk_mul_f32 v[44:45], v[12:13], v[12:13]
    v_pk_mul_f32 v[46:47], v[14:15], v[14:15]
    v_pk_mul_f32 v[48:49], v[16:17], v[16:17]
    v_pk_mul_f32 v[50:51], v[18:19], v[18:19]
    v_pk_fma_f32 v[44:45], v[44:45], v[212:213], v[210:211]
    s_waitcnt lgkmcnt(6)
    v_mfma_f32_32x32x16_bf16 v[20:35], v[164:167], v[132:135], v[20:35]
    v_pk_fma_f32 v[46:47], v[46:47], v[212:213], v[210:211]
    v_pk_fma_f32 v[48:49], v[48:49], v[212:213], v[210:211]
    v_pk_fma_f32 v[50:51], v[50:51], v[212:213], v[210:211]
    v_pk_mul_f32 v[44:45], v[44:45], v[12:13]
    v_pk_mul_f32 v[46:47], v[46:47], v[14:15]
    v_pk_mul_f32 v[48:49], v[48:49], v[16:17]
    v_pk_mul_f32 v[50:51], v[50:51], v[18:19]
    v_exp_f32 v44, v44
    v_exp_f32 v45, v45
    s_waitcnt lgkmcnt(4)
    v_mfma_f32_32x32x16_bf16 v[20:35], v[168:171], v[136:139], v[20:35]
    v_exp_f32 v46, v46
    v_exp_f32 v47, v47
    v_exp_f32 v48, v48
    v_exp_f32 v49, v49
    v_exp_f32 v50, v50
    v_exp_f32 v51, v51
    v_pk_fma_f32 v[44:45], v[44:45], v[208:209], v[208:209]
    v_pk_fma_f32 v[46:47], v[46:47], v[208:209], v[208:209]
    v_pk_fma_f32 v[48:49], v[48:49], v[208:209], v[208:209]
    s_waitcnt lgkmcnt(2)
    v_mfma_f32_32x32x16_bf16 v[20:35], v[172:175], v[140:143], v[20:35]
    v_pk_fma_f32 v[50:51], v[50:51], v[208:209], v[208:209]
    v_rcp_f32 v44, v44
    v_rcp_f32 v45, v45
    v_rcp_f32 v46, v46
    v_rcp_f32 v47, v47
    v_rcp_f32 v48, v48
    v_rcp_f32 v49, v49
    v_rcp_f32 v50, v50
    v_rcp_f32 v51, v51
    s_waitcnt lgkmcnt(0)
    v_mfma_f32_32x32x16_bf16 v[20:35], v[176:179], v[144:147], v[20:35]
    v_pk_mul_f32 v[12:13], v[12:13], v[44:45]
    v_pk_mul_f32 v[14:15], v[14:15], v[46:47]
    v_pk_mul_f32 v[16:17], v[16:17], v[48:49]
    v_pk_mul_f32 v[18:19], v[18:19], v[50:51]
    v_cvt_pk_f16_f32 v56, v12, v13
    v_cvt_pk_f16_f32 v57, v14, v15
    v_cvt_pk_f16_f32 v58, v16, v17
    v_cvt_pk_f16_f32 v59, v18, v19
    buffer_store_dwordx4 v[56:59], v182, s[8:11], s31 offen offset:1024 sc0 sc1
    s_nop 2
    v_pk_add_f32 v[20:21], v[20:21], v[84:85]
    v_pk_add_f32 v[22:23], v[22:23], v[86:87]
    v_pk_add_f32 v[24:25], v[24:25], v[88:89]
    v_pk_add_f32 v[26:27], v[26:27], v[90:91]
    s_mov_b64 exec, s[36:37]
    v_mov_b32 v24, 0
    v_mov_b32 v25, 0
    v_mov_b32 v26, 0
    v_mov_b32 v27, 0
    s_mov_b64 exec, -1
    v_pk_mul_f32 v[36:37], v[20:21], v[20:21]
    v_pk_mul_f32 v[38:39], v[22:23], v[22:23]
    v_pk_mul_f32 v[40:41], v[24:25], v[24:25]
    v_pk_mul_f32 v[42:43], v[26:27], v[26:27]
    v_pk_fma_f32 v[36:37], v[36:37], v[212:213], v[210:211]
    v_pk_fma_f32 v[38:39], v[38:39], v[212:213], v[210:211]
    v_pk_fma_f32 v[40:41], v[40:41], v[212:213], v[210:211]
    v_pk_fma_f32 v[42:43], v[42:43], v[212:213], v[210:211]
    v_pk_mul_f32 v[36:37], v[36:37], v[20:21]
    v_pk_mul_f32 v[38:39], v[38:39], v[22:23]
    v_pk_mul_f32 v[40:41], v[40:41], v[24:25]
    v_pk_mul_f32 v[42:43], v[42:43], v[26:27]
    v_exp_f32 v36, v36
    v_exp_f32 v37, v37
    v_exp_f32 v38, v38
    v_exp_f32 v39, v39
    v_exp_f32 v40, v40
    v_exp_f32 v41, v41
    v_exp_f32 v42, v42
    v_exp_f32 v43, v43
    v_pk_fma_f32 v[36:37], v[36:37], v[208:209], v[208:209]
    v_pk_fma_f32 v[38:39], v[38:39], v[208:209], v[208:209]
    v_pk_fma_f32 v[40:41], v[40:41], v[208:209], v[208:209]
    v_pk_fma_f32 v[42:43], v[42:43], v[208:209], v[208:209]
    v_rcp_f32 v36, v36
    v_rcp_f32 v37, v37
    v_rcp_f32 v38, v38
    v_rcp_f32 v39, v39
    v_rcp_f32 v40, v40
    v_rcp_f32 v41, v41
    v_rcp_f32 v42, v42
    v_rcp_f32 v43, v43
    v_pk_mul_f32 v[20:21], v[20:21], v[36:37]
    v_pk_mul_f32 v[22:23], v[22:23], v[38:39]
    v_pk_mul_f32 v[24:25], v[24:25], v[40:41]
    v_pk_mul_f32 v[26:27], v[26:27], v[42:43]
    v_cvt_pk_f16_f32 v60, v20, v21
    v_cvt_pk_f16_f32 v61, v22, v23
    v_cvt_pk_f16_f32 v62, v24, v25
    v_cvt_pk_f16_f32 v63, v26, v27
    buffer_store_dwordx4 v[60:63], v182, s[8:11], s31 offen offset:2048 sc0 sc1
    s_cmp_eq_u32 s18, 0
    s_cbranch_scc1 L_u3_173
    v_mov_b32 v28, 0
    v_mov_b32 v29, 0
    v_mov_b32 v30, 0
    v_mov_b32 v31, 0
    v_mov_b32 v32, 0
    v_mov_b32 v33, 0
    v_mov_b32 v34, 0
    v_mov_b32 v35, 0
    s_branch L_u4_174
L_u3_173:
    v_pk_add_f32 v[28:29], v[28:29], v[92:93]
    v_pk_add_f32 v[30:31], v[30:31], v[94:95]
    v_pk_add_f32 v[32:33], v[32:33], v[96:97]
    v_pk_add_f32 v[34:35], v[34:35], v[98:99]
    v_pk_mul_f32 v[44:45], v[28:29], v[28:29]
    v_pk_mul_f32 v[46:47], v[30:31], v[30:31]
    v_pk_mul_f32 v[48:49], v[32:33], v[32:33]
    v_pk_mul_f32 v[50:51], v[34:35], v[34:35]
    v_pk_fma_f32 v[44:45], v[44:45], v[212:213], v[210:211]
    v_pk_fma_f32 v[46:47], v[46:47], v[212:213], v[210:211]
    v_pk_fma_f32 v[48:49], v[48:49], v[212:213], v[210:211]
    v_pk_fma_f32 v[50:51], v[50:51], v[212:213], v[210:211]
    v_pk_mul_f32 v[44:45], v[44:45], v[28:29]
    v_pk_mul_f32 v[46:47], v[46:47], v[30:31]
    v_pk_mul_f32 v[48:49], v[48:49], v[32:33]
    v_pk_mul_f32 v[50:51], v[50:51], v[34:35]
    v_exp_f32 v44, v44
    v_exp_f32 v45, v45
    v_exp_f32 v46, v46
    v_exp_f32 v47, v47
    v_exp_f32 v48, v48
    v_exp_f32 v49, v49
    v_exp_f32 v50, v50
    v_exp_f32 v51, v51
    v_pk_fma_f32 v[44:45], v[44:45], v[208:209], v[208:209]
    v_pk_fma_f32 v[46:47], v[46:47], v[208:209], v[208:209]
    v_pk_fma_f32 v[48:49], v[48:49], v[208:209], v[208:209]
    v_pk_fma_f32 v[50:51], v[50:51], v[208:209], v[208:209]
    v_rcp_f32 v44, v44
    v_rcp_f32 v45, v45
    v_rcp_f32 v46, v46
    v_rcp_f32 v47, v47
    v_rcp_f32 v48, v48
    v_rcp_f32 v49, v49
    v_rcp_f32 v50, v50
    v_rcp_f32 v51, v51
    v_pk_mul_f32 v[28:29], v[28:29], v[44:45]
    v_pk_mul_f32 v[30:31], v[30:31], v[46:47]
    v_pk_mul_f32 v[32:33], v[32:33], v[48:49]
    v_pk_mul_f32 v[34:35], v[34:35], v[50:51]
    v_cvt_pk_f16_f32 v64, v28, v29
    v_cvt_pk_f16_f32 v65, v30, v31
    v_cvt_pk_f16_f32 v66, v32, v33
    v_cvt_pk_f16_f32 v67, v34, v35
    buffer_store_dwordx4 v[64:67], v182, s[8:11], s31 offen offset:3072 sc0 sc1
L_u4_174:
    s_cmp_lt_u32 s25, 8
    s_cbranch_scc1 L_nostat_175
    v_pk_add_f32 v[216:217], v[4:5], v[6:7]
    v_pk_mul_f32 v[218:219], v[4:5], v[4:5]
    v_pk_fma_f32 v[218:219], v[6:7], v[6:7], v[218:219]
    v_pk_add_f32 v[216:217], v[216:217], v[8:9]
    v_pk_fma_f32 v[218:219], v[8:9], v[8:9], v[218:219]
    v_pk_add_f32 v[216:217], v[216:217], v[10:11]
    v_pk_fma_f32 v[218:219], v[10:11], v[10:11], v[218:219]
    v_pk_add_f32 v[216:217], v[216:217], v[12:13]
    v_pk_fma_f32 v[218:219], v[12:13], v[12:13], v[218:219]
    v_pk_add_f32 v[216:217], v[216:217], v[14:15]
    v_pk_fma_f32 v[218:219], v[14:15], v[14:15], v[218:219]
    v_pk_add_f32 v[216:217], v[216:217], v[16:17]
    v_pk_fma_f32 v[218:219], v[16:17], v[16:17], v[218:219]
    v_pk_add_f32 v[216:217], v[216:217], v[18:19]
    v_pk_fma_f32 v[218:219], v[18:19], v[18:19], v[218:219]
    v_pk_add_f32 v[216:217], v[216:217], v[20:21]
    v_pk_fma_f32 v[218:219], v[20:21], v[20:21], v[218:219]
    v_pk_add_f32 v[216:217], v[216:217], v[22:23]
    v_pk_fma_f32 v[218:219], v[22:23], v[22:23], v[218:219]
    v_pk_add_f32 v[216:217], v[216:217], v[24:25]
    v_pk_fma_f32 v[218:219], v[24:25], v[24:25], v[218:219]
    v_pk_add_f32 v[216:217], v[216:217], v[26:27]
    v_pk_fma_f32 v[218:219], v[26:27], v[26:27], v[218:219]
    v_pk_add_f32 v[216:217], v[216:217], v[28:29]
    v_pk_fma_f32 v[218:219], v[28:29], v[28:29], v[218:219]
    v_pk_add_f32 v[216:217], v[216:217], v[30:31]
    v_pk_fma_f32 v[218:219], v[30:31], v[30:31], v[218:219]
    v_pk_add_f32 v[216:217], v[216:217], v[32:33]
    v_pk_fma_f32 v[218:219], v[32:33], v[32:33], v[218:219]
    v_pk_add_f32 v[216:217], v[216:217], v[34:35]
    v_pk_fma_f32 v[218:219], v[34:35], v[34:35], v[218:219]
    v_add_f32 v216, v216, v217
    v_add_f32 v218, v218, v219
    s_nop 1
    v_permlane32_swap_b32 v216, v218
    v_add_f32 v216, v216, v218
    v_lshrrev_b32 v205, 1, v205
    v_bfe_u32 v204, v0, 5, 1
    v_lshl_add_u32 v205, v204, 13, v205
    buffer_atomic_add_f32 v216, v205, s[8:11], s33 offen sc1
L_nostat_175:
    s_load_dwordx2 s[12:13], s[0:1], 48
    s_mov_b32 s14, 0x1000
    s_mov_b32 s15, 0x20000
    s_load_dwordx2 s[44:45], s[0:1], 80
    s_mov_b32 s46, 0x280000
    s_mov_b32 s47, 0x20000
    v_and_b32 v5, 63, v0
    v_lshlrev_b32 v1, 12, v5
    v_mov_b32 v2, 1
    s_lshr_b32 s58, s2, 3
    s_lshl_b32 s58, s58, 7
    s_add_u32 s58, s58, 0x70040
    s_waitcnt vmcnt(0)
    s_barrier
    s_cmp_lg_u32 s16, 0
    s_cbranch_scc1 L_nosig_176
    s_mov_b64 exec, 0xff
    buffer_atomic_add v2, v1, s[8:11], s58 offen sc1
    s_mov_b64 exec, -1
L_nosig_176:
    s_and_b32 s30, s2, 7
    s_lshr_b32 s27, s2, 3
    s_lshr_b32 s28, s30, 1
    s_lshl_b32 s28, s28, 3
    s_and_b32 s29, s27, 7
    s_add_u32 s24, s28, s29
    s_and_b32 s28, s30, 1
    s_lshl_b32 s28, s28, 2
    s_lshr_b32 s29, s27, 3
    s_add_u32 s25, s28, s29
    v_and_b32 v5, 63, v0
    v_lshlrev_b32 v6, 4, v5
    s_mov_b32 s30, 4
    s_mov_b32 s26, 0
    s_mov_b32 s23, 92160
    s_and_b32 s18, s24, 1
    s_mul_i32 s17, s18, 18
    s_cmp_ge_u32 s16, 4
    s_cbranch_scc1 L_loader_177
    s_setprio 3
    v_lshlrev_b32 v246, 5, v0
    s_mov_b32 s56, 0x40000
    s_mov_b32 s57, 0x42000
    v_mov_b32 v195, v246
    v_add_u32 v240, 122880, v246
    v_and_b32 v1, 14, v5
    v_lshlrev_b32 v237, 5, v1
    v_lshrrev_b32 v1, 5, v5
    v_lshl_add_u32 v237, v1, 5, v237
    v_and_b32 v2, 1, v5
    v_lshl_add_u32 v237, v2, 4, v237
    v_add_u32 v237, 122880, v237
    s_lshl_b32 s31, s17, 8
    v_add_u32 v238, 3584, v237
    v_add_u32 v237, s31, v237
    s_and_b32 s31, s25, 3
    s_lshl_b32 s34, s24, 2
    s_add_u32 s34, s34, s31
    s_xor_b32 s31, s34, 4
    s_mul_i32 s62, s34, 14336
    s_mul_i32 s61, s31, 14336
    s_cmp_ge_u32 s25, 4
    s_cselect_b32 s31, 0x300000, 0
    s_add_u32 s31, s31, 0x100000
    s_mov_b32 s64, 0
    s_lshl_b32 s34, s16, 12
    s_add_u32 s31, s31, s34
    s_add_u32 s61, s61, s31
    s_add_u32 s62, s62, s31
    s_cmp_eq_u32 s16, 3
    s_cselect_b32 s63, 0, 2048
    s_add_u32 s63, s63, s62
    s_mul_i32 s34, s24, 114688
    s_mul_i32 s31, s25, 7168
    s_add_u32 s32, s34, s31
    s_lshl_b32 s31, s16, 11
    s_add_u32 s32, s32, s31
    s_add_u32 s32, s32, 0x1500000
    s_add_u32 s36, s32, 57344
    s_lshl_b32 s33, s24, 7
    v_lshl_add_u32 v234, v2, 6, s31
    v_bfe_u32 v4, v5, 1, 1
    v_lshl_add_u32 v234, v4, 3, v234
    v_bfe_u32 v4, v5, 2, 2
    v_lshl_add_u32 v234, v4, 4, v234
    v_bfe_u32 v3, v5, 4, 1
    v_lshl_add_u32 v234, v1, 8, v234
    v_lshl_add_u32 v234, v3, 10, v234
    v_lshl_add_u32 v234, v3, 7, v234
    v_add_u32 v234, 92160, v234
    v_xor_b32 v235, 128, v234
    v_add_u32 v236, 106496, v6
    v_mov_b64 v[40:41], 0
    v_mov_b64 v[42:43], 0
    v_mov_b64 v[44:45], 0
    v_mov_b64 v[46:47], 0
    v_mov_b64 v[48:49], 0
    v_mov_b64 v[50:51], 0
    v_mov_b64 v[52:53], 0
    v_mov_b64 v[54:55], 0
    v_mov_b64 v[56:57], 0
    v_mov_b64 v[58:59], 0
    v_mov_b64 v[60:61], 0
    v_mov_b64 v[62:63], 0
    v_mov_b64 v[64:65], 0
    v_mov_b64 v[66:67], 0
    v_mov_b64 v[68:69], 0
    v_mov_b64 v[70:71], 0
    v_mov_b64 v[88:89], 0
    v_mov_b64 v[90:91], 0
    v_mov_b64 v[92:93], 0
    v_mov_b64 v[94:95], 0
    v_mov_b64 v[228:229], 0
    v_mov_b64 v[230:231], 0
    v_mov_b64 v[80:81], 0
    v_mov_b64 v[82:83], 0
    v_mov_b64 v[128:129], 0
    v_mov_b64 v[130:131], 0
    v_mov_b64 v[132:133], 0
    v_mov_b64 v[134:135], 0
    v_mov_b64 v[136:137], 0
    v_mov_b64 v[138:139], 0
    v_mov_b64 v[140:141], 0
    v_mov_b64 v[142:143], 0
    v_mov_b64 v[84:85], 0
    v_mov_b64 v[86:87], 0
    v_mov_b64 v[144:145], 0
    v_mov_b64 v[146:147], 0
    v_mov_b64 v[148:149], 0
    v_mov_b64 v[150:151], 0
    v_mov_b64 v[152:153], 0
    v_mov_b64 v[154:155], 0
    v_mov_b64 v[156:157], 0
    v_mov_b64 v[158:159], 0
    v_mov_b32 v232, 0x3727c5ac
    v_mov_b32 v233, 0x3727c5ac
    v_mul_u32_u24 v244, 28672, v3
    v_lshl_add_u32 v244, v1, 8, v244
    v_and_b32 v4, 15, v5
    v_lshl_add_u32 v244, v4, 4, v244
    v_and_b32 v246, 31, v5
    v_lshlrev_b32 v246, 1, v246
    v_lshlrev_b32 v247, 7, v5
    s_lshr_b32 s29, s25, 1
    s_mul_i32 s29, s29, 7168
    s_add_u32 s28, s34, s29
    s_add_u32 s28, s28, 0x680000
    s_and_b32 s29, s25, 1
    s_lshr_b32 s31, s31, 1
    s_add_u32 s31, s31, s28
    s_mul_i32 s34, s29, 3072
    s_add_u32 s31, s31, s34
    s_lshl_b32 s29, s29, 9
    s_add_u32 s29, s29, s28
    s_add_u32 s29, s29, 6144
    s_cmp_eq_u32 s16, 3
    s_cselect_b32 s31, s29, s31
    s_add_u32 s29, s31, 57344
    s_mov_b32 s39, 0x3c800000
    s_mov_b32 s40, 0x3a97b426
    s_mov_b32 s41, 0x3a97b426
    s_mov_b32 s42, -92160
    s_mov_b32 s43, 30720
    s_bfe_u32 s28, s2, 0x20003
    s_lshl_b32 s28, s28, 2
    s_add_u32 s28, s28, s16
    s_lshl_b32 s28, s28, 13
    s_lshr_b32 s37, s2, 5
    s_mul_i32 s37, s37, 139264
    s_add_u32 s37, s37, s28
    s_add_u32 s37, s37, 0x2100000
    v_lshlrev_b32 v193, 7, v5
    v_min_u32 v193, 0xf80, v193
    s_and_b32 s59, s2, 7
    s_lshl_b32 s59, s59, 12
    s_add_u32 s59, s59, 0x70040
    s_mov_b32 s60, 0
    s_waitcnt lgkmcnt(0)
    buffer_load_ushort v242, v246, s[12:15], s33 offen offset:0
    buffer_load_ushort v243, v246, s[12:15], s33 offen offset:64
    s_waitcnt vmcnt(1)
    v_lshlrev_b32 v242, 16, v242
    v_mul_f32 v8, 0x42800000, v242
    v_mov_b32 v9, v8
    v_mov_b64 v[10:11], v[8:9]
    v_mov_b64 v[12:13], v[8:9]
    v_mov_b64 v[14:15], v[8:9]
    v_mov_b64 v[16:17], v[8:9]
    v_mov_b64 v[18:19], v[8:9]
    v_mov_b64 v[20:21], v[8:9]
    v_mov_b64 v[22:23], v[8:9]
    s_waitcnt vmcnt(0)
    v_lshlrev_b32 v243, 16, v243
    v_mul_f32 v24, 0x42800000, v243
    v_mov_b32 v25, v24
    v_mov_b64 v[26:27], v[24:25]
    v_mov_b64 v[28:29], v[24:25]
    v_mov_b64 v[30:31], v[24:25]
    v_mov_b64 v[32:33], v[24:25]
    v_mov_b64 v[34:35], v[24:25]
    v_mov_b64 v[36:37], v[24:25]
    v_mov_b64 v[38:39], v[24:25]
    s_cmp_lg_u32 s16, 0
    s_cbranch_scc1 L_ok_179
    s_sleep 8
L_poll_178:
    s_add_u32 s60, s60, 1
    s_cmp_gt_u32 s60, 3000
    s_cbranch_scc1 L_ok_179
    s_sleep 1
    buffer_load_dword v194, v193, s[8:11], s59 offen sc1
    s_waitcnt vmcnt(0)
    v_cmp_gt_u32 vcc, 8, v194
    s_cbranch_vccnz L_poll_178
L_ok_179:
    s_barrier
    buffer_load_dwordx4 v[160:163], v195, s[8:11], s56 offen offset:0
    buffer_load_dwordx4 v[168:171], v195, s[8:11], s57 offen offset:0
    buffer_load_dwordx4 v[164:167], v195, s[8:11], s56 offen offset:16
    buffer_load_dwordx4 v[172:175], v195, s[8:11], s57 offen offset:16
    s_waitcnt vmcnt(3)
    v_pk_mul_f32 v[160:161], v[160:161], s[40:41]
    v_pk_mul_f32 v[162:163], v[162:163], s[40:41]
    s_waitcnt vmcnt(2)
    v_pk_fma_f32 v[168:169], v[168:169], s[40:41], v[232:233]
    v_pk_fma_f32 v[170:171], v[170:171], s[40:41], v[232:233]
    v_pk_fma_f32 v[168:169], v[160:161], v[160:161], v[168:169] neg_lo:[1,0,0] neg_hi:[1,0,0]
    v_pk_fma_f32 v[170:171], v[162:163], v[162:163], v[170:171] neg_lo:[1,0,0] neg_hi:[1,0,0]
    v_max_f32 v168, v232, v168
    v_max_f32 v169, v232, v169
    v_max_f32 v170, v232, v170
    v_max_f32 v171, v232, v171
    v_rsq_f32 v168, v168
    v_rsq_f32 v169, v169
    v_rsq_f32 v170, v170
    v_rsq_f32 v171, v171
    v_pk_mul_f32 v[160:161], v[160:161], v[168:169] neg_lo:[1,0] neg_hi:[1,0]
    v_pk_mul_f32 v[162:163], v[162:163], v[170:171] neg_lo:[1,0] neg_hi:[1,0]
    v_cvt_pk_f16_f32 v192, v168, v169
    v_cvt_pk_f16_f32 v194, v160, v161
    v_cvt_pk_f16_f32 v193, v170, v171
    v_cvt_pk_f16_f32 v195, v162, v163
    ds_write_b128 v240, v[192:195] offset:0
    s_waitcnt vmcnt(1)
    v_pk_mul_f32 v[164:165], v[164:165], s[40:41]
    v_pk_mul_f32 v[166:167], v[166:167], s[40:41]
    s_waitcnt vmcnt(0)
    v_pk_fma_f32 v[172:173], v[172:173], s[40:41], v[232:233]
    v_pk_fma_f32 v[174:175], v[174:175], s[40:41], v[232:233]
    v_pk_fma_f32 v[172:173], v[164:165], v[164:165], v[172:173] neg_lo:[1,0,0] neg_hi:[1,0,0]
    v_pk_fma_f32 v[174:175], v[166:167], v[166:167], v[174:175] neg_lo:[1,0,0] neg_hi:[1,0,0]
    v_max_f32 v172, v232, v172
    v_max_f32 v173, v232, v173
    v_max_f32 v174, v232, v174
    v_max_f32 v175, v232, v175
    v_rsq_f32 v172, v172
    v_rsq_f32 v173, v173
    v_rsq_f32 v174, v174
    v_rsq_f32 v175, v175
    v_pk_mul_f32 v[164:165], v[164:165], v[172:173] neg_lo:[1,0] neg_hi:[1,0]
    v_pk_mul_f32 v[166:167], v[166:167], v[174:175] neg_lo:[1,0] neg_hi:[1,0]
    v_cvt_pk_f16_f32 v196, v172, v173
    v_cvt_pk_f16_f32 v198, v164, v165
    v_cvt_pk_f16_f32 v197, v174, v175
    v_cvt_pk_f16_f32 v199, v166, v167
    ds_write_b128 v240, v[196:199] offset:16
    s_setprio 0
    s_waitcnt lgkmcnt(0)
L_cloop_180:
    s_barrier
    ds_read_b128 v[224:227], v237
    v_mfma_f32_32x32x16_f16 v[8:23], v[88:91], v[128:131], v[8:23]
    ds_read_b64_tr_b16 v[72:73], v234 offset:0
    ds_read_b64_tr_b16 v[74:75], v235 offset:0
    v_mov_b64_dpp v[92:93], v[230:231] row_newbcast:6 row_mask:0xf bank_mask:0xf
    v_mov_b64_dpp v[94:95], v[230:231] row_newbcast:7 row_mask:0xf bank_mask:0xf
    v_mfma_f32_32x32x16_f16 v[24:39], v[88:91], v[132:135], v[24:39]
    ds_read_b128 v[96:99], v236 offset:0
    ds_read_b128 v[100:103], v236 offset:4096
    v_pk_fmac_f16_dpp v92, v228, v84 row_newbcast:6 row_mask:0xf bank_mask:0xf
    v_pk_fmac_f16_dpp v93, v229, v85 row_newbcast:6 row_mask:0xf bank_mask:0xf
    v_mfma_f32_32x32x16_f16 v[40:55], v[88:91], v[136:139], v[40:55]
    ds_read_b128 v[104:107], v236 offset:8192
    ds_read_b128 v[108:111], v236 offset:12288
    v_pk_fmac_f16_dpp v94, v228, v86 row_newbcast:7 row_mask:0xf bank_mask:0xf
    v_pk_fmac_f16_dpp v95, v229, v87 row_newbcast:7 row_mask:0xf bank_mask:0xf
    v_mfma_f32_32x32x16_f16 v[56:71], v[88:91], v[140:143], v[56:71]
    ds_read_b64_tr_b16 v[76:77], v234 offset:512
    ds_read_b64_tr_b16 v[78:79], v235 offset:512
    v_add_u32 v237, 256, v237
    s_cmp_eq_u32 s23, 92160
    s_cselect_b32 s35, s42, s43
    s_add_u32 s23, s23, s35
    s_waitcnt lgkmcnt(8)
    v_mov_b64 v[228:229], v[224:225]
    v_mov_b64 v[230:231], v[226:227]
    v_mfma_f32_32x32x16_f16 v[8:23], v[92:95], v[144:147], v[8:23]
    ds_read_b128 v[112:115], v236 offset:1024
    ds_read_b128 v[116:119], v236 offset:5120
    v_mov_b64_dpp v[88:89], v[230:231] row_newbcast:0 row_mask:0xf bank_mask:0xf
    v_mov_b64_dpp v[90:91], v[230:231] row_newbcast:1 row_mask:0xf bank_mask:0xf
    v_mfma_f32_32x32x16_f16 v[24:39], v[92:95], v[148:151], v[24:39]
    ds_read_b128 v[120:123], v236 offset:9216
    ds_read_b128 v[124:127], v236 offset:13312
    s_waitcnt lgkmcnt(10)
    v_pk_fmac_f16_dpp v88, v228, v72 row_newbcast:0 row_mask:0xf bank_mask:0xf
    v_pk_fmac_f16_dpp v89, v229, v73 row_newbcast:0 row_mask:0xf bank_mask:0xf
    v_mfma_f32_32x32x16_f16 v[40:55], v[92:95], v[152:155], v[40:55]
    ds_read_b64_tr_b16 v[80:81], v234 offset:7168
    ds_read_b64_tr_b16 v[82:83], v235 offset:7168
    v_pk_fmac_f16_dpp v90, v228, v74 row_newbcast:1 row_mask:0xf bank_mask:0xf
    v_pk_fmac_f16_dpp v91, v229, v75 row_newbcast:1 row_mask:0xf bank_mask:0xf
    v_mfma_f32_32x32x16_f16 v[56:71], v[92:95], v[156:159], v[56:71]
    ds_read_b128 v[128:131], v236 offset:2048
    ds_read_b128 v[132:135], v236 offset:6144
    s_waitcnt lgkmcnt(13)
    v_mfma_f32_32x32x16_f16 v[8:23], v[88:91], v[96:99], v[8:23]
    ds_read_b128 v[136:139], v236 offset:10240
    ds_read_b128 v[140:143], v236 offset:14336
    v_mov_b64_dpp v[92:93], v[230:231] row_newbcast:2 row_mask:0xf bank_mask:0xf
    v_mov_b64_dpp v[94:95], v[230:231] row_newbcast:3 row_mask:0xf bank_mask:0xf
    s_waitcnt lgkmcnt(14)
    v_mfma_f32_32x32x16_f16 v[24:39], v[88:91], v[100:103], v[24:39]
    ds_read_b64_tr_b16 v[84:85], v234 offset:7680
    ds_read_b64_tr_b16 v[86:87], v235 offset:7680
    s_waitcnt lgkmcnt(12)
    v_pk_fmac_f16_dpp v92, v228, v76 row_newbcast:2 row_mask:0xf bank_mask:0xf
    v_pk_fmac_f16_dpp v93, v229, v77 row_newbcast:2 row_mask:0xf bank_mask:0xf
    v_mfma_f32_32x32x16_f16 v[40:55], v[88:91], v[104:107], v[40:55]
    ds_read_b128 v[144:147], v236 offset:3072
    ds_read_b128 v[148:151], v236 offset:7168
    v_pk_fmac_f16_dpp v94, v228, v78 row_newbcast:3 row_mask:0xf bank_mask:0xf
    v_pk_fmac_f16_dpp v95, v229, v79 row_newbcast:3 row_mask:0xf bank_mask:0xf
    v_mfma_f32_32x32x16_f16 v[56:71], v[88:91], v[108:111], v[56:71]
    ds_read_b128 v[152:155], v236 offset:11264
    ds_read_b128 v[156:159], v236 offset:15360
    v_add_u32 v234, s35, v234
    v_add_u32 v235, s35, v235
    v_add_u32 v236, s35, v236
    s_add_u32 s26, s26, 1
    s_waitcnt lgkmcnt(15)
    v_mfma_f32_32x32x16_f16 v[8:23], v[92:95], v[112:115], v[8:23]
    v_mov_b64_dpp v[88:89], v[230:231] row_newbcast:4 row_mask:0xf bank_mask:0xf
    v_mov_b64_dpp v[90:91], v[230:231] row_newbcast:5 row_mask:0xf bank_mask:0xf
    s_waitcnt lgkmcnt(14)
    v_mfma_f32_32x32x16_f16 v[24:39], v[92:95], v[116:119], v[24:39]
    s_waitcnt lgkmcnt(10)
    v_pk_fmac_f16_dpp v88, v228, v80 row_newbcast:4 row_mask:0xf bank_mask:0xf
    v_pk_fmac_f16_dpp v89, v229, v81 row_newbcast:4 row_mask:0xf bank_mask:0xf
    v_mfma_f32_32x32x16_f16 v[40:55], v[92:95], v[120:123], v[40:55]
    v_pk_fmac_f16_dpp v90, v228, v82 row_newbcast:5 row_mask:0xf bank_mask:0xf
    v_pk_fmac_f16_dpp v91, v229, v83 row_newbcast:5 row_mask:0xf bank_mask:0xf
    v_mfma_f32_32x32x16_f16 v[56:71], v[92:95], v[124:127], v[56:71]
    s_cmp_lg_u32 s26, s30
    s_waitcnt lgkmcnt(0)
    s_cbranch_scc1 L_cloop_180
    s_cmp_lg_u32 s30, 14
    s_cbranch_scc1 L_zld_182
    s_mov_b32 s30, 17
    s_barrier
    ds_read_b128 v[224:227], v238
    ds_read_b64_tr_b16 v[72:73], v234 offset:0
    ds_read_b64_tr_b16 v[74:75], v235 offset:0
    ds_read_b128 v[96:99], v236 offset:0
    ds_read_b128 v[100:103], v236 offset:4096
    v_mfma_f32_32x32x16_f16 v[40:55], v[88:91], v[136:139], v[40:55]
    ds_read_b64_tr_b16 v[76:77], v234 offset:512
    ds_read_b64_tr_b16 v[78:79], v235 offset:512
    ds_read_b128 v[112:115], v236 offset:1024
    ds_read_b128 v[116:119], v236 offset:5120
    v_mov_b64_dpp v[92:93], v[230:231] row_newbcast:6 row_mask:0xf bank_mask:0xf
    v_mov_b64_dpp v[94:95], v[230:231] row_newbcast:7 row_mask:0xf bank_mask:0xf
    v_mfma_f32_32x32x16_f16 v[56:71], v[88:91], v[140:143], v[56:71]
    v_mfma_f32_32x32x16_f16 v[8:23], v[88:91], v[128:131], v[8:23]
    v_pk_fmac_f16_dpp v92, v228, v84 row_newbcast:6 row_mask:0xf bank_mask:0xf
    v_pk_fmac_f16_dpp v93, v229, v85 row_newbcast:6 row_mask:0xf bank_mask:0xf
    v_pk_fmac_f16_dpp v94, v228, v86 row_newbcast:7 row_mask:0xf bank_mask:0xf
    v_pk_fmac_f16_dpp v95, v229, v87 row_newbcast:7 row_mask:0xf bank_mask:0xf
    v_mfma_f32_32x32x16_f16 v[24:39], v[88:91], v[132:135], v[24:39]
    ds_read_b64_tr_b16 v[80:81], v234 offset:7168
    ds_read_b64_tr_b16 v[82:83], v235 offset:7168
    ds_read_b128 v[128:131], v236 offset:2048
    ds_read_b128 v[132:135], v236 offset:6144
    s_waitcnt lgkmcnt(12)
    v_mov_b64 v[228:229], v[224:225]
    v_mov_b64 v[230:231], v[226:227]
    s_nop 1
    v_mov_b64_dpp v[88:89], v[230:231] row_newbcast:0 row_mask:0xf bank_mask:0xf
    v_mov_b64_dpp v[90:91], v[230:231] row_newbcast:1 row_mask:0xf bank_mask:0xf
    s_cmp_eq_u32 s23, 92160
    s_cselect_b32 s35, s42, s43
    s_add_u32 s23, s23, s35
    v_add_u32 v238, 256, v238
    v_mfma_f32_32x32x16_f16 v[40:55], v[92:95], v[152:155], v[40:55]
    ds_read_b64_tr_b16 v[84:85], v234 offset:7680
    ds_read_b64_tr_b16 v[86:87], v235 offset:7680
    v_mfma_f32_32x32x16_f16 v[56:71], v[92:95], v[156:159], v[56:71]
    v_mfma_f32_32x32x16_f16 v[8:23], v[92:95], v[144:147], v[8:23]
    s_waitcnt lgkmcnt(12)
    v_pk_fmac_f16_dpp v88, v228, v72 row_newbcast:0 row_mask:0xf bank_mask:0xf
    v_pk_fmac_f16_dpp v89, v229, v73 row_newbcast:0 row_mask:0xf bank_mask:0xf
    v_pk_fmac_f16_dpp v90, v228, v74 row_newbcast:1 row_mask:0xf bank_mask:0xf
    v_pk_fmac_f16_dpp v91, v229, v75 row_newbcast:1 row_mask:0xf bank_mask:0xf
    v_mfma_f32_32x32x16_f16 v[24:39], v[92:95], v[148:151], v[24:39]
    ds_read_b128 v[144:147], v236 offset:3072
    ds_read_b128 v[148:151], v236 offset:7168
    v_mov_b64_dpp v[92:93], v[230:231] row_newbcast:2 row_mask:0xf bank_mask:0xf
    v_mov_b64_dpp v[94:95], v[230:231] row_newbcast:3 row_mask:0xf bank_mask:0xf
    v_add_u32 v234, s35, v234
    v_add_u32 v235, s35, v235
    v_add_u32 v236, s35, v236
    s_add_u32 s26, s26, 1
    s_waitcnt lgkmcnt(13)
    v_mfma_f32_32x32x16_f16 v[8:23], v[88:91], v[96:99], v[8:23]
    s_waitcnt lgkmcnt(10)
    v_pk_fmac_f16_dpp v92, v228, v76 row_newbcast:2 row_mask:0xf bank_mask:0xf
    v_pk_fmac_f16_dpp v93, v229, v77 row_newbcast:2 row_mask:0xf bank_mask:0xf
    v_pk_fmac_f16_dpp v94, v228, v78 row_newbcast:3 row_mask:0xf bank_mask:0xf
    v_pk_fmac_f16_dpp v95, v229, v79 row_newbcast:3 row_mask:0xf bank_mask:0xf
    v_mfma_f32_32x32x16_f16 v[24:39], v[88:91], v[100:103], v[24:39]
    v_mov_b64_dpp v[88:89], v[230:231] row_newbcast:4 row_mask:0xf bank_mask:0xf
    v_mov_b64_dpp v[90:91], v[230:231] row_newbcast:5 row_mask:0xf bank_mask:0xf
    v_cvt_pk_f16_f32 v40, v40, v41
    v_cvt_pk_f16_f32 v41, v42, v43
    v_cvt_pk_f16_f32 v42, v44, v45
    v_cvt_pk_f16_f32 v43, v46, v47
    v_and_b32 v40, -2, v40
    buffer_store_dwordx4 v[40:43], v6, s[8:11], s61 offen offset:0 sc0 sc1
    v_cvt_pk_f16_f32 v56, v56, v57
    v_cvt_pk_f16_f32 v57, v58, v59
    v_cvt_pk_f16_f32 v58, v60, v61
    v_cvt_pk_f16_f32 v59, v62, v63
    v_and_b32 v56, -2, v56
    buffer_store_dwordx4 v[56:59], v6, s[8:11], s61 offen offset:1024 sc0 sc1
    s_waitcnt lgkmcnt(9)
    v_mfma_f32_32x32x16_f16 v[8:23], v[92:95], v[112:115], v[8:23]
    s_waitcnt lgkmcnt(6)
    v_pk_fmac_f16_dpp v88, v228, v80 row_newbcast:4 row_mask:0xf bank_mask:0xf
    v_pk_fmac_f16_dpp v89, v229, v81 row_newbcast:4 row_mask:0xf bank_mask:0xf
    v_pk_fmac_f16_dpp v90, v228, v82 row_newbcast:5 row_mask:0xf bank_mask:0xf
    v_pk_fmac_f16_dpp v91, v229, v83 row_newbcast:5 row_mask:0xf bank_mask:0xf
    v_mfma_f32_32x32x16_f16 v[24:39], v[92:95], v[116:119], v[24:39]
    s_cmp_eq_u32 s16, 3
    s_cbranch_scc1 L_nos_186
    v_cvt_pk_f16_f32 v48, v48, v49
    v_cvt_pk_f16_f32 v49, v50, v51
    v_cvt_pk_f16_f32 v50, v52, v53
    v_cvt_pk_f16_f32 v51, v54, v55
    v_and_b32 v48, -2, v48
    buffer_store_dwordx4 v[48:51], v6, s[8:11], s61 offen offset:2048 sc0 sc1
    v_cvt_pk_f16_f32 v64, v64, v65
    v_cvt_pk_f16_f32 v65, v66, v67
    v_cvt_pk_f16_f32 v66, v68, v69
    v_cvt_pk_f16_f32 v67, v70, v71
    v_and_b32 v64, -2, v64
    buffer_store_dwordx4 v[64:67], v6, s[8:11], s61 offen offset:3072 sc0 sc1
L_nos_186:
    s_waitcnt lgkmcnt(0)
L_tloop_183:
    s_barrier
    ds_read_b128 v[224:227], v238
    ds_read_b64_tr_b16 v[72:73], v234 offset:0
    ds_read_b64_tr_b16 v[74:75], v235 offset:0
    ds_read_b128 v[96:99], v236 offset:0
    ds_read_b128 v[100:103], v236 offset:4096
    v_mfma_f32_32x32x16_f16 v[8:23], v[88:91], v[128:131], v[8:23]
    ds_read_b64_tr_b16 v[76:77], v234 offset:512
    ds_read_b64_tr_b16 v[78:79], v235 offset:512
    ds_read_b128 v[112:115], v236 offset:1024
    ds_read_b128 v[116:119], v236 offset:5120
    v_mov_b64_dpp v[92:93], v[230:231] row_newbcast:6 row_mask:0xf bank_mask:0xf
    v_mov_b64_dpp v[94:95], v[230:231] row_newbcast:7 row_mask:0xf bank_mask:0xf
    s_nop 0
    v_pk_fmac_f16_dpp v92, v228, v84 row_newbcast:6 row_mask:0xf bank_mask:0xf
    v_pk_fmac_f16_dpp v93, v229, v85 row_newbcast:6 row_mask:0xf bank_mask:0xf
    v_pk_fmac_f16_dpp v94, v228, v86 row_newbcast:7 row_mask:0xf bank_mask:0xf
    v_pk_fmac_f16_dpp v95, v229, v87 row_newbcast:7 row_mask:0xf bank_mask:0xf
    v_mfma_f32_32x32x16_f16 v[24:39], v[88:91], v[132:135], v[24:39]
    ds_read_b64_tr_b16 v[80:81], v234 offset:7168
    ds_read_b64_tr_b16 v[82:83], v235 offset:7168
    ds_read_b128 v[128:131], v236 offset:2048
    ds_read_b128 v[132:135], v236 offset:6144
    s_waitcnt lgkmcnt(12)
    v_mov_b64 v[228:229], v[224:225]
    v_mov_b64 v[230:231], v[226:227]
    s_nop 1
    v_mov_b64_dpp v[88:89], v[230:231] row_newbcast:0 row_mask:0xf bank_mask:0xf
    v_mov_b64_dpp v[90:91], v[230:231] row_newbcast:1 row_mask:0xf bank_mask:0xf
    s_cmp_eq_u32 s23, 92160
    s_cselect_b32 s35, s42, s43
    s_add_u32 s23, s23, s35
    v_add_u32 v238, 256, v238
    v_mfma_f32_32x32x16_f16 v[8:23], v[92:95], v[144:147], v[8:23]
    ds_read_b64_tr_b16 v[84:85], v234 offset:7680
    ds_read_b64_tr_b16 v[86:87], v235 offset:7680
    s_waitcnt lgkmcnt(12)
    v_pk_fmac_f16_dpp v88, v228, v72 row_newbcast:0 row_mask:0xf bank_mask:0xf
    v_pk_fmac_f16_dpp v89, v229, v73 row_newbcast:0 row_mask:0xf bank_mask:0xf
    v_pk_fmac_f16_dpp v90, v228, v74 row_newbcast:1 row_mask:0xf bank_mask:0xf
    v_pk_fmac_f16_dpp v91, v229, v75 row_newbcast:1 row_mask:0xf bank_mask:0xf
    v_mfma_f32_32x32x16_f16 v[24:39], v[92:95], v[148:151], v[24:39]
    ds_read_b128 v[144:147], v236 offset:3072
    ds_read_b128 v[148:151], v236 offset:7168
    v_mov_b64_dpp v[92:93], v[230:231] row_newbcast:2 row_mask:0xf bank_mask:0xf
    v_mov_b64_dpp v[94:95], v[230:231] row_newbcast:3 row_mask:0xf bank_mask:0xf
    v_add_u32 v234, s35, v234
    v_add_u32 v235, s35, v235
    v_add_u32 v236, s35, v236
    s_add_u32 s26, s26, 1
    s_waitcnt lgkmcnt(13)
    v_mfma_f32_32x32x16_f16 v[8:23], v[88:91], v[96:99], v[8:23]
    s_waitcnt lgkmcnt(10)
    v_pk_fmac_f16_dpp v92, v228, v76 row_newbcast:2 row_mask:0xf bank_mask:0xf
    v_pk_fmac_f16_dpp v93, v229, v77 row_newbcast:2 row_mask:0xf bank_mask:0xf
    v_pk_fmac_f16_dpp v94, v228, v78 row_newbcast:3 row_mask:0xf bank_mask:0xf
    v_pk_fmac_f16_dpp v95, v229, v79 row_newbcast:3 row_mask:0xf bank_mask:0xf
    v_mfma_f32_32x32x16_f16 v[24:39], v[88:91], v[100:103], v[24:39]
    v_mov_b64_dpp v[88:89], v[230:231] row_newbcast:4 row_mask:0xf bank_mask:0xf
    v_mov_b64_dpp v[90:91], v[230:231] row_newbcast:5 row_mask:0xf bank_mask:0xf
    s_waitcnt lgkmcnt(9)
    v_mfma_f32_32x32x16_f16 v[8:23], v[92:95], v[112:115], v[8:23]
    s_waitcnt lgkmcnt(6)
    v_pk_fmac_f16_dpp v88, v228, v80 row_newbcast:4 row_mask:0xf bank_mask:0xf
    v_pk_fmac_f16_dpp v89, v229, v81 row_newbcast:4 row_mask:0xf bank_mask:0xf
    v_pk_fmac_f16_dpp v90, v228, v82 row_newbcast:5 row_mask:0xf bank_mask:0xf
    v_pk_fmac_f16_dpp v91, v229, v83 row_newbcast:5 row_mask:0xf bank_mask:0xf
    v_mfma_f32_32x32x16_f16 v[24:39], v[92:95], v[116:119], v[24:39]
    s_cmp_lg_u32 s26, s30
    s_waitcnt lgkmcnt(0)
    s_cbranch_scc1 L_tloop_183
    s_cmp_lg_u32 s30, 18
    s_cbranch_scc1 L_rcv_184
    s_setprio 3
    v_mfma_f32_32x32x16_f16 v[8:23], v[88:91], v[128:131], v[8:23]
    v_mov_b64_dpp v[92:93], v[230:231] row_newbcast:6 row_mask:0xf bank_mask:0xf
    v_mov_b64_dpp v[94:95], v[230:231] row_newbcast:7 row_mask:0xf bank_mask:0xf
    s_nop 0
    v_pk_fmac_f16_dpp v92, v228, v84 row_newbcast:6 row_mask:0xf bank_mask:0xf
    v_pk_fmac_f16_dpp v93, v229, v85 row_newbcast:6 row_mask:0xf bank_mask:0xf
    v_pk_fmac_f16_dpp v94, v228, v86 row_newbcast:7 row_mask:0xf bank_mask:0xf
    v_pk_fmac_f16_dpp v95, v229, v87 row_newbcast:7 row_mask:0xf bank_mask:0xf
    v_mfma_f32_32x32x16_f16 v[24:39], v[88:91], v[132:135], v[24:39]
    s_nop 0
    v_mfma_f32_32x32x16_f16 v[8:23], v[92:95], v[144:147], v[8:23]
    v_mfma_f32_32x32x16_f16 v[24:39], v[92:95], v[148:151], v[24:39]
    s_waitcnt vmcnt(0)
L_chk_187:
    v_or3_b32 v1, v44, v52, v60
    v_bitop3_b32 v1, v1, v68, 1 bitop3:0xa8
    v_cmp_ne_u32 vcc, 0, v1
    s_cbranch_vccnz L_stub_188
L_ok_189:
    v_fma_mix_f32 v192, v44, v176, 0 op_sel:[0,0,0] op_sel_hi:[1,1,0]
    v_fma_mix_f32 v193, v44, v176, 0 op_sel:[1,1,0] op_sel_hi:[1,1,0]
    v_fma_mix_f32 v194, v45, v177, 0 op_sel:[0,0,0] op_sel_hi:[1,1,0]
    v_fma_mix_f32 v195, v45, v177, 0 op_sel:[1,1,0] op_sel_hi:[1,1,0]
    v_fma_mix_f32 v196, v46, v178, 0 op_sel:[0,0,0] op_sel_hi:[1,1,0]
    v_fma_mix_f32 v197, v46, v178, 0 op_sel:[1,1,0] op_sel_hi:[1,1,0]
    v_fma_mix_f32 v198, v47, v179, 0 op_sel:[0,0,0] op_sel_hi:[1,1,0]
    v_fma_mix_f32 v199, v47, v179, 0 op_sel:[1,1,0] op_sel_hi:[1,1,0]
    v_fma_mix_f32 v200, v52, v180, 0 op_sel:[0,0,0] op_sel_hi:[1,1,0]
    v_fma_mix_f32 v201, v52, v180, 0 op_sel:[1,1,0] op_sel_hi:[1,1,0]
    v_fma_mix_f32 v202, v53, v181, 0 op_sel:[0,0,0] op_sel_hi:[1,1,0]
    v_fma_mix_f32 v203, v53, v181, 0 op_sel:[1,1,0] op_sel_hi:[1,1,0]
    v_fma_mix_f32 v204, v54, v182, 0 op_sel:[0,0,0] op_sel_hi:[1,1,0]
    v_fma_mix_f32 v205, v54, v182, 0 op_sel:[1,1,0] op_sel_hi:[1,1,0]
    v_fma_mix_f32 v206, v55, v183, 0 op_sel:[0,0,0] op_sel_hi:[1,1,0]
    v_fma_mix_f32 v207, v55, v183, 0 op_sel:[1,1,0] op_sel_hi:[1,1,0]
    v_fma_mix_f32 v208, v60, v184, 0 op_sel:[0,0,0] op_sel_hi:[1,1,0]
    v_fma_mix_f32 v209, v60, v184, 0 op_sel:[1,1,0] op_sel_hi:[1,1,0]
    v_fma_mix_f32 v210, v61, v185, 0 op_sel:[0,0,0] op_sel_hi:[1,1,0]
    v_fma_mix_f32 v211, v61, v185, 0 op_sel:[1,1,0] op_sel_hi:[1,1,0]
    v_fma_mix_f32 v212, v62, v186, 0 op_sel:[0,0,0] op_sel_hi:[1,1,0]
    v_fma_mix_f32 v213, v62, v186, 0 op_sel:[1,1,0] op_sel_hi:[1,1,0]
    v_fma_mix_f32 v214, v63, v187, 0 op_sel:[0,0,0] op_sel_hi:[1,1,0]
    v_fma_mix_f32 v215, v63, v187, 0 op_sel:[1,1,0] op_sel_hi:[1,1,0]
    v_fma_mix_f32 v216, v68, v188, 0 op_sel:[0,0,0] op_sel_hi:[1,1,0]
    v_fma_mix_f32 v217, v68, v188, 0 op_sel:[1,1,0] op_sel_hi:[1,1,0]
    v_fma_mix_f32 v218, v69, v189, 0 op_sel:[0,0,0] op_sel_hi:[1,1,0]
    v_fma_mix_f32 v219, v69, v189, 0 op_sel:[1,1,0] op_sel_hi:[1,1,0]
    v_fma_mix_f32 v220, v70, v190, 0 op_sel:[0,0,0] op_sel_hi:[1,1,0]
    v_fma_mix_f32 v221, v70, v190, 0 op_sel:[1,1,0] op_sel_hi:[1,1,0]
    v_fma_mix_f32 v222, v71, v191, 0 op_sel:[0,0,0] op_sel_hi:[1,1,0]
    v_fma_mix_f32 v223, v71, v191, 0 op_sel:[1,1,0] op_sel_hi:[1,1,0]
    v_fma_mix_f32 v8, v176, v8, v192 op_sel:[0,0,0] op_sel_hi:[1,0,0]
    v_fma_mix_f32 v9, v176, v9, v193 op_sel:[1,0,0] op_sel_hi:[1,0,0]
    v_fma_mix_f32 v10, v177, v10, v194 op_sel:[0,0,0] op_sel_hi:[1,0,0]
    v_fma_mix_f32 v11, v177, v11, v195 op_sel:[1,0,0] op_sel_hi:[1,0,0]
    v_fma_mix_f32 v12, v178, v12, v196 op_sel:[0,0,0] op_sel_hi:[1,0,0]
    v_fma_mix_f32 v13, v178, v13, v197 op_sel:[1,0,0] op_sel_hi:[1,0,0]
    v_fma_mix_f32 v14, v179, v14, v198 op_sel:[0,0,0] op_sel_hi:[1,0,0]
    v_fma_mix_f32 v15, v179, v15, v199 op_sel:[1,0,0] op_sel_hi:[1,0,0]
    v_and_b32 v8, 0xffff0000, v8
    v_cvt_pk_bf16_f32 v8, v8, v9
    v_or_b32 v8, 1, v8
    v_cvt_pk_bf16_f32 v9, v10, v11
    v_cvt_pk_bf16_f32 v10, v12, v13
    v_cvt_pk_bf16_f32 v11, v14, v15
    buffer_store_dwordx4 v[8:11], v244, s[8:11], s31 offen offset:0 sc0 sc1
    s_cmp_eq_u32 s16, 3
    s_cbranch_scc1 L_nou_190
    v_fma_mix_f32 v16, v180, v16, v200 op_sel:[0,0,0] op_sel_hi:[1,0,0]
    v_fma_mix_f32 v17, v180, v17, v201 op_sel:[1,0,0] op_sel_hi:[1,0,0]
    v_fma_mix_f32 v18, v181, v18, v202 op_sel:[0,0,0] op_sel_hi:[1,0,0]
    v_fma_mix_f32 v19, v181, v19, v203 op_sel:[1,0,0] op_sel_hi:[1,0,0]
    v_fma_mix_f32 v20, v182, v20, v204 op_sel:[0,0,0] op_sel_hi:[1,0,0]
    v_fma_mix_f32 v21, v182, v21, v205 op_sel:[1,0,0] op_sel_hi:[1,0,0]
    v_fma_mix_f32 v22, v183, v22, v206 op_sel:[0,0,0] op_sel_hi:[1,0,0]
    v_fma_mix_f32 v23, v183, v23, v207 op_sel:[1,0,0] op_sel_hi:[1,0,0]
    v_and_b32 v16, 0xffff0000, v16
    v_cvt_pk_bf16_f32 v16, v16, v17
    v_or_b32 v16, 1, v16
    v_cvt_pk_bf16_f32 v17, v18, v19
    v_cvt_pk_bf16_f32 v18, v20, v21
    v_cvt_pk_bf16_f32 v19, v22, v23
    buffer_store_dwordx4 v[16:19], v244, s[8:11], s31 offen offset:512 sc0 sc1
L_nou_190:
    v_fma_mix_f32 v24, v184, v24, v208 op_sel:[0,0,0] op_sel_hi:[1,0,0]
    v_fma_mix_f32 v25, v184, v25, v209 op_sel:[1,0,0] op_sel_hi:[1,0,0]
    v_fma_mix_f32 v26, v185, v26, v210 op_sel:[0,0,0] op_sel_hi:[1,0,0]
    v_fma_mix_f32 v27, v185, v27, v211 op_sel:[1,0,0] op_sel_hi:[1,0,0]
    v_fma_mix_f32 v28, v186, v28, v212 op_sel:[0,0,0] op_sel_hi:[1,0,0]
    v_fma_mix_f32 v29, v186, v29, v213 op_sel:[1,0,0] op_sel_hi:[1,0,0]
    v_fma_mix_f32 v30, v187, v30, v214 op_sel:[0,0,0] op_sel_hi:[1,0,0]
    v_fma_mix_f32 v31, v187, v31, v215 op_sel:[1,0,0] op_sel_hi:[1,0,0]
    v_and_b32 v24, 0xffff0000, v24
    v_cvt_pk_bf16_f32 v24, v24, v25
    v_or_b32 v24, 1, v24
    v_cvt_pk_bf16_f32 v25, v26, v27
    v_cvt_pk_bf16_f32 v26, v28, v29
    v_cvt_pk_bf16_f32 v27, v30, v31
    buffer_store_dwordx4 v[24:27], v244, s[8:11], s29 offen offset:0 sc0 sc1
    s_cmp_eq_u32 s16, 3
    s_cbranch_scc1 L_nou_191
    v_fma_mix_f32 v32, v188, v32, v216 op_sel:[0,0,0] op_sel_hi:[1,0,0]
    v_fma_mix_f32 v33, v188, v33, v217 op_sel:[1,0,0] op_sel_hi:[1,0,0]
    v_fma_mix_f32 v34, v189, v34, v218 op_sel:[0,0,0] op_sel_hi:[1,0,0]
    v_fma_mix_f32 v35, v189, v35, v219 op_sel:[1,0,0] op_sel_hi:[1,0,0]
    v_fma_mix_f32 v36, v190, v36, v220 op_sel:[0,0,0] op_sel_hi:[1,0,0]
    v_fma_mix_f32 v37, v190, v37, v221 op_sel:[1,0,0] op_sel_hi:[1,0,0]
    v_fma_mix_f32 v38, v191, v38, v222 op_sel:[0,0,0] op_sel_hi:[1,0,0]
    v_fma_mix_f32 v39, v191, v39, v223 op_sel:[1,0,0] op_sel_hi:[1,0,0]
    v_and_b32 v32, 0xffff0000, v32
    v_cvt_pk_bf16_f32 v32, v32, v33
    v_or_b32 v32, 1, v32
    v_cvt_pk_bf16_f32 v33, v34, v35
    v_cvt_pk_bf16_f32 v34, v36, v37
    v_cvt_pk_bf16_f32 v35, v38, v39
    buffer_store_dwordx4 v[32:35], v244, s[8:11], s29 offen offset:512 sc0 sc1
L_nou_191:
    s_barrier
    s_waitcnt vmcnt(0)
    s_endpgm
L_rcv_184:
    s_mov_b32 s30, 18
    buffer_load_dwordx4 v[44:47], v6, s[8:11], s62 offen offset:0 sc1
    buffer_load_dwordx4 v[60:63], v6, s[8:11], s62 offen offset:1024 sc1
    buffer_load_dwordx4 v[52:55], v6, s[8:11], s63 offen offset:0 sc1
    buffer_load_dwordx4 v[68:71], v6, s[8:11], s63 offen offset:1024 sc1
    s_branch L_tloop_183
L_zld_182:
    s_mov_b32 s30, 14
    buffer_load_dwordx4 v[176:179], v6, s[8:11], s32 offen offset:0
    buffer_load_dwordx4 v[180:183], v6, s[8:11], s32 offen offset:1024
    buffer_load_dwordx4 v[184:187], v6, s[8:11], s36 offen offset:0
    buffer_load_dwordx4 v[188:191], v6, s[8:11], s36 offen offset:1024
    s_branch L_cloop_180
L_loader_177:
    s_setprio 3
    s_sub_u32 s16, s16, 4
    s_lshr_b32 s28, s16, 1
    s_and_b32 s29, s16, 1
    s_mul_i32 s19, s28, 57344
    s_mul_i32 s22, s28, 7168
    s_mul_i32 s31, s25, 7168
    s_add_u32 s19, s19, s31
    s_add_u32 s19, s19, 0x1900000
    s_lshl_b32 s31, s29, 12
    s_add_u32 s19, s19, s31
    s_add_u32 s22, s22, s31
    s_lshl_b32 s53, s28, 11
    s_lshl_b32 s52, s24, 18
    s_add_u32 s52, s52, s53
    s_add_u32 s53, s53, s31
    s_add_u32 s53, s53, 14336
    s_lshl_b32 s31, s29, 13
    s_add_u32 s31, s31, 0x2800000
    s_add_u32 s52, s52, s31
    s_xor_b32 s21, s24, s28
    s_lshl_b32 s21, s21, 18
    s_add_u32 s21, s21, s31
    s_lshl_b32 s27, s16, 12
    s_add_u32 s27, s27, 14336
    v_bfe_u32 v3, v5, 2, 1
    v_lshlrev_b32 v248, 9, v3
    v_and_b32 v3, 3, v5
    v_lshl_add_u32 v248, v3, 4, v248
    v_lshrrev_b32 v4, 3, v5
    v_lshl_add_u32 v248, v4, 6, v248
    v_xor_b32 v249, 64, v248
    s_waitcnt lgkmcnt(0)
    v_lshlrev_b32 v160, 7, v5
    v_min_u32 v160, 0xf80, v160
    s_mov_b32 s56, 0x7a000
    buffer_load_dword v161, v160, s[8:11], s56 offen sc1
    s_and_b32 s28, s2, 7
    s_lshl_b32 s28, s28, 2
    s_bfe_u32 s24, s2, 0x20003
    s_add_u32 s24, s24, s28
    s_lshr_b32 s25, s2, 5
    s_lshl_b32 s32, s24, 2
    s_add_u32 s32, s32, s16
    s_mul_i32 s28, s25, 160
    s_mul_i32 s33, s32, 20480
    s_add_u32 s33, s33, s28
    s_and_b32 s48, s16, 1
    s_mul_i32 s28, s48, 14336
    s_add_u32 s28, s28, 0x680000
    s_mul_i32 s34, s32, 28672
    s_add_u32 s34, s34, s28
    s_xor_b32 s43, s32, 1
    s_mul_i32 s43, s43, 28672
    s_add_u32 s43, s43, s28
    s_mul_i32 s35, s25, 320
    s_add_u32 s35, s35, 0x13200
    s_lshr_b32 s36, s32, 1
    s_mul_i32 s36, s36, 40960
    s_and_b32 s28, s32, 1
    s_lshl_b32 s28, s28, 8
    s_add_u32 s36, s36, s28
    s_mul_i32 s28, s25, 5120
    s_add_u32 s36, s36, s28
    s_add_u32 s36, s36, 0xf00000
    s_add_u32 s37, s36, 4096
    s_lshl_b32 s39, s16, 10
    s_mul_i32 s38, s25, 139264
    s_add_u32 s38, s38, s39
    s_add_u32 s38, s38, 0x2100000
    s_add_u32 s39, s39, 24576
    s_mov_b32 s40, 0
    v_and_b32 v1, 15, v0
    v_bfe_u32 v2, v0, 4, 2
    v_lshlrev_b32 v243, 4, v2
    v_lshlrev_b32 v244, 4, v1
    v_lshl_add_u32 v245, v2, 3, v244
    v_lshl_add_u32 v244, v2, 9, v244
    v_bfe_u32 v3, v0, 5, 1
    v_mul_u32_u24 v3, 496, v3
    v_add_u32 v245, v245, v3
    s_xor_b32 s28, s16, 1
    s_mul_i32 s28, s28, 5120
    v_add_u32 v246, s28, v6
    s_mul_i32 s28, s16, 5120
    v_add_u32 v247, s28, v6
    v_mul_u32_u24 v236, 176, v1
    v_lshl_add_u32 v236, v2, 3, v236
    v_add_u32 v236, s28, v236
    s_movk_i32 s29, 1120
    v_add_u32 v2, 0, v5
    v_mul_u32_u24 v3, 6554, v2
    v_lshrrev_b32 v3, 16, v3
    v_lshlrev_b32 v2, 4, v2
    v_lshl_add_u32 v237, v3, 4, v2
    v_add_u32 v237, s28, v237
    v_mad_u32_u24 v240, v3, s29, v2
    v_add_u32 v2, 64, v5
    v_mul_u32_u24 v3, 6554, v2
    v_lshrrev_b32 v3, 16, v3
    v_lshlrev_b32 v2, 4, v2
    v_lshl_add_u32 v238, v3, 4, v2
    v_add_u32 v238, s28, v238
    v_mad_u32_u24 v241, v3, s29, v2
    v_add_u32 v2, 128, v5
    v_min_u32 v2, 159, v2
    v_mul_u32_u24 v3, 6554, v2
    v_lshrrev_b32 v3, 16, v3
    v_lshlrev_b32 v2, 4, v2
    v_lshl_add_u32 v239, v3, 4, v2
    v_add_u32 v239, s28, v239
    v_mad_u32_u24 v242, v3, s29, v2
    v_bfe_u32 v1, v0, 2, 2
    v_mul_u32_u24 v1, 160, v1
    v_and_b32 v2, 3, v0
    v_lshl_add_u32 v1, v2, 3, v1
    s_mul_i32 s29, s48, 69120
    s_add_u32 s29, s29, 24576
    v_add_u32 v1, s29, v1
    v_bfe_u32 v2, v0, 4, 1
    v_bfe_u32 v3, v0, 5, 1
    s_movk_i32 s29, 640
    v_mad_u32_u24 v232, v2, s29, v1
    s_movk_i32 s29, 2560
    v_mad_u32_u24 v232, v3, s29, v232
    v_add_u32 v233, 64000, v232
    s_movk_i32 s29, 640
    v_mad_u32_u24 v234, v2, s29, v1
    s_movk_i32 s29, 17280
    v_mad_u32_u24 v234, v3, s29, v234
    v_add_u32 v235, 64000, v234
    s_add_u32 s28, s39, 0
    v_add_u32 v164, s28, v6
    s_add_u32 s28, s39, 65536
    v_add_u32 v165, s28, v6
    s_waitcnt vmcnt(0) lgkmcnt(0)
    v_cmp_gt_u32 vcc, 8, v161
    s_cbranch_vccnz L_late_192
    s_add_u32 s57, s17, 0
    s_lshr_b32 s55, s57, 1
    s_lshl_b32 s55, s55, 14
    s_add_u32 s55, s55, s21
    s_bitcmp1_b32 s57, 0
    s_cselect_b32 s54, 4096, 0
    s_add_u32 s55, s55, s54
    s_add_u32 m0, s27, 92160
    s_nop 0
    buffer_load_dwordx4 v6, s[8:11], s55 offen offset:0 lds
    buffer_load_dwordx4 v6, s[8:11], s55 offen offset:1024 lds
    buffer_load_dwordx4 v6, s[8:11], s55 offen offset:2048 lds
    buffer_load_dwordx4 v6, s[8:11], s55 offen offset:3072 lds
    s_add_u32 s57, s17, 1
    s_lshr_b32 s55, s57, 1
    s_lshl_b32 s55, s55, 14
    s_add_u32 s55, s55, s21
    s_bitcmp1_b32 s57, 0
    s_cselect_b32 s54, 4096, 0
    s_add_u32 s55, s55, s54
    s_add_u32 m0, s27, 0
    s_nop 0
    buffer_load_dwordx4 v6, s[8:11], s55 offen offset:0 lds
    buffer_load_dwordx4 v6, s[8:11], s55 offen offset:1024 lds
    buffer_load_dwordx4 v6, s[8:11], s55 offen offset:2048 lds
    buffer_load_dwordx4 v6, s[8:11], s55 offen offset:3072 lds
    s_add_u32 s57, s17, 2
    s_lshr_b32 s55, s57, 1
    s_lshl_b32 s55, s55, 14
    s_add_u32 s55, s55, s21
    s_bitcmp1_b32 s57, 0
    s_cselect_b32 s54, 4096, 0
    s_add_u32 s55, s55, s54
    s_add_u32 m0, s27, 30720
    s_nop 0
    buffer_load_dwordx4 v6, s[8:11], s55 offen offset:0 lds
    buffer_load_dwordx4 v6, s[8:11], s55 offen offset:1024 lds
    buffer_load_dwordx4 v6, s[8:11], s55 offen offset:2048 lds
    buffer_load_dwordx4 v6, s[8:11], s55 offen offset:3072 lds
    s_add_u32 s57, s17, 3
    s_lshr_b32 s55, s57, 1
    s_lshl_b32 s55, s55, 14
    s_add_u32 s55, s55, s21
    s_bitcmp1_b32 s57, 0
    s_cselect_b32 s54, 4096, 0
    s_add_u32 s55, s55, s54
    s_add_u32 m0, s27, 61440
    s_nop 0
    buffer_load_dwordx4 v6, s[8:11], s55 offen offset:0 lds
    buffer_load_dwordx4 v6, s[8:11], s55 offen offset:1024 lds
    buffer_load_dwordx4 v6, s[8:11], s55 offen offset:2048 lds
    buffer_load_dwordx4 v6, s[8:11], s55 offen offset:3072 lds
    s_add_u32 s28, s38, 98304
    buffer_load_dwordx4 v[8:11], v6, s[8:11], s28 offen
    s_add_u32 s28, s38, 102400
    buffer_load_dwordx4 v[12:15], v6, s[8:11], s28 offen
    s_add_u32 s28, s38, 65536
    buffer_load_dwordx4 v[16:19], v6, s[8:11], s28 offen
    s_add_u32 s28, s38, 69632
    buffer_load_dwordx4 v[20:23], v6, s[8:11], s28 offen
    s_add_u32 s28, s38, 73728
    buffer_load_dwordx4 v[24:27], v6, s[8:11], s28 offen
    s_add_u32 s28, s38, 77824
    buffer_load_dwordx4 v[28:31], v6, s[8:11], s28 offen
    s_add_u32 s28, s38, 81920
    buffer_load_dwordx4 v[32:35], v6, s[8:11], s28 offen
    s_add_u32 s28, s38, 86016
    buffer_load_dwordx4 v[36:39], v6, s[8:11], s28 offen
L_late_192:
    s_barrier
    s_cbranch_vccz L_late2_193
    s_add_u32 s57, s17, 0
    s_lshr_b32 s55, s57, 1
    s_lshl_b32 s55, s55, 14
    s_add_u32 s55, s55, s21
    s_bitcmp1_b32 s57, 0
    s_cselect_b32 s54, 4096, 0
    s_add_u32 s55, s55, s54
    s_add_u32 m0, s27, 92160
    s_nop 0
    buffer_load_dwordx4 v6, s[8:11], s55 offen offset:0 lds
    buffer_load_dwordx4 v6, s[8:11], s55 offen offset:1024 lds
    buffer_load_dwordx4 v6, s[8:11], s55 offen offset:2048 lds
    buffer_load_dwordx4 v6, s[8:11], s55 offen offset:3072 lds
    s_add_u32 s57, s17, 1
    s_lshr_b32 s55, s57, 1
    s_lshl_b32 s55, s55, 14
    s_add_u32 s55, s55, s21
    s_bitcmp1_b32 s57, 0
    s_cselect_b32 s54, 4096, 0
    s_add_u32 s55, s55, s54
    s_add_u32 m0, s27, 0
    s_nop 0
    buffer_load_dwordx4 v6, s[8:11], s55 offen offset:0 lds
    buffer_load_dwordx4 v6, s[8:11], s55 offen offset:1024 lds
    buffer_load_dwordx4 v6, s[8:11], s55 offen offset:2048 lds
    buffer_load_dwordx4 v6, s[8:11], s55 offen offset:3072 lds
    s_add_u32 s57, s17, 2
    s_lshr_b32 s55, s57, 1
    s_lshl_b32 s55, s55, 14
    s_add_u32 s55, s55, s21
    s_bitcmp1_b32 s57, 0
    s_cselect_b32 s54, 4096, 0
    s_add_u32 s55, s55, s54
    s_add_u32 m0, s27, 30720
    s_nop 0
    buffer_load_dwordx4 v6, s[8:11], s55 offen offset:0 lds
    buffer_load_dwordx4 v6, s[8:11], s55 offen offset:1024 lds
    buffer_load_dwordx4 v6, s[8:11], s55 offen offset:2048 lds
    buffer_load_dwordx4 v6, s[8:11], s55 offen offset:3072 lds
    s_add_u32 s57, s17, 3
    s_lshr_b32 s55, s57, 1
    s_lshl_b32 s55, s55, 14
    s_add_u32 s55, s55, s21
    s_bitcmp1_b32 s57, 0
    s_cselect_b32 s54, 4096, 0
    s_add_u32 s55, s55, s54
    s_add_u32 m0, s27, 61440
    s_nop 0
    buffer_load_dwordx4 v6, s[8:11], s55 offen offset:0 lds
    buffer_load_dwordx4 v6, s[8:11], s55 offen offset:1024 lds
    buffer_load_dwordx4 v6, s[8:11], s55 offen offset:2048 lds
    buffer_load_dwordx4 v6, s[8:11], s55 offen offset:3072 lds
    s_add_u32 s28, s38, 98304
    buffer_load_dwordx4 v[8:11], v6, s[8:11], s28 offen
    s_add_u32 s28, s38, 102400
    buffer_load_dwordx4 v[12:15], v6, s[8:11], s28 offen
    s_add_u32 s28, s38, 65536
    buffer_load_dwordx4 v[16:19], v6, s[8:11], s28 offen
    s_add_u32 s28, s38, 69632
    buffer_load_dwordx4 v[20:23], v6, s[8:11], s28 offen
    s_add_u32 s28, s38, 73728
    buffer_load_dwordx4 v[24:27], v6, s[8:11], s28 offen
    s_add_u32 s28, s38, 77824
    buffer_load_dwordx4 v[28:31], v6, s[8:11], s28 offen
    s_add_u32 s28, s38, 81920
    buffer_load_dwordx4 v[32:35], v6, s[8:11], s28 offen
    s_add_u32 s28, s38, 86016
    buffer_load_dwordx4 v[36:39], v6, s[8:11], s28 offen
L_late2_193:
    s_bitcmp1_b32 s16, 0
    s_cbranch_scc1 L_odd_194
    s_mul_i32 s54, s17, 114688
    s_add_u32 s54, s54, s19
    s_add_u32 m0, s22, s23
    s_nop 0
    buffer_load_dwordx4 v248, s[8:11], s54 offen offset:0 lds
    buffer_load_dwordx4 v249, s[8:11], s54 offen offset:1024 lds
    buffer_load_dwordx4 v248, s[8:11], s54 offen offset:2048 lds
    buffer_load_dwordx4 v249, s[8:11], s54 offen offset:3072 lds
    s_add_u32 s17, s17, 1
    s_add_u32 s23, s23, 30720
    s_cmp_eq_u32 s23, 122880
    s_cselect_b32 s23, 0, s23
    s_mul_i32 s54, s17, 114688
    s_add_u32 s54, s54, s19
    s_add_u32 m0, s22, s23
    s_nop 0
    buffer_load_dwordx4 v248, s[8:11], s54 offen offset:0 lds
    buffer_load_dwordx4 v249, s[8:11], s54 offen offset:1024 lds
    buffer_load_dwordx4 v248, s[8:11], s54 offen offset:2048 lds
    buffer_load_dwordx4 v249, s[8:11], s54 offen offset:3072 lds
    s_add_u32 s17, s17, 1
    s_add_u32 s23, s23, 30720
    s_cmp_eq_u32 s23, 122880
    s_cselect_b32 s23, 0, s23
    s_mul_i32 s54, s17, 114688
    s_add_u32 s54, s54, s19
    s_add_u32 m0, s22, s23
    s_nop 0
    buffer_load_dwordx4 v248, s[8:11], s54 offen offset:0 lds
    buffer_load_dwordx4 v249, s[8:11], s54 offen offset:1024 lds
    buffer_load_dwordx4 v248, s[8:11], s54 offen offset:2048 lds
    buffer_load_dwordx4 v249, s[8:11], s54 offen offset:3072 lds
    s_add_u32 s17, s17, 1
    s_add_u32 s23, s23, 30720
    s_cmp_eq_u32 s23, 122880
    s_cselect_b32 s23, 0, s23
    s_waitcnt vmcnt(8)
    s_barrier
    s_mul_i32 s54, s17, 114688
    s_add_u32 s54, s54, s19
    s_add_u32 m0, s22, s23
    s_nop 0
    buffer_load_dwordx4 v248, s[8:11], s54 offen offset:0 lds
    buffer_load_dwordx4 v249, s[8:11], s54 offen offset:1024 lds
    buffer_load_dwordx4 v248, s[8:11], s54 offen offset:2048 lds
    buffer_load_dwordx4 v249, s[8:11], s54 offen offset:3072 lds
    s_add_u32 s17, s17, 1
    s_add_u32 s23, s23, 30720
    s_cmp_eq_u32 s23, 122880
    s_cselect_b32 s23, 0, s23
    s_mov_b32 s56, 0x3c800000
    s_mov_b32 s57, 0x3c800000
    s_add_u32 s58, s38, 106496
    s_add_u32 s59, s39, 106496
    s_add_u32 s60, s39, 135168
    s_waitcnt vmcnt(8)
    s_barrier
    s_lshr_b32 s55, s17, 1
    s_lshl_b32 s55, s55, 14
    s_add_u32 s55, s55, s21
    s_bitcmp1_b32 s17, 0
    s_cselect_b32 s54, 4096, 0
    s_add_u32 s55, s55, s54
    s_add_u32 m0, s27, s23
    s_nop 0
    buffer_load_dwordx4 v6, s[8:11], s55 offen offset:0 lds
    buffer_load_dwordx4 v6, s[8:11], s55 offen offset:1024 lds
    buffer_load_dwordx4 v6, s[8:11], s55 offen offset:2048 lds
    buffer_load_dwordx4 v6, s[8:11], s55 offen offset:3072 lds
    s_mul_i32 s54, s17, 114688
    s_add_u32 s54, s54, s19
    s_add_u32 m0, s22, s23
    s_nop 0
    buffer_load_dwordx4 v248, s[8:11], s54 offen offset:0 lds
    buffer_load_dwordx4 v249, s[8:11], s54 offen offset:1024 lds
    buffer_load_dwordx4 v248, s[8:11], s54 offen offset:2048 lds
    buffer_load_dwordx4 v249, s[8:11], s54 offen offset:3072 lds
    s_add_u32 s17, s17, 1
    s_add_u32 s23, s23, 30720
    s_cmp_eq_u32 s23, 122880
    s_cselect_b32 s23, 0, s23
    buffer_load_dwordx4 v[200:203], v244, s[8:11], s36 offen
    buffer_load_dwordx4 v[204:207], v244, s[8:11], s36 offen offset:2048
    buffer_load_dwordx2 v[208:209], v245, s[8:11], s37 offen
    buffer_load_dwordx4 v[212:215], v243, s[8:11], s35 offen offset:0
    buffer_load_dwordx4 v[216:219], v243, s[8:11], s35 offen offset:64
    buffer_load_dwordx4 v[220:223], v243, s[8:11], s35 offen offset:128
    buffer_load_dwordx4 v[224:227], v243, s[8:11], s35 offen offset:192
    buffer_load_dwordx4 v[228:231], v243, s[8:11], s35 offen offset:256
    s_waitcnt vmcnt(20)
    s_barrier
L_lloop_196:
    s_mov_b32 m0, s59
    s_nop 0
    buffer_load_dwordx4 v6, s[8:11], s58 offen lds
    s_cmp_lt_u32 s59, s60
    s_cselect_b32 s61, 4096, 0
    s_add_u32 s58, s58, s61
    s_add_u32 s59, s59, s61
    s_lshr_b32 s55, s17, 1
    s_lshl_b32 s55, s55, 14
    s_add_u32 s55, s55, s21
    s_bitcmp1_b32 s17, 0
    s_cselect_b32 s54, 4096, 0
    s_add_u32 s55, s55, s54
    s_add_u32 m0, s27, s23
    s_nop 0
    buffer_load_dwordx4 v6, s[8:11], s55 offen offset:0 lds
    buffer_load_dwordx4 v6, s[8:11], s55 offen offset:1024 lds
    buffer_load_dwordx4 v6, s[8:11], s55 offen offset:2048 lds
    buffer_load_dwordx4 v6, s[8:11], s55 offen offset:3072 lds
    s_mul_i32 s54, s17, 114688
    s_add_u32 s54, s54, s19
    s_add_u32 m0, s22, s23
    s_nop 0
    buffer_load_dwordx4 v248, s[8:11], s54 offen offset:0 lds
    buffer_load_dwordx4 v249, s[8:11], s54 offen offset:1024 lds
    buffer_load_dwordx4 v248, s[8:11], s54 offen offset:2048 lds
    buffer_load_dwordx4 v249, s[8:11], s54 offen offset:3072 lds
    s_add_u32 s17, s17, 1
    s_add_u32 s23, s23, 30720
    s_cmp_eq_u32 s23, 122880
    s_cselect_b32 s23, 0, s23
    s_add_u32 s26, s26, 1
    s_cmp_lt_u32 s26, 9
    s_waitcnt vmcnt(17)
    s_barrier
    s_cbranch_scc1 L_lloop_196
    s_mov_b32 s17, 14
L_mloop_197:
    s_lshr_b32 s55, s17, 1
    s_lshl_b32 s55, s55, 14
    s_add_u32 s55, s55, s52
    s_bitcmp1_b32 s17, 0
    s_cselect_b32 s54, 4096, 0
    s_add_u32 s55, s55, s54
    s_add_u32 m0, s53, s23
    s_nop 0
    buffer_load_dwordx4 v6, s[8:11], s55 offen offset:0 lds
    buffer_load_dwordx4 v6, s[8:11], s55 offen offset:1024 lds
    s_mul_i32 s54, s17, 114688
    s_add_u32 s54, s54, s19
    s_add_u32 m0, s22, s23
    s_nop 0
    buffer_load_dwordx4 v248, s[8:11], s54 offen offset:0 lds
    buffer_load_dwordx4 v249, s[8:11], s54 offen offset:1024 lds
    buffer_load_dwordx4 v248, s[8:11], s54 offen offset:2048 lds
    buffer_load_dwordx4 v249, s[8:11], s54 offen offset:3072 lds
    s_add_u32 s17, s17, 1
    s_add_u32 s23, s23, 30720
    s_cmp_eq_u32 s23, 122880
    s_cselect_b32 s23, 0, s23
    s_cmp_lt_u32 s17, 18
    s_waitcnt vmcnt(12)
    s_barrier
    s_cbranch_scc1 L_mloop_197
    s_waitcnt vmcnt(6)
    s_branch L_jn_195
L_odd_194:
    s_mul_i32 s54, s17, 114688
    s_add_u32 s54, s54, s19
    s_add_u32 m0, s22, s23
    s_nop 0
    buffer_load_dwordx4 v248, s[8:11], s54 offen offset:0 lds
    buffer_load_dwordx4 v249, s[8:11], s54 offen offset:1024 lds
    buffer_load_dwordx4 v248, s[8:11], s54 offen offset:2048 lds
    s_add_u32 s17, s17, 1
    s_add_u32 s23, s23, 30720
    s_cmp_eq_u32 s23, 122880
    s_cselect_b32 s23, 0, s23
    s_mul_i32 s54, s17, 114688
    s_add_u32 s54, s54, s19
    s_add_u32 m0, s22, s23
    s_nop 0
    buffer_load_dwordx4 v248, s[8:11], s54 offen offset:0 lds
    buffer_load_dwordx4 v249, s[8:11], s54 offen offset:1024 lds
    buffer_load_dwordx4 v248, s[8:11], s54 offen offset:2048 lds
    s_add_u32 s17, s17, 1
    s_add_u32 s23, s23, 30720
    s_cmp_eq_u32 s23, 122880
    s_cselect_b32 s23, 0, s23
    s_mul_i32 s54, s17, 114688
    s_add_u32 s54, s54, s19
    s_add_u32 m0, s22, s23
    s_nop 0
    buffer_load_dwordx4 v248, s[8:11], s54 offen offset:0 lds
    buffer_load_dwordx4 v249, s[8:11], s54 offen offset:1024 lds
    buffer_load_dwordx4 v248, s[8:11], s54 offen offset:2048 lds
    s_add_u32 s17, s17, 1
    s_add_u32 s23, s23, 30720
    s_cmp_eq_u32 s23, 122880
    s_cselect_b32 s23, 0, s23
    s_waitcnt vmcnt(6)
    s_barrier
    s_mul_i32 s54, s17, 114688
    s_add_u32 s54, s54, s19
    s_add_u32 m0, s22, s23
    s_nop 0
    buffer_load_dwordx4 v248, s[8:11], s54 offen offset:0 lds
    buffer_load_dwordx4 v249, s[8:11], s54 offen offset:1024 lds
    buffer_load_dwordx4 v248, s[8:11], s54 offen offset:2048 lds
    s_add_u32 s17, s17, 1
    s_add_u32 s23, s23, 30720
    s_cmp_eq_u32 s23, 122880
    s_cselect_b32 s23, 0, s23
    s_mov_b32 s56, 0x3c800000
    s_mov_b32 s57, 0x3c800000
    s_add_u32 s58, s38, 106496
    s_add_u32 s59, s39, 106496
    s_add_u32 s60, s39, 135168
    s_waitcnt vmcnt(6)
    s_barrier
    s_lshr_b32 s55, s17, 1
    s_lshl_b32 s55, s55, 14
    s_add_u32 s55, s55, s21
    s_bitcmp1_b32 s17, 0
    s_cselect_b32 s54, 4096, 0
    s_add_u32 s55, s55, s54
    s_add_u32 m0, s27, s23
    s_nop 0
    buffer_load_dwordx4 v6, s[8:11], s55 offen offset:0 lds
    buffer_load_dwordx4 v6, s[8:11], s55 offen offset:1024 lds
    buffer_load_dwordx4 v6, s[8:11], s55 offen offset:2048 lds
    buffer_load_dwordx4 v6, s[8:11], s55 offen offset:3072 lds
    s_mul_i32 s54, s17, 114688
    s_add_u32 s54, s54, s19
    s_add_u32 m0, s22, s23
    s_nop 0
    buffer_load_dwordx4 v248, s[8:11], s54 offen offset:0 lds
    buffer_load_dwordx4 v249, s[8:11], s54 offen offset:1024 lds
    buffer_load_dwordx4 v248, s[8:11], s54 offen offset:2048 lds
    s_add_u32 s17, s17, 1
    s_add_u32 s23, s23, 30720
    s_cmp_eq_u32 s23, 122880
    s_cselect_b32 s23, 0, s23
    buffer_load_dwordx4 v[200:203], v244, s[8:11], s36 offen
    buffer_load_dwordx4 v[204:207], v244, s[8:11], s36 offen offset:2048
    buffer_load_dwordx2 v[208:209], v245, s[8:11], s37 offen
    buffer_load_dwordx4 v[212:215], v243, s[8:11], s35 offen offset:0
    buffer_load_dwordx4 v[216:219], v243, s[8:11], s35 offen offset:64
    buffer_load_dwordx4 v[220:223], v243, s[8:11], s35 offen offset:128
    buffer_load_dwordx4 v[224:227], v243, s[8:11], s35 offen offset:192
    buffer_load_dwordx4 v[228:231], v243, s[8:11], s35 offen offset:256
    s_waitcnt vmcnt(18)
    s_barrier
L_lloop_198:
    s_mov_b32 m0, s59
    s_nop 0
    buffer_load_dwordx4 v6, s[8:11], s58 offen lds
    s_cmp_lt_u32 s59, s60
    s_cselect_b32 s61, 4096, 0
    s_add_u32 s58, s58, s61
    s_add_u32 s59, s59, s61
    s_lshr_b32 s55, s17, 1
    s_lshl_b32 s55, s55, 14
    s_add_u32 s55, s55, s21
    s_bitcmp1_b32 s17, 0
    s_cselect_b32 s54, 4096, 0
    s_add_u32 s55, s55, s54
    s_add_u32 m0, s27, s23
    s_nop 0
    buffer_load_dwordx4 v6, s[8:11], s55 offen offset:0 lds
    buffer_load_dwordx4 v6, s[8:11], s55 offen offset:1024 lds
    buffer_load_dwordx4 v6, s[8:11], s55 offen offset:2048 lds
    buffer_load_dwordx4 v6, s[8:11], s55 offen offset:3072 lds
    s_mul_i32 s54, s17, 114688
    s_add_u32 s54, s54, s19
    s_add_u32 m0, s22, s23
    s_nop 0
    buffer_load_dwordx4 v248, s[8:11], s54 offen offset:0 lds
    buffer_load_dwordx4 v249, s[8:11], s54 offen offset:1024 lds
    buffer_load_dwordx4 v248, s[8:11], s54 offen offset:2048 lds
    s_add_u32 s17, s17, 1
    s_add_u32 s23, s23, 30720
    s_cmp_eq_u32 s23, 122880
    s_cselect_b32 s23, 0, s23
    s_add_u32 s26, s26, 1
    s_cmp_lt_u32 s26, 9
    s_waitcnt vmcnt(15)
    s_barrier
    s_cbranch_scc1 L_lloop_198
    s_mov_b32 s17, 14
L_mloop_199:
    s_lshr_b32 s55, s17, 1
    s_lshl_b32 s55, s55, 14
    s_add_u32 s55, s55, s52
    s_bitcmp1_b32 s17, 0
    s_cselect_b32 s54, 4096, 0
    s_add_u32 s55, s55, s54
    s_add_u32 m0, s53, s23
    s_nop 0
    buffer_load_dwordx4 v6, s[8:11], s55 offen offset:0 lds
    buffer_load_dwordx4 v6, s[8:11], s55 offen offset:1024 lds
    s_mul_i32 s54, s17, 114688
    s_add_u32 s54, s54, s19
    s_add_u32 m0, s22, s23
    s_nop 0
    buffer_load_dwordx4 v248, s[8:11], s54 offen offset:0 lds
    buffer_load_dwordx4 v249, s[8:11], s54 offen offset:1024 lds
    buffer_load_dwordx4 v248, s[8:11], s54 offen offset:2048 lds
    s_add_u32 s17, s17, 1
    s_add_u32 s23, s23, 30720
    s_cmp_eq_u32 s23, 122880
    s_cselect_b32 s23, 0, s23
    s_cmp_lt_u32 s17, 18
    s_waitcnt vmcnt(10)
    s_barrier
    s_cbranch_scc1 L_mloop_199
    s_waitcnt vmcnt(5)
L_jn_195:
    s_add_u32 m0, s39, 28672
    s_add_u32 s28, s38, 28672
    buffer_load_dwordx4 v6, s[8:11], s28 offen lds
    s_add_u32 m0, s39, 32768
    s_add_u32 s28, s38, 32768
    buffer_load_dwordx4 v6, s[8:11], s28 offen lds
    s_add_u32 m0, s39, 61440
    s_add_u32 s28, s38, 61440
    buffer_load_dwordx4 v6, s[8:11], s28 offen lds
    s_add_u32 m0, s39, 90112
    s_add_u32 s28, s38, 90112
    buffer_load_dwordx4 v6, s[8:11], s28 offen lds
    s_barrier
    s_add_u32 m0, s39, 94208
    s_add_u32 s28, s38, 94208
    buffer_load_dwordx4 v6, s[8:11], s28 offen lds
    s_add_u32 m0, s39, 0
    s_add_u32 s28, s38, 0
    buffer_load_dwordx4 v6, s[8:11], s28 offen lds
    s_add_u32 m0, s39, 4096
    s_add_u32 s28, s38, 4096
    buffer_load_dwordx4 v6, s[8:11], s28 offen lds
    s_add_u32 m0, s39, 8192
    s_add_u32 s28, s38, 8192
    buffer_load_dwordx4 v6, s[8:11], s28 offen lds
    s_waitcnt vmcnt(7)
    s_setprio 0
    s_barrier
    s_add_u32 m0, s39, 12288
    s_add_u32 s28, s38, 12288
    buffer_load_dwordx4 v6, s[8:11], s28 offen lds
    s_add_u32 m0, s39, 16384
    s_add_u32 s28, s38, 16384
    buffer_load_dwordx4 v6, s[8:11], s28 offen lds
    s_add_u32 m0, s39, 20480
    s_add_u32 s28, s38, 20480
    buffer_load_dwordx4 v6, s[8:11], s28 offen lds
    s_add_u32 m0, s39, 24576
    s_add_u32 s28, s38, 24576
    buffer_load_dwordx4 v6, s[8:11], s28 offen lds
    ds_write_b128 v165, v[16:19] offset:0
    ds_write_b128 v165, v[20:23] offset:4096
    ds_write_b128 v165, v[24:27] offset:8192
    ds_write_b128 v165, v[28:31] offset:12288
    ds_write_b128 v165, v[32:35] offset:16384
    ds_write_b128 v165, v[36:39] offset:20480
    s_barrier
    s_add_u32 m0, s39, 36864
    s_add_u32 s28, s38, 36864
    buffer_load_dwordx4 v6, s[8:11], s28 offen lds
    s_add_u32 m0, s39, 40960
    s_add_u32 s28, s38, 40960
    buffer_load_dwordx4 v6, s[8:11], s28 offen lds
    s_add_u32 m0, s39, 45056
    s_add_u32 s28, s38, 45056
    buffer_load_dwordx4 v6, s[8:11], s28 offen lds
    s_add_u32 m0, s39, 49152
    s_add_u32 s28, s38, 49152
    buffer_load_dwordx4 v6, s[8:11], s28 offen lds
    s_add_u32 m0, s39, 53248
    s_add_u32 s28, s38, 53248
    buffer_load_dwordx4 v6, s[8:11], s28 offen lds
    s_add_u32 m0, s39, 57344
    s_add_u32 s28, s38, 57344
    buffer_load_dwordx4 v6, s[8:11], s28 offen lds
    ds_write_b128 v165, v[8:11] offset:32768
    ds_write_b128 v165, v[12:15] offset:36864
    v_pk_mul_f32 v[212:213], v[212:213], s[56:57]
    v_pk_mul_f32 v[214:215], v[214:215], s[56:57]
    v_pk_mul_f32 v[216:217], v[216:217], s[56:57]
    v_pk_mul_f32 v[218:219], v[218:219], s[56:57]
    v_pk_mul_f32 v[220:221], v[220:221], s[56:57]
    v_pk_mul_f32 v[222:223], v[222:223], s[56:57]
    v_pk_mul_f32 v[224:225], v[224:225], s[56:57]
    v_pk_mul_f32 v[226:227], v[226:227], s[56:57]
    v_pk_mul_f32 v[228:229], v[228:229], s[56:57]
    v_pk_mul_f32 v[230:231], v[230:231], s[56:57]
    s_waitcnt vmcnt(0) lgkmcnt(0)
    s_barrier
    s_add_u32 s41, s34, 0
    buffer_load_dwordx4 v[48:51], v6, s[8:11], s41 offen offset:0 sc1
    s_add_u32 s42, s43, 0
    buffer_load_dwordx4 v[52:55], v6, s[8:11], s42 offen offset:0 sc1
    buffer_load_dwordx4 v[56:59], v6, s[8:11], s41 offen offset:1024 sc1
    buffer_load_dwordx4 v[60:63], v6, s[8:11], s42 offen offset:1024 sc1
    buffer_load_dwordx4 v[64:67], v6, s[8:11], s41 offen offset:2048 sc1
    buffer_load_dwordx4 v[68:71], v6, s[8:11], s42 offen offset:2048 sc1
    buffer_load_dwordx4 v[72:75], v6, s[8:11], s41 offen offset:3072 sc1
    buffer_load_dwordx4 v[76:79], v6, s[8:11], s42 offen offset:3072 sc1
    ds_read_b64_tr_b16 v[160:161], v232 offset:0
    ds_read_b64_tr_b16 v[162:163], v232 offset:1280
    ds_read_b64_tr_b16 v[164:165], v232 offset:32
    ds_read_b64_tr_b16 v[166:167], v232 offset:1312
    ds_read_b64_tr_b16 v[168:169], v232 offset:64
    ds_read_b64_tr_b16 v[170:171], v232 offset:1344
    ds_read_b64_tr_b16 v[172:173], v232 offset:96
    ds_read_b64_tr_b16 v[174:175], v232 offset:1376
    ds_read_b64_tr_b16 v[176:177], v232 offset:128
    ds_read_b64_tr_b16 v[178:179], v232 offset:1408
    s_waitcnt vmcnt(6)
L_chk_200:
    v_bitop3_b32 v1, v48, v52, 1 bitop3:0x80
    v_cmp_eq_u32 vcc, 0, v1
    s_cbranch_vccnz L_stub_201
L_ok_202:
    s_waitcnt lgkmcnt(8)
    v_mfma_f32_16x16x32_bf16 v[8:11], v[160:163], v[48:51], 0
    ds_read_b64_tr_b16 v[180:181], v232 offset:5120
    ds_read_b64_tr_b16 v[182:183], v232 offset:6400
    v_mfma_f32_16x16x32_bf16 v[28:31], v[160:163], v[52:55], 0
    ds_read_b64_tr_b16 v[184:185], v232 offset:5152
    ds_read_b64_tr_b16 v[186:187], v232 offset:6432
    s_waitcnt lgkmcnt(10)
    v_mfma_f32_16x16x32_bf16 v[12:15], v[164:167], v[48:51], 0
    ds_read_b64_tr_b16 v[188:189], v232 offset:5184
    ds_read_b64_tr_b16 v[190:191], v232 offset:6464
    v_mfma_f32_16x16x32_bf16 v[32:35], v[164:167], v[52:55], 0
    ds_read_b64_tr_b16 v[192:193], v232 offset:5216
    ds_read_b64_tr_b16 v[194:195], v232 offset:6496
    s_waitcnt lgkmcnt(12)
    v_mfma_f32_16x16x32_bf16 v[16:19], v[168:171], v[48:51], 0
    ds_read_b64_tr_b16 v[196:197], v232 offset:5248
    ds_read_b64_tr_b16 v[198:199], v232 offset:6528
    v_mfma_f32_16x16x32_bf16 v[36:39], v[168:171], v[52:55], 0
    s_add_u32 s41, s34, 4096
    buffer_load_dwordx4 v[80:83], v6, s[8:11], s41 offen offset:0 sc1
    s_waitcnt lgkmcnt(12)
    v_mfma_f32_16x16x32_bf16 v[20:23], v[172:175], v[48:51], 0
    s_add_u32 s42, s43, 4096
    buffer_load_dwordx4 v[84:87], v6, s[8:11], s42 offen offset:0 sc1
    v_mfma_f32_16x16x32_bf16 v[40:43], v[172:175], v[52:55], 0
    buffer_load_dwordx4 v[88:91], v6, s[8:11], s41 offen offset:1024 sc1
    buffer_load_dwordx4 v[92:95], v6, s[8:11], s42 offen offset:1024 sc1
    s_waitcnt lgkmcnt(10)
    v_mfma_f32_16x16x32_bf16 v[24:27], v[176:179], v[48:51], 0
    s_waitcnt vmcnt(8)
L_chk_203:
    v_bitop3_b32 v1, v56, v60, 1 bitop3:0x80
    v_cmp_eq_u32 vcc, 0, v1
    s_cbranch_vccnz L_stub_204
L_ok_205:
    v_mfma_f32_16x16x32_bf16 v[44:47], v[176:179], v[52:55], 0
    s_waitcnt lgkmcnt(8)
    v_mfma_f32_16x16x32_bf16 v[8:11], v[180:183], v[56:59], v[8:11]
    ds_read_b64_tr_b16 v[160:161], v232 offset:10240
    ds_read_b64_tr_b16 v[162:163], v232 offset:11520
    v_mfma_f32_16x16x32_bf16 v[28:31], v[180:183], v[60:63], v[28:31]
    ds_read_b64_tr_b16 v[164:165], v232 offset:10272
    ds_read_b64_tr_b16 v[166:167], v232 offset:11552
    s_waitcnt lgkmcnt(10)
    v_mfma_f32_16x16x32_bf16 v[12:15], v[184:187], v[56:59], v[12:15]
    ds_read_b64_tr_b16 v[168:169], v232 offset:10304
    ds_read_b64_tr_b16 v[170:171], v232 offset:11584
    v_mfma_f32_16x16x32_bf16 v[32:35], v[184:187], v[60:63], v[32:35]
    ds_read_b64_tr_b16 v[172:173], v232 offset:10336
    ds_read_b64_tr_b16 v[174:175], v232 offset:11616
    s_waitcnt lgkmcnt(12)
    v_mfma_f32_16x16x32_bf16 v[16:19], v[188:191], v[56:59], v[16:19]
    ds_read_b64_tr_b16 v[176:177], v232 offset:10368
    ds_read_b64_tr_b16 v[178:179], v232 offset:11648
    v_mfma_f32_16x16x32_bf16 v[36:39], v[188:191], v[60:63], v[36:39]
    buffer_load_dwordx4 v[96:99], v6, s[8:11], s41 offen offset:2048 sc1
    s_waitcnt lgkmcnt(12)
    v_mfma_f32_16x16x32_bf16 v[20:23], v[192:195], v[56:59], v[20:23]
    buffer_load_dwordx4 v[100:103], v6, s[8:11], s42 offen offset:2048 sc1
    v_mfma_f32_16x16x32_bf16 v[40:43], v[192:195], v[60:63], v[40:43]
    buffer_load_dwordx4 v[104:107], v6, s[8:11], s41 offen offset:3072 sc1
    buffer_load_dwordx4 v[108:111], v6, s[8:11], s42 offen offset:3072 sc1
    s_waitcnt lgkmcnt(10)
    v_mfma_f32_16x16x32_bf16 v[24:27], v[196:199], v[56:59], v[24:27]
    s_waitcnt vmcnt(10)
L_chk_206:
    v_bitop3_b32 v1, v64, v68, 1 bitop3:0x80
    v_cmp_eq_u32 vcc, 0, v1
    s_cbranch_vccnz L_stub_207
L_ok_208:
    v_mfma_f32_16x16x32_bf16 v[44:47], v[196:199], v[60:63], v[44:47]
    s_waitcnt lgkmcnt(8)
    v_mfma_f32_16x16x32_bf16 v[8:11], v[160:163], v[64:67], v[8:11]
    ds_read_b64_tr_b16 v[180:181], v232 offset:17280
    ds_read_b64_tr_b16 v[182:183], v232 offset:18560
    v_mfma_f32_16x16x32_bf16 v[28:31], v[160:163], v[68:71], v[28:31]
    ds_read_b64_tr_b16 v[184:185], v232 offset:17312
    ds_read_b64_tr_b16 v[186:187], v232 offset:18592
    s_waitcnt lgkmcnt(10)
    v_mfma_f32_16x16x32_bf16 v[12:15], v[164:167], v[64:67], v[12:15]
    ds_read_b64_tr_b16 v[188:189], v232 offset:17344
    ds_read_b64_tr_b16 v[190:191], v232 offset:18624
    v_mfma_f32_16x16x32_bf16 v[32:35], v[164:167], v[68:71], v[32:35]
    ds_read_b64_tr_b16 v[192:193], v232 offset:17376
    ds_read_b64_tr_b16 v[194:195], v232 offset:18656
    s_waitcnt lgkmcnt(12)
    v_mfma_f32_16x16x32_bf16 v[16:19], v[168:171], v[64:67], v[16:19]
    ds_read_b64_tr_b16 v[196:197], v232 offset:17408
    ds_read_b64_tr_b16 v[198:199], v232 offset:18688
    v_mfma_f32_16x16x32_bf16 v[36:39], v[168:171], v[68:71], v[36:39]
    s_add_u32 s41, s34, 8192
    buffer_load_dwordx4 v[112:115], v6, s[8:11], s41 offen offset:0 sc1
    s_waitcnt lgkmcnt(12)
    v_mfma_f32_16x16x32_bf16 v[20:23], v[172:175], v[64:67], v[20:23]
    s_add_u32 s42, s43, 8192
    buffer_load_dwordx4 v[116:119], v6, s[8:11], s42 offen offset:0 sc1
    v_mfma_f32_16x16x32_bf16 v[40:43], v[172:175], v[68:71], v[40:43]
    buffer_load_dwordx4 v[120:123], v6, s[8:11], s41 offen offset:1024 sc1
    buffer_load_dwordx4 v[124:127], v6, s[8:11], s42 offen offset:1024 sc1
    s_waitcnt lgkmcnt(10)
    v_mfma_f32_16x16x32_bf16 v[24:27], v[176:179], v[64:67], v[24:27]
    s_waitcnt vmcnt(12)
L_chk_209:
    v_bitop3_b32 v1, v72, v76, 1 bitop3:0x80
    v_cmp_eq_u32 vcc, 0, v1
    s_cbranch_vccnz L_stub_210
L_ok_211:
    v_mfma_f32_16x16x32_bf16 v[44:47], v[176:179], v[68:71], v[44:47]
    s_waitcnt lgkmcnt(8)
    v_mfma_f32_16x16x32_bf16 v[8:11], v[180:183], v[72:75], v[8:11]
    ds_read_b64_tr_b16 v[160:161], v232 offset:22400
    ds_read_b64_tr_b16 v[162:163], v232 offset:23680
    v_mfma_f32_16x16x32_bf16 v[28:31], v[180:183], v[76:79], v[28:31]
    ds_read_b64_tr_b16 v[164:165], v232 offset:22432
    ds_read_b64_tr_b16 v[166:167], v232 offset:23712
    s_waitcnt lgkmcnt(10)
    v_mfma_f32_16x16x32_bf16 v[12:15], v[184:187], v[72:75], v[12:15]
    ds_read_b64_tr_b16 v[168:169], v232 offset:22464
    ds_read_b64_tr_b16 v[170:171], v232 offset:23744
    v_mfma_f32_16x16x32_bf16 v[32:35], v[184:187], v[76:79], v[32:35]
    ds_read_b64_tr_b16 v[172:173], v232 offset:22496
    ds_read_b64_tr_b16 v[174:175], v232 offset:23776
    s_waitcnt lgkmcnt(12)
    v_mfma_f32_16x16x32_bf16 v[16:19], v[188:191], v[72:75], v[16:19]
    ds_read_b64_tr_b16 v[176:177], v232 offset:22528
    ds_read_b64_tr_b16 v[178:179], v232 offset:23808
    v_mfma_f32_16x16x32_bf16 v[36:39], v[188:191], v[76:79], v[36:39]
    buffer_load_dwordx4 v[128:131], v6, s[8:11], s41 offen offset:2048 sc1
    s_waitcnt lgkmcnt(12)
    v_mfma_f32_16x16x32_bf16 v[20:23], v[192:195], v[72:75], v[20:23]
    buffer_load_dwordx4 v[132:135], v6, s[8:11], s42 offen offset:2048 sc1
    v_mfma_f32_16x16x32_bf16 v[40:43], v[192:195], v[76:79], v[40:43]
    buffer_load_dwordx4 v[136:139], v6, s[8:11], s41 offen offset:3072 sc1
    buffer_load_dwordx4 v[140:143], v6, s[8:11], s42 offen offset:3072 sc1
    s_waitcnt lgkmcnt(10)
    v_mfma_f32_16x16x32_bf16 v[24:27], v[196:199], v[72:75], v[24:27]
    s_waitcnt vmcnt(14)
L_chk_212:
    v_bitop3_b32 v1, v80, v84, 1 bitop3:0x80
    v_cmp_eq_u32 vcc, 0, v1
    s_cbranch_vccnz L_stub_213
L_ok_214:
    v_mfma_f32_16x16x32_bf16 v[44:47], v[196:199], v[76:79], v[44:47]
    s_waitcnt lgkmcnt(8)
    v_mfma_f32_16x16x32_bf16 v[8:11], v[160:163], v[80:83], v[8:11]
    ds_read_b64_tr_b16 v[180:181], v232 offset:27520
    ds_read_b64_tr_b16 v[182:183], v232 offset:28800
    v_mfma_f32_16x16x32_bf16 v[28:31], v[160:163], v[84:87], v[28:31]
    ds_read_b64_tr_b16 v[184:185], v232 offset:27552
    ds_read_b64_tr_b16 v[186:187], v232 offset:28832
    s_waitcnt lgkmcnt(10)
    v_mfma_f32_16x16x32_bf16 v[12:15], v[164:167], v[80:83], v[12:15]
    ds_read_b64_tr_b16 v[188:189], v232 offset:27584
    ds_read_b64_tr_b16 v[190:191], v232 offset:28864
    v_mfma_f32_16x16x32_bf16 v[32:35], v[164:167], v[84:87], v[32:35]
    ds_read_b64_tr_b16 v[192:193], v232 offset:27616
    ds_read_b64_tr_b16 v[194:195], v232 offset:28896
    s_waitcnt lgkmcnt(12)
    v_mfma_f32_16x16x32_bf16 v[16:19], v[168:171], v[80:83], v[16:19]
    ds_read_b64_tr_b16 v[196:197], v232 offset:27648
    ds_read_b64_tr_b16 v[198:199], v232 offset:28928
    v_mfma_f32_16x16x32_bf16 v[36:39], v[168:171], v[84:87], v[36:39]
    s_add_u32 s41, s34, 12288
    buffer_load_dwordx4 v[144:147], v6, s[8:11], s41 offen offset:0 sc1
    s_waitcnt lgkmcnt(12)
    v_mfma_f32_16x16x32_bf16 v[20:23], v[172:175], v[80:83], v[20:23]
    s_add_u32 s42, s43, 12288
    buffer_load_dwordx4 v[148:151], v6, s[8:11], s42 offen offset:0 sc1
    v_mfma_f32_16x16x32_bf16 v[40:43], v[172:175], v[84:87], v[40:43]
    buffer_load_dwordx4 v[152:155], v6, s[8:11], s41 offen offset:1024 sc1
    buffer_load_dwordx4 v[156:159], v6, s[8:11], s42 offen offset:1024 sc1
    s_waitcnt lgkmcnt(10)
    v_mfma_f32_16x16x32_bf16 v[24:27], v[176:179], v[80:83], v[24:27]
    s_waitcnt vmcnt(16)
L_chk_215:
    v_bitop3_b32 v1, v88, v92, 1 bitop3:0x80
    v_cmp_eq_u32 vcc, 0, v1
    s_cbranch_vccnz L_stub_216
L_ok_217:
    v_mfma_f32_16x16x32_bf16 v[44:47], v[176:179], v[84:87], v[44:47]
    s_waitcnt lgkmcnt(8)
    v_mfma_f32_16x16x32_bf16 v[8:11], v[180:183], v[88:91], v[8:11]
    ds_read_b64_tr_b16 v[160:161], v234 offset:15360
    ds_read_b64_tr_b16 v[162:163], v234 offset:16640
    v_mfma_f32_16x16x32_bf16 v[28:31], v[180:183], v[92:95], v[28:31]
    ds_read_b64_tr_b16 v[164:165], v234 offset:15392
    ds_read_b64_tr_b16 v[166:167], v234 offset:16672
    s_waitcnt lgkmcnt(10)
    v_mfma_f32_16x16x32_bf16 v[12:15], v[184:187], v[88:91], v[12:15]
    ds_read_b64_tr_b16 v[168:169], v234 offset:15424
    ds_read_b64_tr_b16 v[170:171], v234 offset:16704
    v_mfma_f32_16x16x32_bf16 v[32:35], v[184:187], v[92:95], v[32:35]
    ds_read_b64_tr_b16 v[172:173], v234 offset:15456
    ds_read_b64_tr_b16 v[174:175], v234 offset:16736
    s_waitcnt lgkmcnt(12)
    v_mfma_f32_16x16x32_bf16 v[16:19], v[188:191], v[88:91], v[16:19]
    ds_read_b64_tr_b16 v[176:177], v234 offset:15488
    ds_read_b64_tr_b16 v[178:179], v234 offset:16768
    v_mfma_f32_16x16x32_bf16 v[36:39], v[188:191], v[92:95], v[36:39]
    s_waitcnt lgkmcnt(12)
    v_mfma_f32_16x16x32_bf16 v[20:23], v[192:195], v[88:91], v[20:23]
    v_mfma_f32_16x16x32_bf16 v[40:43], v[192:195], v[92:95], v[40:43]
    s_waitcnt lgkmcnt(10)
    v_mfma_f32_16x16x32_bf16 v[24:27], v[196:199], v[88:91], v[24:27]
    s_waitcnt vmcnt(14)
L_chk_218:
    v_bitop3_b32 v1, v96, v100, 1 bitop3:0x80
    v_cmp_eq_u32 vcc, 0, v1
    s_cbranch_vccnz L_stub_219
L_ok_220:
    v_mfma_f32_16x16x32_bf16 v[44:47], v[196:199], v[92:95], v[44:47]
    s_waitcnt lgkmcnt(8)
    v_mfma_f32_16x16x32_bf16 v[8:11], v[160:163], v[96:99], v[8:11]
    ds_read_b64_tr_b16 v[180:181], v232 offset:34560
    ds_read_b64_tr_b16 v[182:183], v232 offset:35840
    v_mfma_f32_16x16x32_bf16 v[28:31], v[160:163], v[100:103], v[28:31]
    ds_read_b64_tr_b16 v[184:185], v232 offset:34592
    ds_read_b64_tr_b16 v[186:187], v232 offset:35872
    s_waitcnt lgkmcnt(10)
    v_mfma_f32_16x16x32_bf16 v[12:15], v[164:167], v[96:99], v[12:15]
    ds_read_b64_tr_b16 v[188:189], v232 offset:34624
    ds_read_b64_tr_b16 v[190:191], v232 offset:35904
    v_mfma_f32_16x16x32_bf16 v[32:35], v[164:167], v[100:103], v[32:35]
    ds_read_b64_tr_b16 v[192:193], v232 offset:34656
    ds_read_b64_tr_b16 v[194:195], v232 offset:35936
    s_waitcnt lgkmcnt(12)
    v_mfma_f32_16x16x32_bf16 v[16:19], v[168:171], v[96:99], v[16:19]
    ds_read_b64_tr_b16 v[196:197], v232 offset:34688
    ds_read_b64_tr_b16 v[198:199], v232 offset:35968
    v_mfma_f32_16x16x32_bf16 v[36:39], v[168:171], v[100:103], v[36:39]
    s_waitcnt lgkmcnt(12)
    v_mfma_f32_16x16x32_bf16 v[20:23], v[172:175], v[96:99], v[20:23]
    v_mfma_f32_16x16x32_bf16 v[40:43], v[172:175], v[100:103], v[40:43]
    s_waitcnt lgkmcnt(10)
    v_mfma_f32_16x16x32_bf16 v[24:27], v[176:179], v[96:99], v[24:27]
    s_waitcnt vmcnt(12)
L_chk_221:
    v_bitop3_b32 v1, v104, v108, 1 bitop3:0x80
    v_cmp_eq_u32 vcc, 0, v1
    s_cbranch_vccnz L_stub_222
L_ok_223:
    v_mfma_f32_16x16x32_bf16 v[44:47], v[176:179], v[100:103], v[44:47]
    s_waitcnt lgkmcnt(8)
    v_mfma_f32_16x16x32_bf16 v[8:11], v[180:183], v[104:107], v[8:11]
    ds_read_b64_tr_b16 v[160:161], v232 offset:39680
    ds_read_b64_tr_b16 v[162:163], v232 offset:40960
    v_mfma_f32_16x16x32_bf16 v[28:31], v[180:183], v[108:111], v[28:31]
    ds_read_b64_tr_b16 v[164:165], v232 offset:39712
    ds_read_b64_tr_b16 v[166:167], v232 offset:40992
    s_waitcnt lgkmcnt(10)
    v_mfma_f32_16x16x32_bf16 v[12:15], v[184:187], v[104:107], v[12:15]
    ds_read_b64_tr_b16 v[168:169], v232 offset:39744
    ds_read_b64_tr_b16 v[170:171], v232 offset:41024
    v_mfma_f32_16x16x32_bf16 v[32:35], v[184:187], v[108:111], v[32:35]
    ds_read_b64_tr_b16 v[172:173], v232 offset:39776
    ds_read_b64_tr_b16 v[174:175], v232 offset:41056
    s_waitcnt lgkmcnt(12)
    v_mfma_f32_16x16x32_bf16 v[16:19], v[188:191], v[104:107], v[16:19]
    ds_read_b64_tr_b16 v[176:177], v232 offset:39808
    ds_read_b64_tr_b16 v[178:179], v232 offset:41088
    v_mfma_f32_16x16x32_bf16 v[36:39], v[188:191], v[108:111], v[36:39]
    s_waitcnt lgkmcnt(12)
    v_mfma_f32_16x16x32_bf16 v[20:23], v[192:195], v[104:107], v[20:23]
    v_mfma_f32_16x16x32_bf16 v[40:43], v[192:195], v[108:111], v[40:43]
    s_waitcnt lgkmcnt(10)
    v_mfma_f32_16x16x32_bf16 v[24:27], v[196:199], v[104:107], v[24:27]
    s_waitcnt vmcnt(10)
L_chk_224:
    v_bitop3_b32 v1, v112, v116, 1 bitop3:0x80
    v_cmp_eq_u32 vcc, 0, v1
    s_cbranch_vccnz L_stub_225
L_ok_226:
    v_mfma_f32_16x16x32_bf16 v[44:47], v[196:199], v[108:111], v[44:47]
    s_waitcnt lgkmcnt(8)
    v_mfma_f32_16x16x32_bf16 v[8:11], v[160:163], v[112:115], v[8:11]
    ds_read_b64_tr_b16 v[180:181], v232 offset:44800
    ds_read_b64_tr_b16 v[182:183], v232 offset:46080
    v_mfma_f32_16x16x32_bf16 v[28:31], v[160:163], v[116:119], v[28:31]
    ds_read_b64_tr_b16 v[184:185], v232 offset:44832
    ds_read_b64_tr_b16 v[186:187], v232 offset:46112
    s_waitcnt lgkmcnt(10)
    v_mfma_f32_16x16x32_bf16 v[12:15], v[164:167], v[112:115], v[12:15]
    ds_read_b64_tr_b16 v[188:189], v232 offset:44864
    ds_read_b64_tr_b16 v[190:191], v232 offset:46144
    v_mfma_f32_16x16x32_bf16 v[32:35], v[164:167], v[116:119], v[32:35]
    ds_read_b64_tr_b16 v[192:193], v232 offset:44896
    ds_read_b64_tr_b16 v[194:195], v232 offset:46176
    s_waitcnt lgkmcnt(12)
    v_mfma_f32_16x16x32_bf16 v[16:19], v[168:171], v[112:115], v[16:19]
    ds_read_b64_tr_b16 v[196:197], v232 offset:44928
    ds_read_b64_tr_b16 v[198:199], v232 offset:46208
    v_mfma_f32_16x16x32_bf16 v[36:39], v[168:171], v[116:119], v[36:39]
    s_waitcnt lgkmcnt(12)
    v_mfma_f32_16x16x32_bf16 v[20:23], v[172:175], v[112:115], v[20:23]
    v_mfma_f32_16x16x32_bf16 v[40:43], v[172:175], v[116:119], v[40:43]
    s_waitcnt lgkmcnt(10)
    v_mfma_f32_16x16x32_bf16 v[24:27], v[176:179], v[112:115], v[24:27]
    s_waitcnt vmcnt(8)
L_chk_227:
    v_bitop3_b32 v1, v120, v124, 1 bitop3:0x80
    v_cmp_eq_u32 vcc, 0, v1
    s_cbranch_vccnz L_stub_228
L_ok_229:
    v_mfma_f32_16x16x32_bf16 v[44:47], v[176:179], v[116:119], v[44:47]
    s_waitcnt lgkmcnt(8)
    v_mfma_f32_16x16x32_bf16 v[8:11], v[180:183], v[120:123], v[8:11]
    ds_read_b64_tr_b16 v[160:161], v232 offset:51840
    ds_read_b64_tr_b16 v[162:163], v232 offset:53120
    v_mfma_f32_16x16x32_bf16 v[28:31], v[180:183], v[124:127], v[28:31]
    ds_read_b64_tr_b16 v[164:165], v232 offset:51872
    ds_read_b64_tr_b16 v[166:167], v232 offset:53152
    s_waitcnt lgkmcnt(10)
    v_mfma_f32_16x16x32_bf16 v[12:15], v[184:187], v[120:123], v[12:15]
    ds_read_b64_tr_b16 v[168:169], v232 offset:51904
    ds_read_b64_tr_b16 v[170:171], v232 offset:53184
    v_mfma_f32_16x16x32_bf16 v[32:35], v[184:187], v[124:127], v[32:35]
    ds_read_b64_tr_b16 v[172:173], v232 offset:51936
    ds_read_b64_tr_b16 v[174:175], v232 offset:53216
    s_waitcnt lgkmcnt(12)
    v_mfma_f32_16x16x32_bf16 v[16:19], v[188:191], v[120:123], v[16:19]
    ds_read_b64_tr_b16 v[176:177], v232 offset:51968
    ds_read_b64_tr_b16 v[178:179], v232 offset:53248
    v_mfma_f32_16x16x32_bf16 v[36:39], v[188:191], v[124:127], v[36:39]
    s_waitcnt lgkmcnt(12)
    v_mfma_f32_16x16x32_bf16 v[20:23], v[192:195], v[120:123], v[20:23]
    v_mfma_f32_16x16x32_bf16 v[40:43], v[192:195], v[124:127], v[40:43]
    s_waitcnt lgkmcnt(10)
    v_mfma_f32_16x16x32_bf16 v[24:27], v[196:199], v[120:123], v[24:27]
    s_waitcnt vmcnt(6)
L_chk_230:
    v_bitop3_b32 v1, v128, v132, 1 bitop3:0x80
    v_cmp_eq_u32 vcc, 0, v1
    s_cbranch_vccnz L_stub_231
L_ok_232:
    v_mfma_f32_16x16x32_bf16 v[44:47], v[196:199], v[124:127], v[44:47]
    s_waitcnt lgkmcnt(8)
    v_mfma_f32_16x16x32_bf16 v[8:11], v[160:163], v[128:131], v[8:11]
    ds_read_b64_tr_b16 v[180:181], v232 offset:56960
    ds_read_b64_tr_b16 v[182:183], v232 offset:58240
    v_mfma_f32_16x16x32_bf16 v[28:31], v[160:163], v[132:135], v[28:31]
    ds_read_b64_tr_b16 v[184:185], v232 offset:56992
    ds_read_b64_tr_b16 v[186:187], v232 offset:58272
    s_waitcnt lgkmcnt(10)
    v_mfma_f32_16x16x32_bf16 v[12:15], v[164:167], v[128:131], v[12:15]
    ds_read_b64_tr_b16 v[188:189], v232 offset:57024
    ds_read_b64_tr_b16 v[190:191], v232 offset:58304
    v_mfma_f32_16x16x32_bf16 v[32:35], v[164:167], v[132:135], v[32:35]
    ds_read_b64_tr_b16 v[192:193], v232 offset:57056
    ds_read_b64_tr_b16 v[194:195], v232 offset:58336
    s_waitcnt lgkmcnt(12)
    v_mfma_f32_16x16x32_bf16 v[16:19], v[168:171], v[128:131], v[16:19]
    ds_read_b64_tr_b16 v[196:197], v232 offset:57088
    ds_read_b64_tr_b16 v[198:199], v232 offset:58368
    v_mfma_f32_16x16x32_bf16 v[36:39], v[168:171], v[132:135], v[36:39]
    s_waitcnt lgkmcnt(12)
    v_mfma_f32_16x16x32_bf16 v[20:23], v[172:175], v[128:131], v[20:23]
    v_mfma_f32_16x16x32_bf16 v[40:43], v[172:175], v[132:135], v[40:43]
    s_waitcnt lgkmcnt(10)
    v_mfma_f32_16x16x32_bf16 v[24:27], v[176:179], v[128:131], v[24:27]
    s_waitcnt vmcnt(4)
L_chk_233:
    v_bitop3_b32 v1, v136, v140, 1 bitop3:0x80
    v_cmp_eq_u32 vcc, 0, v1
    s_cbranch_vccnz L_stub_234
L_ok_235:
    v_mfma_f32_16x16x32_bf16 v[44:47], v[176:179], v[132:135], v[44:47]
    s_waitcnt lgkmcnt(8)
    v_mfma_f32_16x16x32_bf16 v[8:11], v[180:183], v[136:139], v[8:11]
    ds_read_b64_tr_b16 v[160:161], v232 offset:62080
    ds_read_b64_tr_b16 v[162:163], v232 offset:63360
    v_mfma_f32_16x16x32_bf16 v[28:31], v[180:183], v[140:143], v[28:31]
    ds_read_b64_tr_b16 v[164:165], v232 offset:62112
    ds_read_b64_tr_b16 v[166:167], v232 offset:63392
    s_waitcnt lgkmcnt(10)
    v_mfma_f32_16x16x32_bf16 v[12:15], v[184:187], v[136:139], v[12:15]
    ds_read_b64_tr_b16 v[168:169], v232 offset:62144
    ds_read_b64_tr_b16 v[170:171], v232 offset:63424
    v_mfma_f32_16x16x32_bf16 v[32:35], v[184:187], v[140:143], v[32:35]
    ds_read_b64_tr_b16 v[172:173], v232 offset:62176
    ds_read_b64_tr_b16 v[174:175], v232 offset:63456
    s_waitcnt lgkmcnt(12)
    v_mfma_f32_16x16x32_bf16 v[16:19], v[188:191], v[136:139], v[16:19]
    ds_read_b64_tr_b16 v[176:177], v232 offset:62208
    ds_read_b64_tr_b16 v[178:179], v232 offset:63488
    v_mfma_f32_16x16x32_bf16 v[36:39], v[188:191], v[140:143], v[36:39]
    s_waitcnt lgkmcnt(12)
    v_mfma_f32_16x16x32_bf16 v[20:23], v[192:195], v[136:139], v[20:23]
    v_mfma_f32_16x16x32_bf16 v[40:43], v[192:195], v[140:143], v[40:43]
    s_waitcnt lgkmcnt(10)
    v_mfma_f32_16x16x32_bf16 v[24:27], v[196:199], v[136:139], v[24:27]
    s_waitcnt vmcnt(2)
L_chk_236:
    v_bitop3_b32 v1, v144, v148, 1 bitop3:0x80
    v_cmp_eq_u32 vcc, 0, v1
    s_cbranch_vccnz L_stub_237
L_ok_238:
    v_mfma_f32_16x16x32_bf16 v[44:47], v[196:199], v[140:143], v[44:47]
    s_waitcnt lgkmcnt(8)
    v_mfma_f32_16x16x32_bf16 v[28:31], v[160:163], v[148:151], v[28:31]
    ds_read_b64_tr_b16 v[180:181], v234 offset:49920
    ds_read_b64_tr_b16 v[182:183], v234 offset:51200
    s_waitcnt lgkmcnt(8)
    v_mfma_f32_16x16x32_bf16 v[32:35], v[164:167], v[148:151], v[32:35]
    ds_read_b64_tr_b16 v[184:185], v234 offset:49952
    ds_read_b64_tr_b16 v[186:187], v234 offset:51232
    s_waitcnt lgkmcnt(8)
    v_mfma_f32_16x16x32_bf16 v[36:39], v[168:171], v[148:151], v[36:39]
    ds_read_b64_tr_b16 v[188:189], v234 offset:49984
    ds_read_b64_tr_b16 v[190:191], v234 offset:51264
    s_waitcnt lgkmcnt(8)
    v_mfma_f32_16x16x32_bf16 v[40:43], v[172:175], v[148:151], v[40:43]
    ds_read_b64_tr_b16 v[192:193], v234 offset:50016
    ds_read_b64_tr_b16 v[194:195], v234 offset:51296
    s_waitcnt lgkmcnt(8)
    v_mfma_f32_16x16x32_bf16 v[44:47], v[176:179], v[148:151], v[44:47]
    ds_read_b64_tr_b16 v[196:197], v234 offset:50048
    ds_read_b64_tr_b16 v[198:199], v234 offset:51328
    v_mfma_f32_16x16x32_bf16 v[8:11], v[160:163], v[144:147], v[8:11]
    v_mfma_f32_16x16x32_bf16 v[12:15], v[164:167], v[144:147], v[12:15]
    s_waitcnt vmcnt(0)
L_chk_239:
    v_bitop3_b32 v1, v152, v156, 1 bitop3:0x80
    v_cmp_eq_u32 vcc, 0, v1
    s_cbranch_vccnz L_stub_240
L_ok_241:
    v_mfma_f32_16x16x32_bf16 v[16:19], v[168:171], v[144:147], v[16:19]
    s_waitcnt lgkmcnt(8)
    v_mfma_f32_16x16x32_bf16 v[28:31], v[180:183], v[156:159], v[28:31]
    s_waitcnt lgkmcnt(6)
    v_mfma_f32_16x16x32_bf16 v[32:35], v[184:187], v[156:159], v[32:35]
    s_waitcnt lgkmcnt(4)
    v_mfma_f32_16x16x32_bf16 v[36:39], v[188:191], v[156:159], v[36:39]
    s_waitcnt lgkmcnt(2)
    v_mfma_f32_16x16x32_bf16 v[40:43], v[192:195], v[156:159], v[40:43]
    s_waitcnt lgkmcnt(0)
    v_mfma_f32_16x16x32_bf16 v[44:47], v[196:199], v[156:159], v[44:47]
    v_mfma_f32_16x16x32_bf16 v[20:23], v[172:175], v[144:147], v[20:23]
    ds_write_b128 v246, v[28:31] offset:0
    v_mfma_f32_16x16x32_bf16 v[24:27], v[176:179], v[144:147], v[24:27]
    ds_write_b128 v246, v[32:35] offset:1024
    v_mfma_f32_16x16x32_bf16 v[8:11], v[180:183], v[152:155], v[8:11]
    ds_write_b128 v246, v[36:39] offset:2048
    v_mfma_f32_16x16x32_bf16 v[12:15], v[184:187], v[152:155], v[12:15]
    ds_write_b128 v246, v[40:43] offset:3072
    v_mfma_f32_16x16x32_bf16 v[16:19], v[188:191], v[152:155], v[16:19]
    ds_write_b128 v246, v[44:47] offset:4096
    v_mfma_f32_16x16x32_bf16 v[20:23], v[192:195], v[152:155], v[20:23]
    v_mfma_f32_16x16x32_bf16 v[24:27], v[196:199], v[152:155], v[24:27]
    v_lshlrev_b32 v80, 16, v200
    v_and_b32 v81, 0xffff0000, v200
    v_lshlrev_b32 v82, 16, v201
    v_and_b32 v83, 0xffff0000, v201
    v_lshlrev_b32 v84, 16, v202
    v_and_b32 v85, 0xffff0000, v202
    v_lshlrev_b32 v86, 16, v203
    v_and_b32 v87, 0xffff0000, v203
    v_lshlrev_b32 v88, 16, v204
    v_and_b32 v89, 0xffff0000, v204
    v_lshlrev_b32 v90, 16, v205
    v_and_b32 v91, 0xffff0000, v205
    v_lshlrev_b32 v92, 16, v206
    v_and_b32 v93, 0xffff0000, v206
    v_lshlrev_b32 v94, 16, v207
    v_and_b32 v95, 0xffff0000, v207
    v_lshlrev_b32 v96, 16, v208
    v_and_b32 v97, 0xffff0000, v208
    v_lshlrev_b32 v98, 16, v209
    v_and_b32 v99, 0xffff0000, v209
    v_pk_fma_f32 v[8:9], v[8:9], v[212:213], v[80:81]
    v_pk_fma_f32 v[10:11], v[10:11], v[214:215], v[82:83]
    v_pk_fma_f32 v[12:13], v[12:13], v[216:217], v[84:85]
    v_pk_fma_f32 v[14:15], v[14:15], v[218:219], v[86:87]
    v_pk_fma_f32 v[16:17], v[16:17], v[220:221], v[88:89]
    v_pk_fma_f32 v[18:19], v[18:19], v[222:223], v[90:91]
    v_pk_fma_f32 v[20:21], v[20:21], v[224:225], v[92:93]
    v_pk_fma_f32 v[22:23], v[22:23], v[226:227], v[94:95]
    v_pk_fma_f32 v[24:25], v[24:25], v[228:229], v[96:97]
    v_pk_fma_f32 v[26:27], v[26:27], v[230:231], v[98:99]
    s_waitcnt lgkmcnt(0)
    s_barrier
    ds_read_b128 v[48:51], v247 offset:0
    ds_read_b128 v[52:55], v247 offset:1024
    ds_read_b128 v[56:59], v247 offset:2048
    ds_read_b128 v[60:63], v247 offset:3072
    ds_read_b128 v[64:67], v247 offset:4096
    s_waitcnt lgkmcnt(4)
    v_pk_fma_f32 v[8:9], v[48:49], v[212:213], v[8:9]
    v_pk_fma_f32 v[10:11], v[50:51], v[214:215], v[10:11]
    s_waitcnt lgkmcnt(3)
    v_pk_fma_f32 v[12:13], v[52:53], v[216:217], v[12:13]
    v_pk_fma_f32 v[14:15], v[54:55], v[218:219], v[14:15]
    s_waitcnt lgkmcnt(2)
    v_pk_fma_f32 v[16:17], v[56:57], v[220:221], v[16:17]
    v_pk_fma_f32 v[18:19], v[58:59], v[222:223], v[18:19]
    s_waitcnt lgkmcnt(1)
    v_pk_fma_f32 v[20:21], v[60:61], v[224:225], v[20:21]
    v_pk_fma_f32 v[22:23], v[62:63], v[226:227], v[22:23]
    s_waitcnt lgkmcnt(0)
    v_pk_fma_f32 v[24:25], v[64:65], v[228:229], v[24:25]
    v_pk_fma_f32 v[26:27], v[66:67], v[230:231], v[26:27]
    v_cvt_pk_bf16_f32 v100, v8, v9
    v_cvt_pk_bf16_f32 v101, v10, v11
    v_cvt_pk_bf16_f32 v102, v12, v13
    v_cvt_pk_bf16_f32 v103, v14, v15
    v_cvt_pk_bf16_f32 v104, v16, v17
    v_cvt_pk_bf16_f32 v105, v18, v19
    v_cvt_pk_bf16_f32 v106, v20, v21
    v_cvt_pk_bf16_f32 v107, v22, v23
    v_cvt_pk_bf16_f32 v108, v24, v25
    v_cvt_pk_bf16_f32 v109, v26, v27
    ds_write_b64 v236, v[100:101] offset:0
    ds_write_b64 v236, v[102:103] offset:32
    ds_write_b64 v236, v[104:105] offset:64
    ds_write_b64 v236, v[106:107] offset:96
    ds_write_b64 v236, v[108:109] offset:128
    s_waitcnt lgkmcnt(0)
    ds_read_b128 v[80:83], v237
    ds_read_b128 v[84:87], v238
    ds_read_b128 v[88:91], v239
    s_waitcnt lgkmcnt(2)
    buffer_store_dwordx4 v[80:83], v240, s[44:47], s33 offen
    s_waitcnt lgkmcnt(1)
    buffer_store_dwordx4 v[84:87], v241, s[44:47], s33 offen
    s_mov_b32 exec_hi, 0
    s_waitcnt lgkmcnt(0)
    buffer_store_dwordx4 v[88:91], v242, s[44:47], s33 offen
    s_endpgm
L_stub_188:
    s_add_u32 s64, s64, 1
    s_cmp_gt_u32 s64, 3000
    s_cbranch_scc1 L_ok_189
    s_sleep 2
    buffer_load_dwordx4 v[44:47], v6, s[8:11], s62 offen offset:0 sc1
    buffer_load_dwordx4 v[60:63], v6, s[8:11], s62 offen offset:1024 sc1
    buffer_load_dwordx4 v[52:55], v6, s[8:11], s63 offen offset:0 sc1
    buffer_load_dwordx4 v[68:71], v6, s[8:11], s63 offen offset:1024 sc1
    s_waitcnt vmcnt(0)
    s_branch L_chk_187
L_stub_201:
    s_add_u32 s40, s40, 1
    s_cmp_gt_u32 s40, 3000
    s_cbranch_scc1 L_ok_202
    s_sleep 2
    s_add_u32 s50, s34, 0
    buffer_load_dwordx4 v[48:51], v6, s[8:11], s50 offen offset:0 sc1
    s_add_u32 s51, s43, 0
    buffer_load_dwordx4 v[52:55], v6, s[8:11], s51 offen offset:0 sc1
    buffer_load_dwordx4 v[56:59], v6, s[8:11], s50 offen offset:1024 sc1
    buffer_load_dwordx4 v[60:63], v6, s[8:11], s51 offen offset:1024 sc1
    buffer_load_dwordx4 v[64:67], v6, s[8:11], s50 offen offset:2048 sc1
    buffer_load_dwordx4 v[68:71], v6, s[8:11], s51 offen offset:2048 sc1
    buffer_load_dwordx4 v[72:75], v6, s[8:11], s50 offen offset:3072 sc1
    buffer_load_dwordx4 v[76:79], v6, s[8:11], s51 offen offset:3072 sc1
    s_waitcnt vmcnt(0)
    s_branch L_chk_200
L_stub_204:
    s_add_u32 s40, s40, 1
    s_cmp_gt_u32 s40, 3000
    s_cbranch_scc1 L_ok_205
    s_sleep 2
    s_add_u32 s50, s34, 0
    buffer_load_dwordx4 v[56:59], v6, s[8:11], s50 offen offset:1024 sc1
    s_add_u32 s51, s43, 0
    buffer_load_dwordx4 v[60:63], v6, s[8:11], s51 offen offset:1024 sc1
    buffer_load_dwordx4 v[64:67], v6, s[8:11], s50 offen offset:2048 sc1
    buffer_load_dwordx4 v[68:71], v6, s[8:11], s51 offen offset:2048 sc1
    buffer_load_dwordx4 v[72:75], v6, s[8:11], s50 offen offset:3072 sc1
    buffer_load_dwordx4 v[76:79], v6, s[8:11], s51 offen offset:3072 sc1
    s_add_u32 s50, s34, 4096
    buffer_load_dwordx4 v[80:83], v6, s[8:11], s50 offen offset:0 sc1
    s_add_u32 s51, s43, 4096
    buffer_load_dwordx4 v[84:87], v6, s[8:11], s51 offen offset:0 sc1
    buffer_load_dwordx4 v[88:91], v6, s[8:11], s50 offen offset:1024 sc1
    buffer_load_dwordx4 v[92:95], v6, s[8:11], s51 offen offset:1024 sc1
    s_waitcnt vmcnt(0)
    s_branch L_chk_203
L_stub_207:
    s_add_u32 s40, s40, 1
    s_cmp_gt_u32 s40, 3000
    s_cbranch_scc1 L_ok_208
    s_sleep 2
    s_add_u32 s50, s34, 0
    buffer_load_dwordx4 v[64:67], v6, s[8:11], s50 offen offset:2048 sc1
    s_add_u32 s51, s43, 0
    buffer_load_dwordx4 v[68:71], v6, s[8:11], s51 offen offset:2048 sc1
    buffer_load_dwordx4 v[72:75], v6, s[8:11], s50 offen offset:3072 sc1
    buffer_load_dwordx4 v[76:79], v6, s[8:11], s51 offen offset:3072 sc1
    s_add_u32 s50, s34, 4096
    buffer_load_dwordx4 v[80:83], v6, s[8:11], s50 offen offset:0 sc1
    s_add_u32 s51, s43, 4096
    buffer_load_dwordx4 v[84:87], v6, s[8:11], s51 offen offset:0 sc1
    buffer_load_dwordx4 v[88:91], v6, s[8:11], s50 offen offset:1024 sc1
    buffer_load_dwordx4 v[92:95], v6, s[8:11], s51 offen offset:1024 sc1
    buffer_load_dwordx4 v[96:99], v6, s[8:11], s50 offen offset:2048 sc1
    buffer_load_dwordx4 v[100:103], v6, s[8:11], s51 offen offset:2048 sc1
    buffer_load_dwordx4 v[104:107], v6, s[8:11], s50 offen offset:3072 sc1
    buffer_load_dwordx4 v[108:111], v6, s[8:11], s51 offen offset:3072 sc1
    s_waitcnt vmcnt(0)
    s_branch L_chk_206
L_stub_210:
    s_add_u32 s40, s40, 1
    s_cmp_gt_u32 s40, 3000
    s_cbranch_scc1 L_ok_211
    s_sleep 2
    s_add_u32 s50, s34, 0
    buffer_load_dwordx4 v[72:75], v6, s[8:11], s50 offen offset:3072 sc1
    s_add_u32 s51, s43, 0
    buffer_load_dwordx4 v[76:79], v6, s[8:11], s51 offen offset:3072 sc1
    s_add_u32 s50, s34, 4096
    buffer_load_dwordx4 v[80:83], v6, s[8:11], s50 offen offset:0 sc1
    s_add_u32 s51, s43, 4096
    buffer_load_dwordx4 v[84:87], v6, s[8:11], s51 offen offset:0 sc1
    buffer_load_dwordx4 v[88:91], v6, s[8:11], s50 offen offset:1024 sc1
    buffer_load_dwordx4 v[92:95], v6, s[8:11], s51 offen offset:1024 sc1
    buffer_load_dwordx4 v[96:99], v6, s[8:11], s50 offen offset:2048 sc1
    buffer_load_dwordx4 v[100:103], v6, s[8:11], s51 offen offset:2048 sc1
    buffer_load_dwordx4 v[104:107], v6, s[8:11], s50 offen offset:3072 sc1
    buffer_load_dwordx4 v[108:111], v6, s[8:11], s51 offen offset:3072 sc1
    s_add_u32 s50, s34, 8192
    buffer_load_dwordx4 v[112:115], v6, s[8:11], s50 offen offset:0 sc1
    s_add_u32 s51, s43, 8192
    buffer_load_dwordx4 v[116:119], v6, s[8:11], s51 offen offset:0 sc1
    buffer_load_dwordx4 v[120:123], v6, s[8:11], s50 offen offset:1024 sc1
    buffer_load_dwordx4 v[124:127], v6, s[8:11], s51 offen offset:1024 sc1
    s_waitcnt vmcnt(0)
    s_branch L_chk_209
L_stub_213:
    s_add_u32 s40, s40, 1
    s_cmp_gt_u32 s40, 3000
    s_cbranch_scc1 L_ok_214
    s_sleep 2
    s_add_u32 s50, s34, 4096
    buffer_load_dwordx4 v[80:83], v6, s[8:11], s50 offen offset:0 sc1
    s_add_u32 s51, s43, 4096
    buffer_load_dwordx4 v[84:87], v6, s[8:11], s51 offen offset:0 sc1
    buffer_load_dwordx4 v[88:91], v6, s[8:11], s50 offen offset:1024 sc1
    buffer_load_dwordx4 v[92:95], v6, s[8:11], s51 offen offset:1024 sc1
    buffer_load_dwordx4 v[96:99], v6, s[8:11], s50 offen offset:2048 sc1
    buffer_load_dwordx4 v[100:103], v6, s[8:11], s51 offen offset:2048 sc1
    buffer_load_dwordx4 v[104:107], v6, s[8:11], s50 offen offset:3072 sc1
    buffer_load_dwordx4 v[108:111], v6, s[8:11], s51 offen offset:3072 sc1
    s_add_u32 s50, s34, 8192
    buffer_load_dwordx4 v[112:115], v6, s[8:11], s50 offen offset:0 sc1
    s_add_u32 s51, s43, 8192
    buffer_load_dwordx4 v[116:119], v6, s[8:11], s51 offen offset:0 sc1
    buffer_load_dwordx4 v[120:123], v6, s[8:11], s50 offen offset:1024 sc1
    buffer_load_dwordx4 v[124:127], v6, s[8:11], s51 offen offset:1024 sc1
    buffer_load_dwordx4 v[128:131], v6, s[8:11], s50 offen offset:2048 sc1
    buffer_load_dwordx4 v[132:135], v6, s[8:11], s51 offen offset:2048 sc1
    buffer_load_dwordx4 v[136:139], v6, s[8:11], s50 offen offset:3072 sc1
    buffer_load_dwordx4 v[140:143], v6, s[8:11], s51 offen offset:3072 sc1
    s_waitcnt vmcnt(0)
    s_branch L_chk_212
L_stub_216:
    s_add_u32 s40, s40, 1
    s_cmp_gt_u32 s40, 3000
    s_cbranch_scc1 L_ok_217
    s_sleep 2
    s_add_u32 s50, s34, 4096
    buffer_load_dwordx4 v[88:91], v6, s[8:11], s50 offen offset:1024 sc1
    s_add_u32 s51, s43, 4096
    buffer_load_dwordx4 v[92:95], v6, s[8:11], s51 offen offset:1024 sc1
    buffer_load_dwordx4 v[96:99], v6, s[8:11], s50 offen offset:2048 sc1
    buffer_load_dwordx4 v[100:103], v6, s[8:11], s51 offen offset:2048 sc1
    buffer_load_dwordx4 v[104:107], v6, s[8:11], s50 offen offset:3072 sc1
    buffer_load_dwordx4 v[108:111], v6, s[8:11], s51 offen offset:3072 sc1
    s_add_u32 s50, s34, 8192
    buffer_load_dwordx4 v[112:115], v6, s[8:11], s50 offen offset:0 sc1
    s_add_u32 s51, s43, 8192
    buffer_load_dwordx4 v[116:119], v6, s[8:11], s51 offen offset:0 sc1
    buffer_load_dwordx4 v[120:123], v6, s[8:11], s50 offen offset:1024 sc1
    buffer_load_dwordx4 v[124:127], v6, s[8:11], s51 offen offset:1024 sc1
    buffer_load_dwordx4 v[128:131], v6, s[8:11], s50 offen offset:2048 sc1
    buffer_load_dwordx4 v[132:135], v6, s[8:11], s51 offen offset:2048 sc1
    buffer_load_dwordx4 v[136:139], v6, s[8:11], s50 offen offset:3072 sc1
    buffer_load_dwordx4 v[140:143], v6, s[8:11], s51 offen offset:3072 sc1
    s_add_u32 s50, s34, 12288
    buffer_load_dwordx4 v[144:147], v6, s[8:11], s50 offen offset:0 sc1
    s_add_u32 s51, s43, 12288
    buffer_load_dwordx4 v[148:151], v6, s[8:11], s51 offen offset:0 sc1
    buffer_load_dwordx4 v[152:155], v6, s[8:11], s50 offen offset:1024 sc1
    buffer_load_dwordx4 v[156:159], v6, s[8:11], s51 offen offset:1024 sc1
    s_waitcnt vmcnt(0)
    s_branch L_chk_215
L_stub_219:
    s_add_u32 s40, s40, 1
    s_cmp_gt_u32 s40, 3000
    s_cbranch_scc1 L_ok_220
    s_sleep 2
    s_add_u32 s50, s34, 4096
    buffer_load_dwordx4 v[96:99], v6, s[8:11], s50 offen offset:2048 sc1
    s_add_u32 s51, s43, 4096
    buffer_load_dwordx4 v[100:103], v6, s[8:11], s51 offen offset:2048 sc1
    buffer_load_dwordx4 v[104:107], v6, s[8:11], s50 offen offset:3072 sc1
    buffer_load_dwordx4 v[108:111], v6, s[8:11], s51 offen offset:3072 sc1
    s_add_u32 s50, s34, 8192
    buffer_load_dwordx4 v[112:115], v6, s[8:11], s50 offen offset:0 sc1
    s_add_u32 s51, s43, 8192
    buffer_load_dwordx4 v[116:119], v6, s[8:11], s51 offen offset:0 sc1
    buffer_load_dwordx4 v[120:123], v6, s[8:11], s50 offen offset:1024 sc1
    buffer_load_dwordx4 v[124:127], v6, s[8:11], s51 offen offset:1024 sc1
    buffer_load_dwordx4 v[128:131], v6, s[8:11], s50 offen offset:2048 sc1
    buffer_load_dwordx4 v[132:135], v6, s[8:11], s51 offen offset:2048 sc1
    buffer_load_dwordx4 v[136:139], v6, s[8:11], s50 offen offset:3072 sc1
    buffer_load_dwordx4 v[140:143], v6, s[8:11], s51 offen offset:3072 sc1
    s_add_u32 s50, s34, 12288
    buffer_load_dwordx4 v[144:147], v6, s[8:11], s50 offen offset:0 sc1
    s_add_u32 s51, s43, 12288
    buffer_load_dwordx4 v[148:151], v6, s[8:11], s51 offen offset:0 sc1
    buffer_load_dwordx4 v[152:155], v6, s[8:11], s50 offen offset:1024 sc1
    buffer_load_dwordx4 v[156:159], v6, s[8:11], s51 offen offset:1024 sc1
    s_waitcnt vmcnt(0)
    s_branch L_chk_218
L_stub_222:
    s_add_u32 s40, s40, 1
    s_cmp_gt_u32 s40, 3000
    s_cbranch_scc1 L_ok_223
    s_sleep 2
    s_add_u32 s50, s34, 4096
    buffer_load_dwordx4 v[104:107], v6, s[8:11], s50 offen offset:3072 sc1
    s_add_u32 s51, s43, 4096
    buffer_load_dwordx4 v[108:111], v6, s[8:11], s51 offen offset:3072 sc1
    s_add_u32 s50, s34, 8192
    buffer_load_dwordx4 v[112:115], v6, s[8:11], s50 offen offset:0 sc1
    s_add_u32 s51, s43, 8192
    buffer_load_dwordx4 v[116:119], v6, s[8:11], s51 offen offset:0 sc1
    buffer_load_dwordx4 v[120:123], v6, s[8:11], s50 offen offset:1024 sc1
    buffer_load_dwordx4 v[124:127], v6, s[8:11], s51 offen offset:1024 sc1
    buffer_load_dwordx4 v[128:131], v6, s[8:11], s50 offen offset:2048 sc1
    buffer_load_dwordx4 v[132:135], v6, s[8:11], s51 offen offset:2048 sc1
    buffer_load_dwordx4 v[136:139], v6, s[8:11], s50 offen offset:3072 sc1
    buffer_load_dwordx4 v[140:143], v6, s[8:11], s51 offen offset:3072 sc1
    s_add_u32 s50, s34, 12288
    buffer_load_dwordx4 v[144:147], v6, s[8:11], s50 offen offset:0 sc1
    s_add_u32 s51, s43, 12288
    buffer_load_dwordx4 v[148:151], v6, s[8:11], s51 offen offset:0 sc1
    buffer_load_dwordx4 v[152:155], v6, s[8:11], s50 offen offset:1024 sc1
    buffer_load_dwordx4 v[156:159], v6, s[8:11], s51 offen offset:1024 sc1
    s_waitcnt vmcnt(0)
    s_branch L_chk_221
L_stub_225:
    s_add_u32 s40, s40, 1
    s_cmp_gt_u32 s40, 3000
    s_cbranch_scc1 L_ok_226
    s_sleep 2
    s_add_u32 s50, s34, 8192
    buffer_load_dwordx4 v[112:115], v6, s[8:11], s50 offen offset:0 sc1
    s_add_u32 s51, s43, 8192
    buffer_load_dwordx4 v[116:119], v6, s[8:11], s51 offen offset:0 sc1
    buffer_load_dwordx4 v[120:123], v6, s[8:11], s50 offen offset:1024 sc1
    buffer_load_dwordx4 v[124:127], v6, s[8:11], s51 offen offset:1024 sc1
    buffer_load_dwordx4 v[128:131], v6, s[8:11], s50 offen offset:2048 sc1
    buffer_load_dwordx4 v[132:135], v6, s[8:11], s51 offen offset:2048 sc1
    buffer_load_dwordx4 v[136:139], v6, s[8:11], s50 offen offset:3072 sc1
    buffer_load_dwordx4 v[140:143], v6, s[8:11], s51 offen offset:3072 sc1
    s_add_u32 s50, s34, 12288
    buffer_load_dwordx4 v[144:147], v6, s[8:11], s50 offen offset:0 sc1
    s_add_u32 s51, s43, 12288
    buffer_load_dwordx4 v[148:151], v6, s[8:11], s51 offen offset:0 sc1
    buffer_load_dwordx4 v[152:155], v6, s[8:11], s50 offen offset:1024 sc1
    buffer_load_dwordx4 v[156:159], v6, s[8:11], s51 offen offset:1024 sc1
    s_waitcnt vmcnt(0)
    s_branch L_chk_224
L_stub_228:
    s_add_u32 s40, s40, 1
    s_cmp_gt_u32 s40, 3000
    s_cbranch_scc1 L_ok_229
    s_sleep 2
    s_add_u32 s50, s34, 8192
    buffer_load_dwordx4 v[120:123], v6, s[8:11], s50 offen offset:1024 sc1
    s_add_u32 s51, s43, 8192
    buffer_load_dwordx4 v[124:127], v6, s[8:11], s51 offen offset:1024 sc1
    buffer_load_dwordx4 v[128:131], v6, s[8:11], s50 offen offset:2048 sc1
    buffer_load_dwordx4 v[132:135], v6, s[8:11], s51 offen offset:2048 sc1
    buffer_load_dwordx4 v[136:139], v6, s[8:11], s50 offen offset:3072 sc1
    buffer_load_dwordx4 v[140:143], v6, s[8:11], s51 offen offset:3072 sc1
    s_add_u32 s50, s34, 12288
    buffer_load_dwordx4 v[144:147], v6, s[8:11], s50 offen offset:0 sc1
    s_add_u32 s51, s43, 12288
    buffer_load_dwordx4 v[148:151], v6, s[8:11], s51 offen offset:0 sc1
    buffer_load_dwordx4 v[152:155], v6, s[8:11], s50 offen offset:1024 sc1
    buffer_load_dwordx4 v[156:159], v6, s[8:11], s51 offen offset:1024 sc1
    s_waitcnt vmcnt(0)
    s_branch L_chk_227
L_stub_231:
    s_add_u32 s40, s40, 1
    s_cmp_gt_u32 s40, 3000
    s_cbranch_scc1 L_ok_232
    s_sleep 2
    s_add_u32 s50, s34, 8192
    buffer_load_dwordx4 v[128:131], v6, s[8:11], s50 offen offset:2048 sc1
    s_add_u32 s51, s43, 8192
    buffer_load_dwordx4 v[132:135], v6, s[8:11], s51 offen offset:2048 sc1
    buffer_load_dwordx4 v[136:139], v6, s[8:11], s50 offen offset:3072 sc1
    buffer_load_dwordx4 v[140:143], v6, s[8:11], s51 offen offset:3072 sc1
    s_add_u32 s50, s34, 12288
    buffer_load_dwordx4 v[144:147], v6, s[8:11], s50 offen offset:0 sc1
    s_add_u32 s51, s43, 12288
    buffer_load_dwordx4 v[148:151], v6, s[8:11], s51 offen offset:0 sc1
    buffer_load_dwordx4 v[152:155], v6, s[8:11], s50 offen offset:1024 sc1
    buffer_load_dwordx4 v[156:159], v6, s[8:11], s51 offen offset:1024 sc1
    s_waitcnt vmcnt(0)
    s_branch L_chk_230
L_stub_234:
    s_add_u32 s40, s40, 1
    s_cmp_gt_u32 s40, 3000
    s_cbranch_scc1 L_ok_235
    s_sleep 2
    s_add_u32 s50, s34, 8192
    buffer_load_dwordx4 v[136:139], v6, s[8:11], s50 offen offset:3072 sc1
    s_add_u32 s51, s43, 8192
    buffer_load_dwordx4 v[140:143], v6, s[8:11], s51 offen offset:3072 sc1
    s_add_u32 s50, s34, 12288
    buffer_load_dwordx4 v[144:147], v6, s[8:11], s50 offen offset:0 sc1
    s_add_u32 s51, s43, 12288
    buffer_load_dwordx4 v[148:151], v6, s[8:11], s51 offen offset:0 sc1
    buffer_load_dwordx4 v[152:155], v6, s[8:11], s50 offen offset:1024 sc1
    buffer_load_dwordx4 v[156:159], v6, s[8:11], s51 offen offset:1024 sc1
    s_waitcnt vmcnt(0)
    s_branch L_chk_233
L_stub_237:
    s_add_u32 s40, s40, 1
    s_cmp_gt_u32 s40, 3000
    s_cbranch_scc1 L_ok_238
    s_sleep 2
    s_add_u32 s50, s34, 12288
    buffer_load_dwordx4 v[144:147], v6, s[8:11], s50 offen offset:0 sc1
    s_add_u32 s51, s43, 12288
    buffer_load_dwordx4 v[148:151], v6, s[8:11], s51 offen offset:0 sc1
    buffer_load_dwordx4 v[152:155], v6, s[8:11], s50 offen offset:1024 sc1
    buffer_load_dwordx4 v[156:159], v6, s[8:11], s51 offen offset:1024 sc1
    s_waitcnt vmcnt(0)
    s_branch L_chk_236
L_stub_240:
    s_add_u32 s40, s40, 1
    s_cmp_gt_u32 s40, 3000
    s_cbranch_scc1 L_ok_241
    s_sleep 2
    s_add_u32 s50, s34, 12288
    buffer_load_dwordx4 v[152:155], v6, s[8:11], s50 offen offset:1024 sc1
    s_add_u32 s51, s43, 12288
    buffer_load_dwordx4 v[156:159], v6, s[8:11], s51 offen offset:1024 sc1
    s_waitcnt vmcnt(0)
    s_branch L_chk_239
L_stub_98:
    s_add_u32 s59, s59, 1
    s_cmp_gt_u32 s59, 3000
    s_cbranch_scc1 L_ok_99
    s_sleep 2
    buffer_load_dwordx4 v[24:27], v182, s[8:11], s88 offen offset:0 sc1
    buffer_load_dwordx4 v[28:31], v182, s[8:11], s88 offen offset:1024 sc1
    s_waitcnt vmcnt(0)
    v_bitop3_b32 v176, v24, v28, 1 bitop3:0x80
    v_cmp_eq_u32 vcc, 0, v176
    s_cbranch_vccnz L_stub_98
    buffer_load_dwordx4 v[32:35], v182, s[8:11], s88 offen offset:2048 sc1
    buffer_load_dwordx4 v[36:39], v182, s[8:11], s88 offen offset:3072 sc1
    buffer_load_dwordx4 v[40:43], v182, s[8:11], s65 offen offset:0 sc1
    buffer_load_dwordx4 v[44:47], v182, s[8:11], s3 offen offset:0 sc1
    buffer_load_dwordx4 v[48:51], v182, s[8:11], s3 offen offset:1024 sc1
    buffer_load_dwordx4 v[52:55], v182, s[8:11], s3 offen offset:2048 sc1
    buffer_load_dwordx4 v[56:59], v182, s[8:11], s3 offen offset:3072 sc1
    buffer_load_dwordx4 v[60:63], v182, s[8:11], s65 offen offset:1024 sc1
    s_branch L_ok_99
L_stub_100:
    s_add_u32 s59, s59, 1
    s_cmp_gt_u32 s59, 3000
    s_cbranch_scc1 L_ok_101
    s_sleep 2
    buffer_load_dwordx4 v[32:35], v182, s[8:11], s88 offen offset:2048 sc1
    buffer_load_dwordx4 v[36:39], v182, s[8:11], s88 offen offset:3072 sc1
    buffer_load_dwordx4 v[40:43], v182, s[8:11], s65 offen offset:0 sc1
    s_waitcnt vmcnt(0)
    v_bitop3_b32 v176, v32, v36, v40 bitop3:0x80
    v_bitop3_b32 v176, v176, v42, 1 bitop3:0x80
    v_cmp_eq_u32 vcc, 0, v176
    s_cbranch_vccnz L_stub_100
    buffer_load_dwordx4 v[44:47], v182, s[8:11], s3 offen offset:0 sc1
    buffer_load_dwordx4 v[48:51], v182, s[8:11], s3 offen offset:1024 sc1
    buffer_load_dwordx4 v[52:55], v182, s[8:11], s3 offen offset:2048 sc1
    buffer_load_dwordx4 v[56:59], v182, s[8:11], s3 offen offset:3072 sc1
    buffer_load_dwordx4 v[60:63], v182, s[8:11], s65 offen offset:1024 sc1
    s_branch L_ok_101
L_stub_102:
    s_add_u32 s59, s59, 1
    s_cmp_gt_u32 s59, 3000
    s_cbranch_scc1 L_ok_103
    s_sleep 2
    buffer_load_dwordx4 v[44:47], v182, s[8:11], s3 offen offset:0 sc1
    buffer_load_dwordx4 v[48:51], v182, s[8:11], s3 offen offset:1024 sc1
    s_waitcnt vmcnt(0)
    v_bitop3_b32 v176, v44, v48, 1 bitop3:0x80
    v_cmp_eq_u32 vcc, 0, v176
    s_cbranch_vccnz L_stub_102
    buffer_load_dwordx4 v[52:55], v182, s[8:11], s3 offen offset:2048 sc1
    buffer_load_dwordx4 v[56:59], v182, s[8:11], s3 offen offset:3072 sc1
    buffer_load_dwordx4 v[60:63], v182, s[8:11], s65 offen offset:1024 sc1
    s_branch L_ok_103
L_stub_104:
    s_add_u32 s59, s59, 1
    s_cmp_gt_u32 s59, 3000
    s_cbranch_scc1 L_ok_105
    s_sleep 2
    buffer_load_dwordx4 v[52:55], v182, s[8:11], s3 offen offset:2048 sc1
    buffer_load_dwordx4 v[56:59], v182, s[8:11], s3 offen offset:3072 sc1
    buffer_load_dwordx4 v[60:63], v182, s[8:11], s65 offen offset:1024 sc1
    s_waitcnt vmcnt(0)
    v_bitop3_b32 v176, v52, v56, v60 bitop3:0x80
    v_bitop3_b32 v176, v176, v62, 1 bitop3:0x80
    v_cmp_eq_u32 vcc, 0, v176
    s_cbranch_vccnz L_stub_104
    s_branch L_ok_105
L_stub_109:
    s_add_u32 s59, s59, 1
    s_cmp_gt_u32 s59, 3000
    s_cbranch_scc1 L_ok_110
    s_sleep 2
    s_add_u32 s60, s20, 0
    buffer_load_dwordx4 v[68:71], v182, s[8:11], s60 offen offset:0 sc1
    s_waitcnt vmcnt(0)
    v_and_b32 v207, 1, v68
    v_cmp_eq_u32 vcc, 0, v207
    s_cbranch_vccnz L_stub_109
    s_add_u32 s60, s20, 0
    buffer_load_dwordx4 v[72:75], v182, s[8:11], s60 offen offset:1024 sc1
    buffer_load_dwordx4 v[76:79], v182, s[8:11], s60 offen offset:2048 sc1
    buffer_load_dwordx4 v[80:83], v182, s[8:11], s60 offen offset:3072 sc1
    s_add_u32 s60, s20, 4096
    buffer_load_dwordx4 v[84:87], v182, s[8:11], s60 offen offset:0 sc1
    buffer_load_dwordx4 v[88:91], v182, s[8:11], s60 offen offset:1024 sc1
    buffer_load_dwordx4 v[92:95], v182, s[8:11], s60 offen offset:2048 sc1
    buffer_load_dwordx4 v[96:99], v182, s[8:11], s60 offen offset:3072 sc1
    s_branch L_ok_110
L_stub_112:
    s_add_u32 s59, s59, 1
    s_cmp_gt_u32 s59, 3000
    s_cbranch_scc1 L_ok_113
    s_sleep 2
    s_add_u32 s60, s20, 0
    buffer_load_dwordx4 v[72:75], v182, s[8:11], s60 offen offset:1024 sc1
    s_waitcnt vmcnt(0)
    v_and_b32 v207, 1, v72
    v_cmp_eq_u32 vcc, 0, v207
    s_cbranch_vccnz L_stub_112
    s_add_u32 s60, s20, 0
    buffer_load_dwordx4 v[76:79], v182, s[8:11], s60 offen offset:2048 sc1
    buffer_load_dwordx4 v[80:83], v182, s[8:11], s60 offen offset:3072 sc1
    s_add_u32 s60, s20, 4096
    buffer_load_dwordx4 v[84:87], v182, s[8:11], s60 offen offset:0 sc1
    buffer_load_dwordx4 v[88:91], v182, s[8:11], s60 offen offset:1024 sc1
    buffer_load_dwordx4 v[92:95], v182, s[8:11], s60 offen offset:2048 sc1
    buffer_load_dwordx4 v[96:99], v182, s[8:11], s60 offen offset:3072 sc1
    s_add_u32 s60, s20, 8192
    buffer_load_dwordx4 v[100:103], v182, s[8:11], s60 offen offset:0 sc1
    s_branch L_ok_113
L_stub_115:
    s_add_u32 s59, s59, 1
    s_cmp_gt_u32 s59, 3000
    s_cbranch_scc1 L_ok_116
    s_sleep 2
    s_add_u32 s60, s20, 0
    buffer_load_dwordx4 v[76:79], v182, s[8:11], s60 offen offset:2048 sc1
    s_waitcnt vmcnt(0)
    v_and_b32 v207, 1, v76
    v_cmp_eq_u32 vcc, 0, v207
    s_cbranch_vccnz L_stub_115
    s_add_u32 s60, s20, 0
    buffer_load_dwordx4 v[80:83], v182, s[8:11], s60 offen offset:3072 sc1
    s_add_u32 s60, s20, 4096
    buffer_load_dwordx4 v[84:87], v182, s[8:11], s60 offen offset:0 sc1
    buffer_load_dwordx4 v[88:91], v182, s[8:11], s60 offen offset:1024 sc1
    buffer_load_dwordx4 v[92:95], v182, s[8:11], s60 offen offset:2048 sc1
    buffer_load_dwordx4 v[96:99], v182, s[8:11], s60 offen offset:3072 sc1
    s_add_u32 s60, s20, 8192
    buffer_load_dwordx4 v[100:103], v182, s[8:11], s60 offen offset:0 sc1
    buffer_load_dwordx4 v[104:107], v182, s[8:11], s60 offen offset:1024 sc1
    buffer_load_dwordx4 v[108:111], v182, s[8:11], s60 offen offset:2048 sc1
    s_branch L_ok_116
L_stub_118:
    s_add_u32 s59, s59, 1
    s_cmp_gt_u32 s59, 3000
    s_cbranch_scc1 L_ok_119
    s_sleep 2
    s_add_u32 s60, s20, 0
    buffer_load_dwordx4 v[80:83], v182, s[8:11], s60 offen offset:3072 sc1
    s_waitcnt vmcnt(0)
    v_and_b32 v207, 1, v80
    v_cmp_eq_u32 vcc, 0, v207
    s_cbranch_vccnz L_stub_118
    s_add_u32 s60, s20, 4096
    buffer_load_dwordx4 v[84:87], v182, s[8:11], s60 offen offset:0 sc1
    buffer_load_dwordx4 v[88:91], v182, s[8:11], s60 offen offset:1024 sc1
    buffer_load_dwordx4 v[92:95], v182, s[8:11], s60 offen offset:2048 sc1
    buffer_load_dwordx4 v[96:99], v182, s[8:11], s60 offen offset:3072 sc1
    s_add_u32 s60, s20, 8192
    buffer_load_dwordx4 v[100:103], v182, s[8:11], s60 offen offset:0 sc1
    buffer_load_dwordx4 v[104:107], v182, s[8:11], s60 offen offset:1024 sc1
    buffer_load_dwordx4 v[108:111], v182, s[8:11], s60 offen offset:2048 sc1
    buffer_load_dwordx4 v[112:115], v182, s[8:11], s60 offen offset:3072 sc1
    s_add_u32 s60, s20, 12288
    buffer_load_dwordx4 v[116:119], v182, s[8:11], s60 offen offset:0 sc1
    s_branch L_ok_119
L_stub_121:
    s_add_u32 s59, s59, 1
    s_cmp_gt_u32 s59, 3000
    s_cbranch_scc1 L_ok_122
    s_sleep 2
    s_add_u32 s60, s20, 4096
    buffer_load_dwordx4 v[84:87], v182, s[8:11], s60 offen offset:0 sc1
    s_waitcnt vmcnt(0)
    v_bitop3_b32 v207, v84, v86, 1 bitop3:0x80
    v_cmp_eq_u32 vcc, 0, v207
    s_cbranch_vccnz L_stub_121
    s_add_u32 s60, s20, 4096
    buffer_load_dwordx4 v[88:91], v182, s[8:11], s60 offen offset:1024 sc1
    buffer_load_dwordx4 v[92:95], v182, s[8:11], s60 offen offset:2048 sc1
    buffer_load_dwordx4 v[96:99], v182, s[8:11], s60 offen offset:3072 sc1
    s_add_u32 s60, s20, 8192
    buffer_load_dwordx4 v[100:103], v182, s[8:11], s60 offen offset:0 sc1
    buffer_load_dwordx4 v[104:107], v182, s[8:11], s60 offen offset:1024 sc1
    buffer_load_dwordx4 v[108:111], v182, s[8:11], s60 offen offset:2048 sc1
    buffer_load_dwordx4 v[112:115], v182, s[8:11], s60 offen offset:3072 sc1
    s_add_u32 s60, s20, 12288
    buffer_load_dwordx4 v[116:119], v182, s[8:11], s60 offen offset:0 sc1
    buffer_load_dwordx4 v[120:123], v182, s[8:11], s60 offen offset:1024 sc1
    buffer_load_dwordx4 v[124:127], v182, s[8:11], s60 offen offset:2048 sc1
    s_branch L_ok_122
L_stub_124:
    s_add_u32 s59, s59, 1
    s_cmp_gt_u32 s59, 3000
    s_cbranch_scc1 L_ok_125
    s_sleep 2
    s_add_u32 s60, s20, 4096
    buffer_load_dwordx4 v[88:91], v182, s[8:11], s60 offen offset:1024 sc1
    s_waitcnt vmcnt(0)
    v_and_b32 v207, 1, v88
    v_cmp_eq_u32 vcc, 0, v207
    s_cbranch_vccnz L_stub_124
    s_add_u32 s60, s20, 4096
    buffer_load_dwordx4 v[92:95], v182, s[8:11], s60 offen offset:2048 sc1
    buffer_load_dwordx4 v[96:99], v182, s[8:11], s60 offen offset:3072 sc1
    s_add_u32 s60, s20, 8192
    buffer_load_dwordx4 v[100:103], v182, s[8:11], s60 offen offset:0 sc1
    buffer_load_dwordx4 v[104:107], v182, s[8:11], s60 offen offset:1024 sc1
    buffer_load_dwordx4 v[108:111], v182, s[8:11], s60 offen offset:2048 sc1
    buffer_load_dwordx4 v[112:115], v182, s[8:11], s60 offen offset:3072 sc1
    s_add_u32 s60, s20, 12288
    buffer_load_dwordx4 v[116:119], v182, s[8:11], s60 offen offset:0 sc1
    buffer_load_dwordx4 v[120:123], v182, s[8:11], s60 offen offset:1024 sc1
    buffer_load_dwordx4 v[124:127], v182, s[8:11], s60 offen offset:2048 sc1
    buffer_load_dwordx4 v[128:131], v182, s[8:11], s60 offen offset:3072 sc1
    s_add_u32 s60, s20, 16384
    buffer_load_dwordx4 v[132:135], v182, s[8:11], s60 offen offset:0 sc1
    s_branch L_ok_125
L_stub_127:
    s_add_u32 s59, s59, 1
    s_cmp_gt_u32 s59, 3000
    s_cbranch_scc1 L_ok_128
    s_sleep 2
    s_add_u32 s60, s20, 4096
    buffer_load_dwordx4 v[92:95], v182, s[8:11], s60 offen offset:2048 sc1
    s_waitcnt vmcnt(0)
    v_and_b32 v207, 1, v92
    v_cmp_eq_u32 vcc, 0, v207
    s_cbranch_vccnz L_stub_127
    s_add_u32 s60, s20, 4096
    buffer_load_dwordx4 v[96:99], v182, s[8:11], s60 offen offset:3072 sc1
    s_add_u32 s60, s20, 8192
    buffer_load_dwordx4 v[100:103], v182, s[8:11], s60 offen offset:0 sc1
    buffer_load_dwordx4 v[104:107], v182, s[8:11], s60 offen offset:1024 sc1
    buffer_load_dwordx4 v[108:111], v182, s[8:11], s60 offen offset:2048 sc1
    buffer_load_dwordx4 v[112:115], v182, s[8:11], s60 offen offset:3072 sc1
    s_add_u32 s60, s20, 12288
    buffer_load_dwordx4 v[116:119], v182, s[8:11], s60 offen offset:0 sc1
    buffer_load_dwordx4 v[120:123], v182, s[8:11], s60 offen offset:1024 sc1
    buffer_load_dwordx4 v[124:127], v182, s[8:11], s60 offen offset:2048 sc1
    buffer_load_dwordx4 v[128:131], v182, s[8:11], s60 offen offset:3072 sc1
    s_add_u32 s60, s20, 16384
    buffer_load_dwordx4 v[132:135], v182, s[8:11], s60 offen offset:0 sc1
    buffer_load_dwordx4 v[136:139], v182, s[8:11], s60 offen offset:1024 sc1
    buffer_load_dwordx4 v[140:143], v182, s[8:11], s60 offen offset:2048 sc1
    s_branch L_ok_128
L_stub_130:
    s_add_u32 s59, s59, 1
    s_cmp_gt_u32 s59, 3000
    s_cbranch_scc1 L_ok_131
    s_sleep 2
    s_add_u32 s60, s20, 4096
    buffer_load_dwordx4 v[96:99], v182, s[8:11], s60 offen offset:3072 sc1
    s_add_u32 s60, s20, 8192
    buffer_load_dwordx4 v[100:103], v182, s[8:11], s60 offen offset:0 sc1
    buffer_load_dwordx4 v[104:107], v182, s[8:11], s60 offen offset:1024 sc1
    buffer_load_dwordx4 v[108:111], v182, s[8:11], s60 offen offset:2048 sc1
    buffer_load_dwordx4 v[112:115], v182, s[8:11], s60 offen offset:3072 sc1
    s_add_u32 s60, s20, 12288
    buffer_load_dwordx4 v[116:119], v182, s[8:11], s60 offen offset:0 sc1
    buffer_load_dwordx4 v[120:123], v182, s[8:11], s60 offen offset:1024 sc1
    buffer_load_dwordx4 v[124:127], v182, s[8:11], s60 offen offset:2048 sc1
    buffer_load_dwordx4 v[128:131], v182, s[8:11], s60 offen offset:3072 sc1
    s_add_u32 s60, s20, 16384
    buffer_load_dwordx4 v[132:135], v182, s[8:11], s60 offen offset:0 sc1
    buffer_load_dwordx4 v[136:139], v182, s[8:11], s60 offen offset:1024 sc1
    buffer_load_dwordx4 v[140:143], v182, s[8:11], s60 offen offset:2048 sc1
    buffer_load_dwordx4 v[144:147], v182, s[8:11], s60 offen offset:3072 sc1
    s_waitcnt vmcnt(0)
    s_branch L_chk_129
L_stub_133:
    s_add_u32 s59, s59, 1
    s_cmp_gt_u32 s59, 3000
    s_cbranch_scc1 L_ok_134
    s_sleep 2
    s_add_u32 s60, s20, 8192
    buffer_load_dwordx4 v[100:103], v182, s[8:11], s60 offen offset:0 sc1
    buffer_load_dwordx4 v[104:107], v182, s[8:11], s60 offen offset:1024 sc1
    buffer_load_dwordx4 v[108:111], v182, s[8:11], s60 offen offset:2048 sc1
    buffer_load_dwordx4 v[112:115], v182, s[8:11], s60 offen offset:3072 sc1
    s_add_u32 s60, s20, 12288
    buffer_load_dwordx4 v[116:119], v182, s[8:11], s60 offen offset:0 sc1
    buffer_load_dwordx4 v[120:123], v182, s[8:11], s60 offen offset:1024 sc1
    buffer_load_dwordx4 v[124:127], v182, s[8:11], s60 offen offset:2048 sc1
    buffer_load_dwordx4 v[128:131], v182, s[8:11], s60 offen offset:3072 sc1
    s_add_u32 s60, s20, 16384
    buffer_load_dwordx4 v[132:135], v182, s[8:11], s60 offen offset:0 sc1
    buffer_load_dwordx4 v[136:139], v182, s[8:11], s60 offen offset:1024 sc1
    buffer_load_dwordx4 v[140:143], v182, s[8:11], s60 offen offset:2048 sc1
    buffer_load_dwordx4 v[144:147], v182, s[8:11], s60 offen offset:3072 sc1
    s_waitcnt vmcnt(0)
    s_branch L_chk_132
L_stub_137:
    s_add_u32 s59, s59, 1
    s_cmp_gt_u32 s59, 3000
    s_cbranch_scc1 L_ok_138
    s_sleep 2
    s_add_u32 s60, s20, 8192
    buffer_load_dwordx4 v[104:107], v182, s[8:11], s60 offen offset:1024 sc1
    buffer_load_dwordx4 v[108:111], v182, s[8:11], s60 offen offset:2048 sc1
    buffer_load_dwordx4 v[112:115], v182, s[8:11], s60 offen offset:3072 sc1
    s_add_u32 s60, s20, 12288
    buffer_load_dwordx4 v[116:119], v182, s[8:11], s60 offen offset:0 sc1
    buffer_load_dwordx4 v[120:123], v182, s[8:11], s60 offen offset:1024 sc1
    buffer_load_dwordx4 v[124:127], v182, s[8:11], s60 offen offset:2048 sc1
    buffer_load_dwordx4 v[128:131], v182, s[8:11], s60 offen offset:3072 sc1
    s_add_u32 s60, s20, 16384
    buffer_load_dwordx4 v[132:135], v182, s[8:11], s60 offen offset:0 sc1
    buffer_load_dwordx4 v[136:139], v182, s[8:11], s60 offen offset:1024 sc1
    buffer_load_dwordx4 v[140:143], v182, s[8:11], s60 offen offset:2048 sc1
    buffer_load_dwordx4 v[144:147], v182, s[8:11], s60 offen offset:3072 sc1
    s_waitcnt vmcnt(0)
    s_branch L_chk_136
L_stub_141:
    s_add_u32 s59, s59, 1
    s_cmp_gt_u32 s59, 3000
    s_cbranch_scc1 L_ok_142
    s_sleep 2
    s_add_u32 s60, s20, 8192
    buffer_load_dwordx4 v[108:111], v182, s[8:11], s60 offen offset:2048 sc1
    buffer_load_dwordx4 v[112:115], v182, s[8:11], s60 offen offset:3072 sc1
    s_add_u32 s60, s20, 12288
    buffer_load_dwordx4 v[116:119], v182, s[8:11], s60 offen offset:0 sc1
    buffer_load_dwordx4 v[120:123], v182, s[8:11], s60 offen offset:1024 sc1
    buffer_load_dwordx4 v[124:127], v182, s[8:11], s60 offen offset:2048 sc1
    buffer_load_dwordx4 v[128:131], v182, s[8:11], s60 offen offset:3072 sc1
    s_add_u32 s60, s20, 16384
    buffer_load_dwordx4 v[132:135], v182, s[8:11], s60 offen offset:0 sc1
    buffer_load_dwordx4 v[136:139], v182, s[8:11], s60 offen offset:1024 sc1
    buffer_load_dwordx4 v[140:143], v182, s[8:11], s60 offen offset:2048 sc1
    buffer_load_dwordx4 v[144:147], v182, s[8:11], s60 offen offset:3072 sc1
    s_waitcnt vmcnt(0)
    s_branch L_chk_140
L_stub_144:
    s_add_u32 s59, s59, 1
    s_cmp_gt_u32 s59, 3000
    s_cbranch_scc1 L_ok_145
    s_sleep 2
    s_add_u32 s60, s20, 8192
    buffer_load_dwordx4 v[112:115], v182, s[8:11], s60 offen offset:3072 sc1
    s_add_u32 s60, s20, 12288
    buffer_load_dwordx4 v[116:119], v182, s[8:11], s60 offen offset:0 sc1
    buffer_load_dwordx4 v[120:123], v182, s[8:11], s60 offen offset:1024 sc1
    buffer_load_dwordx4 v[124:127], v182, s[8:11], s60 offen offset:2048 sc1
    buffer_load_dwordx4 v[128:131], v182, s[8:11], s60 offen offset:3072 sc1
    s_add_u32 s60, s20, 16384
    buffer_load_dwordx4 v[132:135], v182, s[8:11], s60 offen offset:0 sc1
    buffer_load_dwordx4 v[136:139], v182, s[8:11], s60 offen offset:1024 sc1
    buffer_load_dwordx4 v[140:143], v182, s[8:11], s60 offen offset:2048 sc1
    buffer_load_dwordx4 v[144:147], v182, s[8:11], s60 offen offset:3072 sc1
    s_waitcnt vmcnt(0)
    s_branch L_chk_143
L_stub_147:
    s_add_u32 s59, s59, 1
    s_cmp_gt_u32 s59, 3000
    s_cbranch_scc1 L_ok_148
    s_sleep 2
    s_add_u32 s60, s20, 12288
    buffer_load_dwordx4 v[116:119], v182, s[8:11], s60 offen offset:0 sc1
    buffer_load_dwordx4 v[120:123], v182, s[8:11], s60 offen offset:1024 sc1
    buffer_load_dwordx4 v[124:127], v182, s[8:11], s60 offen offset:2048 sc1
    buffer_load_dwordx4 v[128:131], v182, s[8:11], s60 offen offset:3072 sc1
    s_add_u32 s60, s20, 16384
    buffer_load_dwordx4 v[132:135], v182, s[8:11], s60 offen offset:0 sc1
    buffer_load_dwordx4 v[136:139], v182, s[8:11], s60 offen offset:1024 sc1
    buffer_load_dwordx4 v[140:143], v182, s[8:11], s60 offen offset:2048 sc1
    buffer_load_dwordx4 v[144:147], v182, s[8:11], s60 offen offset:3072 sc1
    s_waitcnt vmcnt(0)
    s_branch L_chk_146
L_stub_150:
    s_add_u32 s59, s59, 1
    s_cmp_gt_u32 s59, 3000
    s_cbranch_scc1 L_ok_151
    s_sleep 2
    s_add_u32 s60, s20, 12288
    buffer_load_dwordx4 v[120:123], v182, s[8:11], s60 offen offset:1024 sc1
    buffer_load_dwordx4 v[124:127], v182, s[8:11], s60 offen offset:2048 sc1
    buffer_load_dwordx4 v[128:131], v182, s[8:11], s60 offen offset:3072 sc1
    s_add_u32 s60, s20, 16384
    buffer_load_dwordx4 v[132:135], v182, s[8:11], s60 offen offset:0 sc1
    buffer_load_dwordx4 v[136:139], v182, s[8:11], s60 offen offset:1024 sc1
    buffer_load_dwordx4 v[140:143], v182, s[8:11], s60 offen offset:2048 sc1
    buffer_load_dwordx4 v[144:147], v182, s[8:11], s60 offen offset:3072 sc1
    s_waitcnt vmcnt(0)
    s_branch L_chk_149
L_stub_153:
    s_add_u32 s59, s59, 1
    s_cmp_gt_u32 s59, 3000
    s_cbranch_scc1 L_ok_154
    s_sleep 2
    s_add_u32 s60, s29, 0
    buffer_load_dwordx2 v[216:217], v206, s[8:11], s60 offen sc1
    s_add_u32 s60, s29, 16384
    buffer_load_dwordx2 v[218:219], v206, s[8:11], s60 offen sc1
    s_add_u32 s60, s29, 32768
    buffer_load_dwordx2 v[220:221], v206, s[8:11], s60 offen sc1
    s_add_u32 s60, s29, 49152
    buffer_load_dwordx2 v[222:223], v206, s[8:11], s60 offen sc1
    s_waitcnt vmcnt(0)
    s_branch L_chk_152
L_stub_156:
    s_add_u32 s59, s59, 1
    s_cmp_gt_u32 s59, 3000
    s_cbranch_scc1 L_ok_157
    s_sleep 2
    s_add_u32 s60, s20, 12288
    buffer_load_dwordx4 v[124:127], v182, s[8:11], s60 offen offset:2048 sc1
    buffer_load_dwordx4 v[128:131], v182, s[8:11], s60 offen offset:3072 sc1
    s_add_u32 s60, s20, 16384
    buffer_load_dwordx4 v[132:135], v182, s[8:11], s60 offen offset:0 sc1
    buffer_load_dwordx4 v[136:139], v182, s[8:11], s60 offen offset:1024 sc1
    buffer_load_dwordx4 v[140:143], v182, s[8:11], s60 offen offset:2048 sc1
    buffer_load_dwordx4 v[144:147], v182, s[8:11], s60 offen offset:3072 sc1
    s_waitcnt vmcnt(0)
    s_branch L_chk_155
L_stub_159:
    s_add_u32 s59, s59, 1
    s_cmp_gt_u32 s59, 3000
    s_cbranch_scc1 L_ok_160
    s_sleep 2
    s_add_u32 s60, s20, 12288
    buffer_load_dwordx4 v[128:131], v182, s[8:11], s60 offen offset:3072 sc1
    s_add_u32 s60, s20, 16384
    buffer_load_dwordx4 v[132:135], v182, s[8:11], s60 offen offset:0 sc1
    buffer_load_dwordx4 v[136:139], v182, s[8:11], s60 offen offset:1024 sc1
    buffer_load_dwordx4 v[140:143], v182, s[8:11], s60 offen offset:2048 sc1
    buffer_load_dwordx4 v[144:147], v182, s[8:11], s60 offen offset:3072 sc1
    s_waitcnt vmcnt(0)
    s_branch L_chk_158
L_stub_162:
    s_add_u32 s59, s59, 1
    s_cmp_gt_u32 s59, 3000
    s_cbranch_scc1 L_ok_163
    s_sleep 2
    s_add_u32 s60, s20, 16384
    buffer_load_dwordx4 v[132:135], v182, s[8:11], s60 offen offset:0 sc1
    buffer_load_dwordx4 v[136:139], v182, s[8:11], s60 offen offset:1024 sc1
    buffer_load_dwordx4 v[140:143], v182, s[8:11], s60 offen offset:2048 sc1
    buffer_load_dwordx4 v[144:147], v182, s[8:11], s60 offen offset:3072 sc1
    s_waitcnt vmcnt(0)
    s_branch L_chk_161
L_stub_165:
    s_add_u32 s59, s59, 1
    s_cmp_gt_u32 s59, 3000
    s_cbranch_scc1 L_ok_166
    s_sleep 2
    s_add_u32 s60, s20, 16384
    buffer_load_dwordx4 v[136:139], v182, s[8:11], s60 offen offset:1024 sc1
    buffer_load_dwordx4 v[140:143], v182, s[8:11], s60 offen offset:2048 sc1
    buffer_load_dwordx4 v[144:147], v182, s[8:11], s60 offen offset:3072 sc1
    s_waitcnt vmcnt(0)
    s_branch L_chk_164
L_stub_168:
    s_add_u32 s59, s59, 1
    s_cmp_gt_u32 s59, 3000
    s_cbranch_scc1 L_ok_169
    s_sleep 2
    s_add_u32 s60, s20, 16384
    buffer_load_dwordx4 v[140:143], v182, s[8:11], s60 offen offset:2048 sc1
    buffer_load_dwordx4 v[144:147], v182, s[8:11], s60 offen offset:3072 sc1
    s_waitcnt vmcnt(0)
    s_branch L_chk_167
L_stub_171:
    s_add_u32 s59, s59, 1
    s_cmp_gt_u32 s59, 3000
    s_cbranch_scc1 L_ok_172
    s_sleep 2
    s_add_u32 s60, s20, 16384
    buffer_load_dwordx4 v[144:147], v182, s[8:11], s60 offen offset:3072 sc1
    s_waitcnt vmcnt(0)
    s_branch L_chk_170
L_end_8:
    s_endpgm
L_text_end:
.section .rodata,"a"
.p2align 6
.amdhsa_kernel k1prep_kernel
  .amdhsa_next_free_vgpr 112
  .amdhsa_next_free_sgpr 102
  .amdhsa_accum_offset 112
  .amdhsa_group_segment_fixed_size 0
  .amdhsa_kernarg_size 104
  .amdhsa_user_sgpr_count 2
  .amdhsa_user_sgpr_kernarg_segment_ptr 1
  .amdhsa_system_sgpr_workgroup_id_x 1
.end_amdhsa_kernel
.p2align 6
.amdhsa_kernel k2to7_kernel
  .amdhsa_next_free_vgpr 256
  .amdhsa_next_free_sgpr 102
  .amdhsa_accum_offset 256
  .amdhsa_group_segment_fixed_size 0
  .amdhsa_kernarg_size 104
  .amdhsa_user_sgpr_count 2
  .amdhsa_user_sgpr_kernarg_segment_ptr 1
  .amdhsa_system_sgpr_workgroup_id_x 1
.end_amdhsa_kernel
```
